```python
import torch

def _softmax(x, axis=-1):
    return torch.softmax(x, dim=axis)
def _gelu(x):
    return torch.nn.functional.gelu(x, approximate="tanh")
def _silu(x):
    return torch.nn.functional.silu(x)
def _sigmoid(x):
    return torch.sigmoid(x)
def _layernorm(x, axis=-1, eps=1e-5):
    m = x.mean(dim=axis, keepdim=True)
    v = x.var(dim=axis, keepdim=True, unbiased=False)
    return (x - m) / torch.sqrt(v + eps)
def _scatter_add(tgt, idx, src, axis=0):
    return tgt.clone().index_add_(axis, idx, src)
def _segment_sum(src, seg, n):
    out = torch.zeros((n,) + src.shape[1:], dtype=src.dtype)
    return out.index_add_(0, seg, src)
def _pad(x, pw):
    flat = tuple(v for pair in reversed(pw) for v in pair)
    return torch.nn.functional.pad(x, flat)

kernel_name = 'sequential_preLN__ssm_conv_s4__glu_gated_bilinear__prompt'

def setup_inputs():

    _w = (lambda a: (lambda t: t.to(torch.bfloat16) if t.is_floating_point() else t)(torch.as_tensor(a)))
    def _A_setup():
        B, L, D, N = 1, 2048, 576, 128
        A_re = -(lambda _x: torch.exp(torch.as_tensor(_x)))((lambda *s: torch.randn(*s, dtype=torch.bfloat16) * 3.2)(D, N))
        A_im = torch.pi * (lambda *s: torch.randn(*s, dtype=torch.bfloat16) * 0.05)(D, N)
        B_re = (lambda *s: torch.randn(*s, dtype=torch.bfloat16) * 0.1)(D, N)
        B_im = (lambda *s: torch.randn(*s, dtype=torch.bfloat16) * 0.1)(D, N)
        C_re = (lambda *s: torch.randn(*s, dtype=torch.bfloat16) * 0.1)(D, N)
        C_im = (lambda *s: torch.randn(*s, dtype=torch.bfloat16) * 0.1)(D, N)
        log_dt = (lambda *s: torch.randn(*s, dtype=torch.bfloat16) * 0.05)(D) * 0.5 - 4.0
        Dskip = (lambda *s: torch.randn(*s, dtype=torch.bfloat16) * 0.05)(D)
        return {
            "u": _w((lambda *s: torch.randn(*s, dtype=torch.bfloat16) * 0.05)(B, L, D)),
            "A_re": _w(A_re),
            "A_im": _w(A_im),
            "B_re": _w(B_re),
            "B_im": _w(B_im),
            "C_re": _w(C_re),
            "C_im": _w(C_im),
            "log_dt": _w(log_dt),
            "Dskip": _w(Dskip),
        }
    _A_in = _A_setup()

    def _B_setup():
        B, S, D, F = 1, 2048, 576, 4608
        return {
            "x": _w((lambda *s: torch.randn(*s, dtype=torch.bfloat16) * 0.05)(B, S, D)),
            "w_gate": _w((lambda *s: torch.randn(*s, dtype=torch.bfloat16) * 0.4)(D, F) * (D ** -0.5)),
            "w_up": _w((lambda *s: torch.randn(*s, dtype=torch.bfloat16) * 0.4)(D, F) * (D ** -0.5)),
            "w_down": _w((lambda *s: torch.randn(*s, dtype=torch.bfloat16) * 0.4)(F, D) * (F ** -0.5)),
        }
    _B_in = _B_setup()

    return {
        "A_u": _A_in["u"],
        "A_A_re": _A_in["A_re"],
        "A_A_im": _A_in["A_im"],
        "A_B_re": _A_in["B_re"],
        "A_B_im": _A_in["B_im"],
        "A_C_re": _A_in["C_re"],
        "A_C_im": _A_in["C_im"],
        "A_log_dt": _A_in["log_dt"],
        "A_Dskip": _A_in["Dskip"],
        "B_x": _B_in["x"],
        "B_w_gate": _B_in["w_gate"],
        "B_w_up": _B_in["w_up"],
        "B_w_down": _B_in["w_down"],
    }

def reference(A_u, A_A_re, A_A_im, A_B_re, A_B_im, A_C_re, A_C_im, A_log_dt, A_Dskip, B_x, B_w_gate, B_w_up, B_w_down):
    def _A_ref(u, A_re, A_im, B_re, B_im, C_re, C_im, log_dt, Dskip):
        Bsz, L, D = u.shape
        dt = torch.exp(log_dt)[:, None]
        A = A_re + 1j * A_im
        Bc = B_re + 1j * B_im
        Cc = C_re + 1j * C_im
        logdA = dt * A
        dB = dt * Bc
        l = (lambda x, dt: x.to(dt))(torch.arange(L), A_re.dtype)
        P = torch.exp(logdA[:, :, None] * l[None, None, :])
        K = torch.einsum("dn,dnl,dn->dl", Cc, P, dB).real
        L2 = 2 * L
        Kp = _pad(K, ((0, 0), (0, L)))
        up = (lambda x, *d: x.permute(*d))(u, 0, 2, 1)
        up = _pad(up, ((0, 0), (0, 0), (0, L)))
        Kf = (lambda x, axes=(-2,-1): torch.fft.rfft2(x.float(), dim=axes))(Kp[:, None, :], axes=(-2, -1))
        Uf = (lambda x, axes=(-2,-1): torch.fft.rfft2(x.float(), dim=axes))(up[:, :, None, :], axes=(-2, -1))
        Yf = Uf * Kf[None, :, :, :]
        y = (lambda x, s, axes=(-2,-1): torch.fft.irfft2(x, s=s, dim=axes).to(torch.bfloat16))(Yf, (1, L2), axes=(-2, -1))[:, :, 0, :L]
        y = (lambda x, *d: x.permute(*d))(y, 0, 2, 1) + u * Dskip[None, None, :]
        return y

    def _B_ref(x, w_gate, w_up, w_down):
        g = torch.einsum("bsd,df->bsf", x, w_gate)
        u = torch.einsum("bsd,df->bsf", x, w_up)
        h = g * u
        return torch.einsum("bsf,fd->bsd", h, w_down)

    x = A_u
    h = x + _A_ref(_layernorm(x, axis=-1), A_A_re, A_A_im, A_B_re, A_B_im, A_C_re, A_C_im, A_log_dt, A_Dskip)
    h2 = h + _B_ref(_layernorm(h, axis=-1), B_w_gate, B_w_up, B_w_down)
    return h2
```

```asm
; @launch grid=(256,1,1) block=(256,1,1) lds=163840
.amdgcn_target "amdgcn-amd-amdhsa--gfx950"
.text
.globl sequential_preLN__ssm_conv_s4__glu_gated_bilinear__prompt_kernel
.p2align 8
.type sequential_preLN__ssm_conv_s4__glu_gated_bilinear__prompt_kernel,@function
sequential_preLN__ssm_conv_s4__glu_gated_bilinear__prompt_kernel:
    s_load_dwordx16 s[8:23], s[0:1], 0
    s_load_dwordx8 s[36:43], s[0:1], 64
    s_load_dwordx8 s[44:51], s[0:1], 96
    s_memrealtime s[52:53]
    s_cmp_ge_u32 s2, 256
    s_cbranch_scc1 sequential_preLN__ssm_conv_s4__glu_gated_bilinear__prompt_kernel_end
    v_lshrrev_b32 v4, 6, v0
    v_and_b32 v1, 63, v0
    v_readfirstlane_b32 s33, v4
    s_nop 0
    s_lshl_b32 s3, s33, 8
    s_add_u32 s3, s3, s2
    s_cmp_ge_u32 s3, 24
    s_cbranch_scc1 sequential_preLN__ssm_conv_s4__glu_gated_bilinear__prompt_kernel_nocp
    s_lshr_b32 s4, s2, 3
    s_getpc_b64 s[6:7]
sequential_preLN__ssm_conv_s4__glu_gated_bilinear__prompt_kernel_cp:
    s_add_u32 s6, s6, sequential_preLN__ssm_conv_s4__glu_gated_bilinear__prompt_kernel_main-sequential_preLN__ssm_conv_s4__glu_gated_bilinear__prompt_kernel_cp
    s_addc_u32 s7, s7, 0
    v_lshl_add_u32 v5, s4, 6, v1
    v_lshlrev_b32 v5, 7, v5
    v_min_u32 v5, sequential_preLN__ssm_conv_s4__glu_gated_bilinear__prompt_kernel_last-sequential_preLN__ssm_conv_s4__glu_gated_bilinear__prompt_kernel_main-4, v5
    global_load_dword v199, v5, s[6:7]
sequential_preLN__ssm_conv_s4__glu_gated_bilinear__prompt_kernel_nocp:
    s_mov_b32 s30, 0x10000000
    s_mov_b32 s31, 0x20000
    s_mov_b32 s7, 0xffff0000
    v_mov_b32 v62, 0
    s_mov_b32 s26, 2359296
    s_mov_b32 s27, 0x20000
    s_cmp_ge_u32 s2, 144
    s_cbranch_scc1 sequential_preLN__ssm_conv_s4__glu_gated_bilinear__prompt_kernel_pack
    s_and_b32 s54, s2, 7
    s_mul_i32 s54, s54, 18
    s_lshr_b32 s55, s2, 3
    s_add_u32 s32, s54, s55
    s_lshl_b32 s34, s32, 2
    s_add_u32 s34, s34, s33
    s_lshl_b32 s4, s34, 8
    v_lshl_add_u32 v6, v1, 2, s4
    s_lshl_b32 s4, s34, 1
    v_mov_b32 v7, s4
    v_lshrrev_b32 v8, 1, v0
    v_mul_u32_u24 v8, 1152, v8
    v_and_b32 v9, 1, v0
    v_lshl_add_u32 v8, v9, 7, v8
    s_mul_i32 s5, s55, 147456
    s_lshr_b32 s4, s54, 4
    s_lshl_b32 s4, s4, 7
    s_add_u32 s5, s5, s4
    v_lshrrev_b32 v2, 4, v0
    v_and_b32 v3, 15, v0
    v_mul_u32_u24 v10, 1152, v2
    v_lshl_add_u32 v10, v3, 3, v10
    s_mul_i32 s6, s2, 18432
    s_waitcnt lgkmcnt(0)
    s_cmp_lg_u32 s3, 256
    s_cbranch_scc1 sequential_preLN__ssm_conv_s4__glu_gated_bilinear__prompt_kernel_nonon
    s_lshl_b32 s4, s52, 3
    s_or_b32 s4, s4, 1
    v_mov_b32 v29, s4
    s_mov_b64 exec, 1
    global_store_dword v62, v29, s[48:49] sc1
    s_mov_b64 exec, -1
sequential_preLN__ssm_conv_s4__glu_gated_bilinear__prompt_kernel_nonon:
    global_load_ushort v206, v7, s[22:23]
    global_load_dword v200, v6, s[10:11]
    global_load_dword v201, v6, s[12:13]
    global_load_dword v202, v6, s[14:15]
    global_load_dword v203, v6, s[16:17]
    global_load_dword v204, v6, s[18:19]
    global_load_dword v205, v6, s[20:21]
    global_load_ushort v207, v7, s[36:37]
    s_mov_b32 s24, s8
    s_and_b32 s25, s9, 0xffff
    s_mov_b32 s28, s50
    s_and_b32 s29, s51, 0xffff
    buffer_load_dwordx2 v[160:161], v10, s[24:27], s6 offen offset:0
    buffer_load_dwordx2 v[162:163], v10, s[24:27], s6 offen offset:128
    buffer_load_dwordx2 v[164:165], v10, s[24:27], s6 offen offset:256
    buffer_load_dwordx2 v[166:167], v10, s[24:27], s6 offen offset:384
    buffer_load_dwordx2 v[168:169], v10, s[24:27], s6 offen offset:512
    buffer_load_dwordx2 v[170:171], v10, s[24:27], s6 offen offset:640
    buffer_load_dwordx2 v[172:173], v10, s[24:27], s6 offen offset:768
    buffer_load_dwordx2 v[174:175], v10, s[24:27], s6 offen offset:896
    buffer_load_dwordx2 v[176:177], v10, s[24:27], s6 offen offset:1024
    v_mov_b32 v198, v8
    s_mov_b32 s77, s5
    s_branch sequential_preLN__ssm_conv_s4__glu_gated_bilinear__prompt_kernel_main
sequential_preLN__ssm_conv_s4__glu_gated_bilinear__prompt_kernel_end:
    s_endpgm
.p2align 12
sequential_preLN__ssm_conv_s4__glu_gated_bilinear__prompt_kernel_main:
    s_mul_i32 s35, s33, 30912
    s_mul_i32 s78, s33, 8320
    v_lshl_add_u32 v4, v1, 3, s35
    v_bfe_u32 v2, v0, 4, 2
    v_and_b32 v3, 15, v0
    v_lshl_add_u32 v24, v2, 4, s35
    s_movk_i32 s4, 544
    v_mad_u32_u24 v5, v3, s4, v24
    v_min_u32 v25, 4, v3
    v_mad_u32_u24 v6, v25, s4, v24
    v_max_u32 v24, 1, v2
    v_sub_u32 v24, 5, v24
    v_lshlrev_b32 v25, v24, v3
    v_lshlrev_b32 v26, 8, v2
    v_cmp_eq_u32 vcc, 1, v2
    s_add_u32 s4, s35, 28848
    s_nop 0
    v_cndmask_b32 v26, v26, 8, vcc
    v_add3_u32 v7, v25, v26, s4
    v_lshlrev_b32 v25, v24, 16
    v_add_u32 v10, v7, v25
    v_cmp_eq_u32 vcc, 3, v2
    v_mov_b32 v26, 128
    v_lshlrev_b32 v24, 8, v2
    v_cndmask_b32 v26, 4, v26, vcc
    v_add_u32 v8, v7, v26
    v_add_u32 v11, v10, v26
    v_lshl_add_u32 v24, v3, 1, v24
    v_add_u32 v9, s4, v24
    v_mov_b32 v24, s4
    v_subrev_u32 v24, 4, v24
    ds_write_b32 v24, v62
    v_lshlrev_b32 v25, 2, v2
    v_sub_u32 v25, v3, v25
    v_lshl_add_u32 v53, v25, 2, s4
    v_add_u32 v53, 1016, v53
    v_cmp_le_i32 s[58:59], 0, v25
    v_cmp_le_i32 s[60:61], 1, v25
    v_cmp_le_i32 s[62:63], 2, v25
    v_cmp_le_i32 s[64:65], 3, v25
    v_mov_b32 v63, s4
    v_lshlrev_b32 v25, 2, v1
    v_sub_u32 v54, s4, v25
    v_add_u32 v54, 1020, v54
    v_lshlrev_b32 v25, 3, v1
    v_sub_u32 v26, 760, v25
    v_lshlrev_b32 v25, 4, v1
    v_sub_u32 v27, 1008, v25
    v_min_i32 v27, v27, v26
    v_add_u32 v55, v27, v24
    v_add_u32 v23, s78, v25
    s_lshl_b32 s4, s33, 12
    s_add_u32 s4, s4, 0x0
    v_add_u32 v57, s4, v25
    v_mul_u32_u24 v56, 9216, v0
    s_lshl_b32 s56, s32, 3
    s_add_u32 s57, s56, 4608
    v_cmp_gt_u32 s[68:69], 32, v1
    v_mov_b32 v24, 0x05040706
    v_mov_b32 v25, 0x03020504
    v_mov_b32 v26, 0x01000100
    v_cndmask_b32 v48, v24, v25, s[68:69]
    v_cndmask_b32 v49, v24, v26, s[68:69]
    v_cmp_gt_u32 vcc, 31, v1
    v_mov_b32 v24, 0x07060100
    v_mov_b32 v51, 0x0c0c0c0c
    v_cndmask_b32 v50, v24, v26, vcc
    v_mov_b32 v52, v51
    v_mov_b32 v196, v51
    s_mov_b32 s6, 0x03020c0c
    s_mov_b32 s70, 0x01000100
    s_mov_b32 s71, 0x03020302
    s_mov_b32 s72, 0x01000302
    s_mov_b32 s73, 0x03020504
    s_mov_b32 s75, 0x05040100
    s_mov_b32 s76, 0x07060302
    v_writelane_b32 v51, s71, 3
    v_writelane_b32 v51, s71, 7
    v_writelane_b32 v52, s70, 3
    v_writelane_b32 v52, s72, 7
    v_writelane_b32 v52, s6, 2
    v_writelane_b32 v196, s70, 3
    v_writelane_b32 v196, s70, 7
    v_writelane_b32 v196, s71, 2
    v_writelane_b32 v196, s71, 6
    v_and_b32 v24, 1, v3
    v_mul_u32_u24 v25, 4162, v24
    v_lshlrev_b32 v26, 1, v3
    v_sub_u32 v25, v25, v26
    v_lshl_add_u32 v25, v2, 4, v25
    v_add_u32 v25, s78, v25
    v_add_u32 v12, 3100, v25
    v_add_u32 v13, 2076, v25
    v_add_u32 v14, 1052, v25
    v_lshl_add_u32 v24, v3, 1, v2
    v_lshlrev_b32 v24, 7, v24
    v_lshrrev_b32 v25, 1, v2
    v_add3_u32 v25, v25, v3, s33
    v_add_u32 v26, 7, v25
    v_and_b32 v26, 7, v26
    v_lshl_add_u32 v26, v26, 4, v24
    v_add_u32 v16, 125184, v26
    v_add_u32 v26, 5, v25
    v_and_b32 v26, 7, v26
    v_lshl_add_u32 v26, v26, 4, v24
    v_add_u32 v17, 124672, v26
    v_add_u32 v26, 3, v25
    v_and_b32 v26, 7, v26
    v_lshl_add_u32 v26, v26, 4, v24
    v_add_u32 v18, 124160, v26
    v_add_u32 v26, 1, v25
    v_and_b32 v26, 7, v26
    v_lshl_add_u32 v26, v26, 4, v24
    v_add_u32 v19, 123648, v26
    v_lshrrev_b32 v25, 1, v2
    v_lshl_add_u32 v24, v3, 1, v25
    v_lshlrev_b32 v22, 4, v24
    v_and_b32 v22, 127, v22
    v_and_b32 v26, 1, v2
    v_lshrrev_b32 v27, 2, v3
    v_lshl_add_u32 v27, v26, 2, v27
    v_mul_u32_u24 v27, 73728, v27
    v_add_u32 v22, v22, v27
    v_lshl_add_u32 v24, v3, 1, v26
    v_lshlrev_b32 v24, 7, v24
    v_lshl_add_u32 v25, v25, 2, v3
    v_add3_u32 v25, v25, 4, s33
    v_and_b32 v25, 7, v25
    v_lshl_add_u32 v25, v25, 4, v24
    v_add_u32 v20, 127488, v25
    v_lshl_add_u32 v24, v3, 1, v2
    v_add_u32 v25, 13, v24
    v_lshrrev_b32 v25, 1, v25
    v_add_u32 v25, s33, v25
    v_and_b32 v25, 7, v25
    v_lshlrev_b32 v27, 7, v24
    v_lshl_add_u32 v25, v25, 4, v27
    v_add_u32 v21, 127104, v25
    v_lshrrev_b32 v25, 1, v24
    v_add3_u32 v25, v25, 6, s33
    v_and_b32 v25, 7, v25
    v_lshl_add_u32 v25, v25, 4, v27
    v_add_u32 v15, 126976, v25
    s_lshl_b32 s79, s34, 7
    s_add_u32 s79, s79, 0x900000
    v_lshrrev_b32 v24, 1, v0
    v_lshlrev_b32 v25, 7, v0
    v_add_u32 v25, 127488, v25
    v_add_u32 v26, 0, v24
    v_and_b32 v26, 7, v26
    v_lshl_add_u32 v58, v26, 4, v25
    v_add_u32 v26, 1, v24
    v_and_b32 v26, 7, v26
    v_lshl_add_u32 v59, v26, 4, v25
    v_add_u32 v26, 2, v24
    v_and_b32 v26, 7, v26
    v_lshl_add_u32 v60, v26, 4, v25
    v_add_u32 v26, 3, v24
    v_and_b32 v26, 7, v26
    v_lshl_add_u32 v61, v26, 4, v25
    buffer_load_dword v199, v198, s[24:27], s77 offen
    s_mov_b32 s4, 0x8001
    s_mov_b32 s6, 0x10001
    v_lshlrev_b32 v26, 3, v2
    v_sub_u32 v26, v3, v26
    v_mov_b32 v25, 0
    v_add_u32 v27, 28, v26
    v_mov_b32 v24, 511
    v_lshlrev_b64 v[28:29], v27, v[24:25]
    v_bfe_u32 v27, v28, 24, 2
    v_mul_u32_u24 v27, s4, v27
    v_and_b32 v27, s6, v27
    v_mul_u32_u24 v27, 0x3f80, v27
    v_accvgpr_write_b32 a20, v27
    v_bfe_u32 v27, v28, 26, 2
    v_mul_u32_u24 v27, s4, v27
    v_and_b32 v27, s6, v27
    v_mul_u32_u24 v27, 0x3f80, v27
    v_accvgpr_write_b32 a21, v27
    v_bfe_u32 v27, v28, 28, 2
    v_mul_u32_u24 v27, s4, v27
    v_and_b32 v27, s6, v27
    v_mul_u32_u24 v27, 0x3f80, v27
    v_accvgpr_write_b32 a22, v27
    v_bfe_u32 v27, v28, 30, 2
    v_mul_u32_u24 v27, s4, v27
    v_and_b32 v27, s6, v27
    v_mul_u32_u24 v27, 0x3f80, v27
    v_accvgpr_write_b32 a23, v27
    v_add_u32 v27, 29, v26
    v_mov_b32 v24, 127
    v_lshlrev_b64 v[28:29], v27, v[24:25]
    v_bfe_u32 v27, v28, 24, 2
    v_mul_u32_u24 v27, s4, v27
    v_and_b32 v27, s6, v27
    v_mul_u32_u24 v27, 0x3f80, v27
    v_accvgpr_write_b32 a24, v27
    v_bfe_u32 v27, v28, 26, 2
    v_mul_u32_u24 v27, s4, v27
    v_and_b32 v27, s6, v27
    v_mul_u32_u24 v27, 0x3f80, v27
    v_accvgpr_write_b32 a25, v27
    v_bfe_u32 v27, v28, 28, 2
    v_mul_u32_u24 v27, s4, v27
    v_and_b32 v27, s6, v27
    v_mul_u32_u24 v27, 0x3f80, v27
    v_accvgpr_write_b32 a26, v27
    v_bfe_u32 v27, v28, 30, 2
    v_mul_u32_u24 v27, s4, v27
    v_and_b32 v27, s6, v27
    v_mul_u32_u24 v27, 0x3f80, v27
    v_accvgpr_write_b32 a27, v27
    v_and_b32 v27, 1, v2
    v_lshlrev_b32 v27, 3, v27
    v_sub_u32 v27, v3, v27
    v_add_u32 v27, 24, v27
    v_mov_b32 v24, 1
    v_lshlrev_b64 v[28:29], v27, v[24:25]
    v_bfe_u32 v27, v28, 24, 2
    v_mul_u32_u24 v27, s4, v27
    v_and_b32 v240, s6, v27
    v_bfe_u32 v27, v28, 26, 2
    v_mul_u32_u24 v27, s4, v27
    v_and_b32 v241, s6, v27
    v_bfe_u32 v27, v28, 28, 2
    v_mul_u32_u24 v27, s4, v27
    v_and_b32 v242, s6, v27
    v_bfe_u32 v27, v28, 30, 2
    v_mul_u32_u24 v27, s4, v27
    v_and_b32 v243, s6, v27
    v_cmp_gt_u32 s[66:67], 2, v2
    s_lshl_b32 s4, s2, 1
    s_lshr_b32 s6, s33, 1
    s_add_u32 s4, s4, s6
    s_lshr_b32 s6, s4, 6
    s_lshl_b32 s6, s6, 12
    s_and_b32 s4, s4, 63
    s_lshl_b32 s4, s4, 4
    s_add_u32 s4, s4, s6
    s_and_b32 s6, s33, 1
    s_lshl_b32 s6, s6, 11
    s_add_u32 s4, s4, s6
    s_add_u32 s54, s4, 0x0
    v_lshrrev_b32 v24, 1, v2
    v_and_b32 v25, 1, v2
    v_lshlrev_b32 v25, 3, v25
    v_lshl_add_u32 v24, v24, 10, v25
    s_lshr_b32 s4, s2, 7
    v_add_u32 v25, s4, v3
    v_min_u32 v25, 1, v25
    v_lshl_add_u32 v197, v25, 29, v24
    s_mov_b32 s55, 0x3f803f80
    v_mov_b32 v180, 0
    v_mov_b32 v181, 0
    v_mov_b32 v182, 0
    v_mov_b32 v183, 0
    v_mov_b32 v24, 0
    v_mov_b32 v25, 0
    v_mov_b32 v26, 0
    v_mov_b32 v27, 0
    v_min_u32 v28, 239, v0
    v_lshlrev_b32 v28, 4, v28
    v_add_u32 v28, 123648, v28
    ds_write_b128 v28, v[24:27]
    v_bfe_u32 v28, v0, 2, 1
    v_mul_u32_u24 v28, 4160, v28
    v_and_b32 v29, 3, v0
    v_lshl_add_u32 v28, v29, 4, v28
    v_add_u32 v28, s78, v28
    v_bfe_u32 v29, v0, 3, 1
    v_mul_u32_u24 v29, 2112, v29
    v_add_u32 v28, v28, v29
    v_mov_b32 v44, 0x3f80
    v_mov_b32 v45, 0x3f80
    ds_write_b64 v4, v[44:45] offset:17408
    s_mov_b64 exec, 0
    s_cmp_eq_u32 s33, 0
    s_cbranch_scc1 sequential_preLN__ssm_conv_s4__glu_gated_bilinear__prompt_kernel_c_h0
    s_cmp_eq_u32 s33, 1
    s_cbranch_scc1 sequential_preLN__ssm_conv_s4__glu_gated_bilinear__prompt_kernel_c_h1
    s_cmp_eq_u32 s33, 2
    s_cbranch_scc1 sequential_preLN__ssm_conv_s4__glu_gated_bilinear__prompt_kernel_c_h2
    s_branch sequential_preLN__ssm_conv_s4__glu_gated_bilinear__prompt_kernel_c_h3
sequential_preLN__ssm_conv_s4__glu_gated_bilinear__prompt_kernel_c_h2:
sequential_preLN__ssm_conv_s4__glu_gated_bilinear__prompt_kernel_c_h3:
sequential_preLN__ssm_conv_s4__glu_gated_bilinear__prompt_kernel_c_ret:
    s_mov_b64 exec, -1
sequential_preLN__ssm_conv_s4__glu_gated_bilinear__prompt_kernel_c0:
    s_waitcnt vmcnt(9)
    v_dot2c_f32_bf16 v180, s55, v160
    v_dot2c_f32_bf16 v182, v160, v160
    v_dot2c_f32_bf16 v181, s55, v161
    v_dot2c_f32_bf16 v183, v161, v161
    s_waitcnt vmcnt(8)
    v_dot2c_f32_bf16 v180, s55, v162
    v_dot2c_f32_bf16 v182, v162, v162
    v_dot2c_f32_bf16 v181, s55, v163
    v_dot2c_f32_bf16 v183, v163, v163
    s_waitcnt vmcnt(7)
    v_dot2c_f32_bf16 v180, s55, v164
    v_dot2c_f32_bf16 v182, v164, v164
    v_dot2c_f32_bf16 v181, s55, v165
    v_dot2c_f32_bf16 v183, v165, v165
    s_waitcnt vmcnt(6)
    v_dot2c_f32_bf16 v180, s55, v166
    v_dot2c_f32_bf16 v182, v166, v166
    v_dot2c_f32_bf16 v181, s55, v167
    v_dot2c_f32_bf16 v183, v167, v167
    s_waitcnt vmcnt(5)
    v_dot2c_f32_bf16 v180, s55, v168
    v_dot2c_f32_bf16 v182, v168, v168
    v_dot2c_f32_bf16 v181, s55, v169
    v_dot2c_f32_bf16 v183, v169, v169
    s_waitcnt vmcnt(4)
    v_dot2c_f32_bf16 v180, s55, v170
    v_dot2c_f32_bf16 v182, v170, v170
    v_dot2c_f32_bf16 v181, s55, v171
    v_dot2c_f32_bf16 v183, v171, v171
    s_waitcnt vmcnt(3)
    v_dot2c_f32_bf16 v180, s55, v172
    v_dot2c_f32_bf16 v182, v172, v172
    v_dot2c_f32_bf16 v181, s55, v173
    v_dot2c_f32_bf16 v183, v173, v173
    s_waitcnt vmcnt(2)
    v_dot2c_f32_bf16 v180, s55, v174
    v_dot2c_f32_bf16 v182, v174, v174
    v_dot2c_f32_bf16 v181, s55, v175
    v_dot2c_f32_bf16 v183, v175, v175
    s_waitcnt vmcnt(1)
    v_dot2c_f32_bf16 v180, s55, v176
    v_dot2c_f32_bf16 v182, v176, v176
    v_dot2c_f32_bf16 v181, s55, v177
    v_dot2c_f32_bf16 v183, v177, v177
    global_load_dword v31, v62, s[48:49] sc1
    v_lshlrev_b32 v46, 16, v206
    v_add_f32 v180, v180, v181
    v_mul_f32 v46, 0x3fb8aa3b, v46
    v_add_f32 v182, v182, v183
    v_exp_f32 v46, v46
    v_add_f32_dpp v180, v180, v180 row_ror:8 row_mask:0xf bank_mask:0xf
    v_cvt_pk_bf16_f32 v46, v46, v46
    v_add_f32_dpp v182, v182, v182 row_ror:8 row_mask:0xf bank_mask:0xf
    v_lshlrev_b32 v46, 16, v46
    v_add_f32_dpp v180, v180, v180 row_ror:4 row_mask:0xf bank_mask:0xf
    v_lshlrev_b32 v64, 16, v200
    v_add_f32_dpp v182, v182, v182 row_ror:4 row_mask:0xf bank_mask:0xf
    v_lshlrev_b32 v65, 16, v201
    v_add_f32_dpp v180, v180, v180 row_ror:2 row_mask:0xf bank_mask:0xf
    v_lshlrev_b32 v66, 16, v202
    v_add_f32_dpp v182, v182, v182 row_ror:2 row_mask:0xf bank_mask:0xf
    v_lshlrev_b32 v67, 16, v203
    v_add_f32_dpp v180, v180, v180 row_ror:1 row_mask:0xf bank_mask:0xf
    v_lshlrev_b32 v68, 16, v204
    v_add_f32_dpp v182, v182, v182 row_ror:1 row_mask:0xf bank_mask:0xf
    v_lshlrev_b32 v69, 16, v205
    v_mul_f32 v180, 0x3ae38e39, v180
    v_and_b32 v112, s7, v200
    v_mul_f32 v182, 0x3ae38e39, v182
    v_and_b32 v113, s7, v201
    v_fma_f32 v182, -v180, v180, v182
    v_and_b32 v114, s7, v202
    v_max_f32 v182, 0, v182
    v_and_b32 v115, s7, v203
    v_cvt_pk_bf16_f32 v182, v182, v182
    v_and_b32 v116, s7, v204
    v_lshlrev_b32 v182, 16, v182
    v_and_b32 v117, s7, v205
    v_add_f32 v182, 0x3727c5ac, v182
    v_pk_mul_f32 v[64:65], v[64:65], v[46:47] op_sel_hi:[1,0]
    v_cvt_pk_bf16_f32 v182, v182, v182
    v_pk_mul_f32 v[66:67], v[66:67], v[46:47] op_sel_hi:[1,0]
    v_lshlrev_b32 v182, 16, v182
    v_pk_mul_f32 v[112:113], v[112:113], v[46:47] op_sel_hi:[1,0]
    v_sqrt_f32 v182, v182
    v_pk_mul_f32 v[114:115], v[114:115], v[46:47] op_sel_hi:[1,0]
    v_cvt_pk_bf16_f32 v30, v182, v180
    v_mul_f32 v64, 0x3fb8aa3b, v64
    v_mul_f32 v65, 0.15915494, v65
    v_pk_mul_f32 v[76:77], v[68:69], v[66:67] op_sel_hi:[1,0]
    v_pk_fma_f32 v[76:77], v[68:69], v[66:67], v[76:77] op_sel:[1,1,0] op_sel_hi:[0,1,1] neg_lo:[1,0,0]
    v_mul_f32 v112, 0x3fb8aa3b, v112
    v_mul_f32 v113, 0.15915494, v113
    v_pk_mul_f32 v[124:125], v[116:117], v[114:115] op_sel_hi:[1,0]
    v_pk_fma_f32 v[124:125], v[116:117], v[114:115], v[124:125] op_sel:[1,1,0] op_sel_hi:[0,1,1] neg_lo:[1,0,0]
    v_mul_f32 v104, 0x43000000, v64
    v_mul_f32 v105, 0x43000000, v65
    v_fract_f32 v105, v105
    v_exp_f32 v104, v104
    v_cos_f32 v74, v105
    v_sin_f32 v75, v105
    v_mul_f32 v152, 0x43000000, v112
    v_mul_f32 v153, 0x43000000, v113
    v_fract_f32 v153, v153
    v_exp_f32 v152, v152
    v_cos_f32 v122, v153
    v_sin_f32 v123, v153
    v_mul_f32 v106, 0x41000000, v64
    v_mul_f32 v107, 0x41000000, v65
    v_fract_f32 v107, v107
    v_exp_f32 v106, v106
    v_cos_f32 v72, v107
    v_sin_f32 v73, v107
    v_mul_f32 v154, 0x41000000, v112
    v_mul_f32 v155, 0x41000000, v113
    v_fract_f32 v155, v155
    v_exp_f32 v154, v154
    v_cos_f32 v120, v155
    v_sin_f32 v121, v155
    v_fract_f32 v109, v65
    v_exp_f32 v108, v64
    v_cos_f32 v70, v109
    v_sin_f32 v71, v109
    v_fract_f32 v157, v113
    v_exp_f32 v156, v112
    v_cos_f32 v118, v157
    v_sin_f32 v119, v157
    v_pk_mul_f32 v[74:75], v[74:75], v[104:105] op_sel_hi:[1,0]
    v_pk_mul_f32 v[122:123], v[122:123], v[152:153] op_sel_hi:[1,0]
    v_pk_mul_f32 v[72:73], v[72:73], v[106:107] op_sel_hi:[1,0]
    v_pk_mul_f32 v[120:121], v[120:121], v[154:155] op_sel_hi:[1,0]
    v_pk_mul_f32 v[70:71], v[70:71], v[108:109] op_sel_hi:[1,0]
    v_pk_mul_f32 v[118:119], v[118:119], v[156:157] op_sel_hi:[1,0]
    v_pk_mul_f32 v[80:81], v[76:77], v[74:75] op_sel_hi:[1,0]
    v_pk_mul_f32 v[128:129], v[124:125], v[122:123] op_sel_hi:[1,0]
    v_pk_fma_f32 v[80:81], v[76:77], v[74:75], v[80:81] op_sel:[1,1,0] op_sel_hi:[0,1,1] neg_lo:[1,0,0]
    v_pk_fma_f32 v[128:129], v[124:125], v[122:123], v[128:129] op_sel:[1,1,0] op_sel_hi:[0,1,1] neg_lo:[1,0,0]
    v_pk_mul_f32 v[78:79], v[76:77], v[72:73] op_sel_hi:[1,0]
    v_pk_mul_f32 v[126:127], v[124:125], v[120:121] op_sel_hi:[1,0]
    v_pk_mul_f32 v[82:83], v[80:81], v[72:73] op_sel_hi:[1,0]
    v_pk_mul_f32 v[130:131], v[128:129], v[120:121] op_sel_hi:[1,0]
    v_cvt_pk_bf16_f32 v34, v76, v77
    v_cvt_pk_bf16_f32 v35, v124, v125
    v_pk_fma_f32 v[78:79], v[76:77], v[72:73], v[78:79] op_sel:[1,1,0] op_sel_hi:[0,1,1] neg_lo:[1,0,0]
    v_pk_fma_f32 v[126:127], v[124:125], v[120:121], v[126:127] op_sel:[1,1,0] op_sel_hi:[0,1,1] neg_lo:[1,0,0]
    v_pk_fma_f32 v[82:83], v[80:81], v[72:73], v[82:83] op_sel:[1,1,0] op_sel_hi:[0,1,1] neg_lo:[1,0,0]
    v_pk_fma_f32 v[130:131], v[128:129], v[120:121], v[130:131] op_sel:[1,1,0] op_sel_hi:[0,1,1] neg_lo:[1,0,0]
    v_cvt_pk_bf16_f32 v36, v80, v81
    v_cvt_pk_bf16_f32 v37, v128, v129
    v_cvt_pk_bf16_f32 v38, v70, -v71
    v_cvt_pk_bf16_f32 v39, v118, -v119
    v_pk_mul_f32 v[84:85], v[70:71], v[70:71] op_sel_hi:[1,0]
    v_pk_mul_f32 v[132:133], v[118:119], v[118:119] op_sel_hi:[1,0]
    v_pk_fma_f32 v[84:85], v[70:71], v[70:71], v[84:85] op_sel:[1,1,0] op_sel_hi:[0,1,1] neg_lo:[1,0,0]
    v_pk_fma_f32 v[132:133], v[118:119], v[118:119], v[132:133] op_sel:[1,1,0] op_sel_hi:[0,1,1] neg_lo:[1,0,0]
    v_cvt_pk_bf16_f32 v40, v84, -v85
    v_cvt_pk_bf16_f32 v41, v132, -v133
    ds_write_b64 v4, v[34:35] offset:0
    ds_write_b64 v4, v[36:37] offset:8704
    ds_write_b64 v4, v[38:39] offset:17952
    ds_write_b64 v4, v[40:41] offset:18496
    buffer_load_dwordx2 v[208:209], v56, s[24:27], s56 offen offset:0
    v_pk_mul_f32 v[76:77], v[78:79], v[72:73] op_sel_hi:[1,0]
    v_pk_mul_f32 v[124:125], v[126:127], v[120:121] op_sel_hi:[1,0]
    v_pk_mul_f32 v[80:81], v[82:83], v[72:73] op_sel_hi:[1,0]
    v_pk_mul_f32 v[128:129], v[130:131], v[120:121] op_sel_hi:[1,0]
    v_cvt_pk_bf16_f32 v42, v78, v79
    v_cvt_pk_bf16_f32 v43, v126, v127
    v_pk_fma_f32 v[76:77], v[78:79], v[72:73], v[76:77] op_sel:[1,1,0] op_sel_hi:[0,1,1] neg_lo:[1,0,0]
    v_pk_fma_f32 v[124:125], v[126:127], v[120:121], v[124:125] op_sel:[1,1,0] op_sel_hi:[0,1,1] neg_lo:[1,0,0]
    v_pk_fma_f32 v[80:81], v[82:83], v[72:73], v[80:81] op_sel:[1,1,0] op_sel_hi:[0,1,1] neg_lo:[1,0,0]
    v_pk_fma_f32 v[128:129], v[130:131], v[120:121], v[128:129] op_sel:[1,1,0] op_sel_hi:[0,1,1] neg_lo:[1,0,0]
    v_cvt_pk_bf16_f32 v24, v82, v83
    v_cvt_pk_bf16_f32 v25, v130, v131
    v_pk_mul_f32 v[92:93], v[74:75], v[74:75] op_sel_hi:[1,0]
    v_pk_mul_f32 v[140:141], v[122:123], v[122:123] op_sel_hi:[1,0]
    v_pk_fma_f32 v[92:93], v[74:75], v[74:75], v[92:93] op_sel:[1,1,0] op_sel_hi:[0,1,1] neg_lo:[1,0,0]
    v_pk_fma_f32 v[140:141], v[122:123], v[122:123], v[140:141] op_sel:[1,1,0] op_sel_hi:[0,1,1] neg_lo:[1,0,0]
    v_cvt_pk_bf16_f32 v26, v92, -v93
    v_cvt_pk_bf16_f32 v27, v140, -v141
    v_pk_mul_f32 v[86:87], v[84:85], v[70:71] op_sel_hi:[1,0]
    v_pk_mul_f32 v[134:135], v[132:133], v[118:119] op_sel_hi:[1,0]
    v_pk_fma_f32 v[86:87], v[84:85], v[70:71], v[86:87] op_sel:[1,1,0] op_sel_hi:[0,1,1] neg_lo:[1,0,0]
    v_pk_fma_f32 v[134:135], v[132:133], v[118:119], v[134:135] op_sel:[1,1,0] op_sel_hi:[0,1,1] neg_lo:[1,0,0]
    v_cvt_pk_bf16_f32 v32, v86, -v87
    v_cvt_pk_bf16_f32 v33, v134, -v135
    ds_write_b64 v4, v[42:43] offset:544
    ds_write_b64 v4, v[24:25] offset:9248
    ds_write_b64 v4, v[26:27] offset:21760
    ds_write_b64 v4, v[32:33] offset:19040
    v_pk_mul_f32 v[78:79], v[76:77], v[72:73] op_sel_hi:[1,0]
    v_pk_mul_f32 v[126:127], v[124:125], v[120:121] op_sel_hi:[1,0]
    v_pk_mul_f32 v[82:83], v[80:81], v[72:73] op_sel_hi:[1,0]
    v_pk_mul_f32 v[130:131], v[128:129], v[120:121] op_sel_hi:[1,0]
    v_cvt_pk_bf16_f32 v34, v76, v77
    v_cvt_pk_bf16_f32 v35, v124, v125
    v_pk_fma_f32 v[78:79], v[76:77], v[72:73], v[78:79] op_sel:[1,1,0] op_sel_hi:[0,1,1] neg_lo:[1,0,0]
    v_pk_fma_f32 v[126:127], v[124:125], v[120:121], v[126:127] op_sel:[1,1,0] op_sel_hi:[0,1,1] neg_lo:[1,0,0]
    v_pk_fma_f32 v[82:83], v[80:81], v[72:73], v[82:83] op_sel:[1,1,0] op_sel_hi:[0,1,1] neg_lo:[1,0,0]
    v_pk_fma_f32 v[130:131], v[128:129], v[120:121], v[130:131] op_sel:[1,1,0] op_sel_hi:[0,1,1] neg_lo:[1,0,0]
    v_cvt_pk_bf16_f32 v36, v80, v81
    v_cvt_pk_bf16_f32 v37, v128, v129
    v_pk_mul_f32 v[88:89], v[84:85], v[84:85] op_sel_hi:[1,0]
    v_pk_mul_f32 v[136:137], v[132:133], v[132:133] op_sel_hi:[1,0]
    v_pk_fma_f32 v[88:89], v[84:85], v[84:85], v[88:89] op_sel:[1,1,0] op_sel_hi:[0,1,1] neg_lo:[1,0,0]
    v_pk_fma_f32 v[136:137], v[132:133], v[132:133], v[136:137] op_sel:[1,1,0] op_sel_hi:[0,1,1] neg_lo:[1,0,0]
    v_cvt_pk_bf16_f32 v38, v88, -v89
    v_cvt_pk_bf16_f32 v39, v136, -v137
    v_pk_mul_f32 v[94:95], v[92:93], v[92:93] op_sel_hi:[1,0]
    v_pk_mul_f32 v[142:143], v[140:141], v[140:141] op_sel_hi:[1,0]
    v_pk_fma_f32 v[94:95], v[92:93], v[92:93], v[94:95] op_sel:[1,1,0] op_sel_hi:[0,1,1] neg_lo:[1,0,0]
    v_pk_fma_f32 v[142:143], v[140:141], v[140:141], v[142:143] op_sel:[1,1,0] op_sel_hi:[0,1,1] neg_lo:[1,0,0]
    v_cvt_pk_bf16_f32 v40, v94, -v95
    v_cvt_pk_bf16_f32 v41, v142, -v143
    ds_write_b64 v4, v[34:35] offset:1088
    ds_write_b64 v4, v[36:37] offset:9792
    ds_write_b64 v4, v[38:39] offset:19584
    ds_write_b64 v4, v[40:41] offset:23936
    buffer_load_dwordx2 v[210:211], v56, s[24:27], s56 offen offset:1152
    v_pk_mul_f32 v[76:77], v[78:79], v[72:73] op_sel_hi:[1,0]
    v_pk_mul_f32 v[124:125], v[126:127], v[120:121] op_sel_hi:[1,0]
    v_pk_mul_f32 v[80:81], v[82:83], v[72:73] op_sel_hi:[1,0]
    v_pk_mul_f32 v[128:129], v[130:131], v[120:121] op_sel_hi:[1,0]
    v_cvt_pk_bf16_f32 v42, v78, v79
    v_cvt_pk_bf16_f32 v43, v126, v127
    v_pk_fma_f32 v[76:77], v[78:79], v[72:73], v[76:77] op_sel:[1,1,0] op_sel_hi:[0,1,1] neg_lo:[1,0,0]
    v_pk_fma_f32 v[124:125], v[126:127], v[120:121], v[124:125] op_sel:[1,1,0] op_sel_hi:[0,1,1] neg_lo:[1,0,0]
    v_pk_fma_f32 v[80:81], v[82:83], v[72:73], v[80:81] op_sel:[1,1,0] op_sel_hi:[0,1,1] neg_lo:[1,0,0]
    v_pk_fma_f32 v[128:129], v[130:131], v[120:121], v[128:129] op_sel:[1,1,0] op_sel_hi:[0,1,1] neg_lo:[1,0,0]
    v_cvt_pk_bf16_f32 v24, v82, v83
    v_cvt_pk_bf16_f32 v25, v130, v131
    v_pk_mul_f32 v[100:101], v[88:89], v[70:71] op_sel_hi:[1,0]
    v_pk_mul_f32 v[148:149], v[136:137], v[118:119] op_sel_hi:[1,0]
    v_pk_fma_f32 v[100:101], v[88:89], v[70:71], v[100:101] op_sel:[1,1,0] op_sel_hi:[0,1,1] neg_lo:[1,0,0]
    v_pk_fma_f32 v[148:149], v[136:137], v[118:119], v[148:149] op_sel:[1,1,0] op_sel_hi:[0,1,1] neg_lo:[1,0,0]
    v_cvt_pk_bf16_f32 v26, v100, -v101
    v_cvt_pk_bf16_f32 v27, v148, -v149
    v_pk_mul_f32 v[90:91], v[88:89], v[84:85] op_sel_hi:[1,0]
    v_pk_mul_f32 v[138:139], v[136:137], v[132:133] op_sel_hi:[1,0]
    v_pk_fma_f32 v[90:91], v[88:89], v[84:85], v[90:91] op_sel:[1,1,0] op_sel_hi:[0,1,1] neg_lo:[1,0,0]
    v_pk_fma_f32 v[138:139], v[136:137], v[132:133], v[138:139] op_sel:[1,1,0] op_sel_hi:[0,1,1] neg_lo:[1,0,0]
    v_cvt_pk_bf16_f32 v32, v90, -v91
    v_cvt_pk_bf16_f32 v33, v138, -v139
    ds_write_b64 v4, v[42:43] offset:1632
    ds_write_b64 v4, v[24:25] offset:10336
    ds_write_b64 v4, v[26:27] offset:20128
    ds_write_b64 v4, v[32:33] offset:20672
    s_waitcnt vmcnt(2)
    v_cmp_ne_u32 vcc, 0, v31
    s_cbranch_vccz sequential_preLN__ssm_conv_s4__glu_gated_bilinear__prompt_kernel_tag1_s
sequential_preLN__ssm_conv_s4__glu_gated_bilinear__prompt_kernel_tag1_b:
    buffer_store_dwordx2 v[30:31], v197, s[28:31], s54 offen sc1
    v_pk_mul_f32 v[78:79], v[76:77], v[72:73] op_sel_hi:[1,0]
    v_pk_mul_f32 v[126:127], v[124:125], v[120:121] op_sel_hi:[1,0]
    v_pk_mul_f32 v[82:83], v[80:81], v[72:73] op_sel_hi:[1,0]
    v_pk_mul_f32 v[130:131], v[128:129], v[120:121] op_sel_hi:[1,0]
    v_cvt_pk_bf16_f32 v34, v76, v77
    v_cvt_pk_bf16_f32 v35, v124, v125
    v_pk_fma_f32 v[78:79], v[76:77], v[72:73], v[78:79] op_sel:[1,1,0] op_sel_hi:[0,1,1] neg_lo:[1,0,0]
    v_pk_fma_f32 v[126:127], v[124:125], v[120:121], v[126:127] op_sel:[1,1,0] op_sel_hi:[0,1,1] neg_lo:[1,0,0]
    v_pk_fma_f32 v[82:83], v[80:81], v[72:73], v[82:83] op_sel:[1,1,0] op_sel_hi:[0,1,1] neg_lo:[1,0,0]
    v_pk_fma_f32 v[130:131], v[128:129], v[120:121], v[130:131] op_sel:[1,1,0] op_sel_hi:[0,1,1] neg_lo:[1,0,0]
    v_cvt_pk_bf16_f32 v36, v80, v81
    v_cvt_pk_bf16_f32 v37, v128, v129
    v_pk_mul_f32 v[102:103], v[88:89], v[86:87] op_sel_hi:[1,0]
    v_pk_mul_f32 v[150:151], v[136:137], v[134:135] op_sel_hi:[1,0]
    v_pk_fma_f32 v[102:103], v[88:89], v[86:87], v[102:103] op_sel:[1,1,0] op_sel_hi:[0,1,1] neg_lo:[1,0,0]
    v_pk_fma_f32 v[150:151], v[136:137], v[134:135], v[150:151] op_sel:[1,1,0] op_sel_hi:[0,1,1] neg_lo:[1,0,0]
    v_cvt_pk_bf16_f32 v38, v102, -v103
    v_cvt_pk_bf16_f32 v39, v150, -v151
    ds_write_b64 v4, v[34:35] offset:2176
    ds_write_b64 v4, v[36:37] offset:10880
    ds_write_b64 v4, v[38:39] offset:21216
    buffer_load_dwordx2 v[212:213], v56, s[24:27], s56 offen offset:2304
    v_pk_mul_f32 v[76:77], v[78:79], v[72:73] op_sel_hi:[1,0]
    v_pk_mul_f32 v[124:125], v[126:127], v[120:121] op_sel_hi:[1,0]
    v_pk_mul_f32 v[80:81], v[82:83], v[72:73] op_sel_hi:[1,0]
    v_pk_mul_f32 v[128:129], v[130:131], v[120:121] op_sel_hi:[1,0]
    v_cvt_pk_bf16_f32 v40, v78, v79
    v_cvt_pk_bf16_f32 v41, v126, v127
    v_pk_fma_f32 v[76:77], v[78:79], v[72:73], v[76:77] op_sel:[1,1,0] op_sel_hi:[0,1,1] neg_lo:[1,0,0]
    v_pk_fma_f32 v[124:125], v[126:127], v[120:121], v[124:125] op_sel:[1,1,0] op_sel_hi:[0,1,1] neg_lo:[1,0,0]
    v_pk_fma_f32 v[80:81], v[82:83], v[72:73], v[80:81] op_sel:[1,1,0] op_sel_hi:[0,1,1] neg_lo:[1,0,0]
    v_pk_fma_f32 v[128:129], v[130:131], v[120:121], v[128:129] op_sel:[1,1,0] op_sel_hi:[0,1,1] neg_lo:[1,0,0]
    v_cvt_pk_bf16_f32 v42, v82, v83
    v_cvt_pk_bf16_f32 v43, v130, v131
    v_pk_mul_f32 v[100:101], v[92:93], v[84:85] op_sel_hi:[1,0]
    v_pk_mul_f32 v[148:149], v[140:141], v[132:133] op_sel_hi:[1,0]
    v_pk_fma_f32 v[100:101], v[92:93], v[84:85], v[100:101] op_sel:[1,1,0] op_sel_hi:[0,1,1] neg_lo:[1,0,0]
    v_pk_fma_f32 v[148:149], v[140:141], v[132:133], v[148:149] op_sel:[1,1,0] op_sel_hi:[0,1,1] neg_lo:[1,0,0]
    v_cvt_pk_bf16_f32 v24, v100, -v101
    v_cvt_pk_bf16_f32 v25, v148, -v149
    ds_write_b64 v4, v[40:41] offset:2720
    ds_write_b64 v4, v[42:43] offset:11424
    ds_write_b64 v4, v[24:25] offset:22304
    v_pk_mul_f32 v[78:79], v[76:77], v[72:73] op_sel_hi:[1,0]
    v_pk_mul_f32 v[126:127], v[124:125], v[120:121] op_sel_hi:[1,0]
    v_pk_mul_f32 v[82:83], v[80:81], v[72:73] op_sel_hi:[1,0]
    v_pk_mul_f32 v[130:131], v[128:129], v[120:121] op_sel_hi:[1,0]
    v_cvt_pk_bf16_f32 v26, v76, v77
    v_cvt_pk_bf16_f32 v27, v124, v125
    v_pk_fma_f32 v[78:79], v[76:77], v[72:73], v[78:79] op_sel:[1,1,0] op_sel_hi:[0,1,1] neg_lo:[1,0,0]
    v_pk_fma_f32 v[126:127], v[124:125], v[120:121], v[126:127] op_sel:[1,1,0] op_sel_hi:[0,1,1] neg_lo:[1,0,0]
    v_pk_fma_f32 v[82:83], v[80:81], v[72:73], v[82:83] op_sel:[1,1,0] op_sel_hi:[0,1,1] neg_lo:[1,0,0]
    v_pk_fma_f32 v[130:131], v[128:129], v[120:121], v[130:131] op_sel:[1,1,0] op_sel_hi:[0,1,1] neg_lo:[1,0,0]
    v_cvt_pk_bf16_f32 v32, v80, v81
    v_cvt_pk_bf16_f32 v33, v128, v129
    v_pk_mul_f32 v[102:103], v[92:93], v[88:89] op_sel_hi:[1,0]
    v_pk_mul_f32 v[150:151], v[140:141], v[136:137] op_sel_hi:[1,0]
    v_pk_fma_f32 v[102:103], v[92:93], v[88:89], v[102:103] op_sel:[1,1,0] op_sel_hi:[0,1,1] neg_lo:[1,0,0]
    v_pk_fma_f32 v[150:151], v[140:141], v[136:137], v[150:151] op_sel:[1,1,0] op_sel_hi:[0,1,1] neg_lo:[1,0,0]
    v_cvt_pk_bf16_f32 v34, v102, -v103
    v_cvt_pk_bf16_f32 v35, v150, -v151
    ds_write_b64 v4, v[26:27] offset:3264
    ds_write_b64 v4, v[32:33] offset:11968
    ds_write_b64 v4, v[34:35] offset:22848
    v_pk_mul_f32 v[76:77], v[78:79], v[72:73] op_sel_hi:[1,0]
    v_pk_mul_f32 v[124:125], v[126:127], v[120:121] op_sel_hi:[1,0]
    v_pk_mul_f32 v[80:81], v[82:83], v[72:73] op_sel_hi:[1,0]
    v_pk_mul_f32 v[128:129], v[130:131], v[120:121] op_sel_hi:[1,0]
    v_cvt_pk_bf16_f32 v36, v78, v79
    v_cvt_pk_bf16_f32 v37, v126, v127
    v_pk_fma_f32 v[76:77], v[78:79], v[72:73], v[76:77] op_sel:[1,1,0] op_sel_hi:[0,1,1] neg_lo:[1,0,0]
    v_pk_fma_f32 v[124:125], v[126:127], v[120:121], v[124:125] op_sel:[1,1,0] op_sel_hi:[0,1,1] neg_lo:[1,0,0]
    v_pk_fma_f32 v[80:81], v[82:83], v[72:73], v[80:81] op_sel:[1,1,0] op_sel_hi:[0,1,1] neg_lo:[1,0,0]
    v_pk_fma_f32 v[128:129], v[130:131], v[120:121], v[128:129] op_sel:[1,1,0] op_sel_hi:[0,1,1] neg_lo:[1,0,0]
    v_cvt_pk_bf16_f32 v38, v82, v83
    v_cvt_pk_bf16_f32 v39, v130, v131
    v_pk_mul_f32 v[100:101], v[92:93], v[90:91] op_sel_hi:[1,0]
    v_pk_mul_f32 v[148:149], v[140:141], v[138:139] op_sel_hi:[1,0]
    v_pk_fma_f32 v[100:101], v[92:93], v[90:91], v[100:101] op_sel:[1,1,0] op_sel_hi:[0,1,1] neg_lo:[1,0,0]
    v_pk_fma_f32 v[148:149], v[140:141], v[138:139], v[148:149] op_sel:[1,1,0] op_sel_hi:[0,1,1] neg_lo:[1,0,0]
    v_cvt_pk_bf16_f32 v40, v100, -v101
    v_cvt_pk_bf16_f32 v41, v148, -v149
    ds_write_b64 v4, v[36:37] offset:3808
    ds_write_b64 v4, v[38:39] offset:12512
    ds_write_b64 v4, v[40:41] offset:23392
    buffer_load_dwordx2 v[214:215], v56, s[24:27], s56 offen offset:3456
    v_pk_mul_f32 v[78:79], v[76:77], v[72:73] op_sel_hi:[1,0]
    v_pk_mul_f32 v[126:127], v[124:125], v[120:121] op_sel_hi:[1,0]
    v_pk_mul_f32 v[82:83], v[80:81], v[72:73] op_sel_hi:[1,0]
    v_pk_mul_f32 v[130:131], v[128:129], v[120:121] op_sel_hi:[1,0]
    v_cvt_pk_bf16_f32 v42, v76, v77
    v_cvt_pk_bf16_f32 v43, v124, v125
    v_pk_fma_f32 v[78:79], v[76:77], v[72:73], v[78:79] op_sel:[1,1,0] op_sel_hi:[0,1,1] neg_lo:[1,0,0]
    v_pk_fma_f32 v[126:127], v[124:125], v[120:121], v[126:127] op_sel:[1,1,0] op_sel_hi:[0,1,1] neg_lo:[1,0,0]
    v_pk_fma_f32 v[82:83], v[80:81], v[72:73], v[82:83] op_sel:[1,1,0] op_sel_hi:[0,1,1] neg_lo:[1,0,0]
    v_pk_fma_f32 v[130:131], v[128:129], v[120:121], v[130:131] op_sel:[1,1,0] op_sel_hi:[0,1,1] neg_lo:[1,0,0]
    v_cvt_pk_bf16_f32 v24, v80, v81
    v_cvt_pk_bf16_f32 v25, v128, v129
sequential_preLN__ssm_conv_s4__glu_gated_bilinear__prompt_kernel_c_h0:
    s_cbranch_execz sequential_preLN__ssm_conv_s4__glu_gated_bilinear__prompt_kernel_c_h0_1
    v_pk_mul_f32 v[102:103], v[94:95], v[88:89] op_sel_hi:[1,0]
    v_pk_mul_f32 v[150:151], v[142:143], v[136:137] op_sel_hi:[1,0]
    v_pk_fma_f32 v[102:103], v[94:95], v[88:89], v[102:103] op_sel:[1,1,0] op_sel_hi:[0,1,1] neg_lo:[1,0,0]
    v_pk_fma_f32 v[150:151], v[142:143], v[136:137], v[150:151] op_sel:[1,1,0] op_sel_hi:[0,1,1] neg_lo:[1,0,0]
    v_cvt_pk_bf16_f32 v26, v102, -v103
    v_cvt_pk_bf16_f32 v27, v150, -v151
    ds_write_b64 v4, v[42:43] offset:4352
    ds_write_b64 v4, v[24:25] offset:13056
    ds_write_b64 v4, v[26:27] offset:24480
    v_pk_mul_f32 v[76:77], v[78:79], v[72:73] op_sel_hi:[1,0]
    v_pk_mul_f32 v[124:125], v[126:127], v[120:121] op_sel_hi:[1,0]
    v_pk_mul_f32 v[80:81], v[82:83], v[72:73] op_sel_hi:[1,0]
    v_pk_mul_f32 v[128:129], v[130:131], v[120:121] op_sel_hi:[1,0]
    v_cvt_pk_bf16_f32 v32, v78, v79
    v_cvt_pk_bf16_f32 v33, v126, v127
    v_pk_fma_f32 v[76:77], v[78:79], v[72:73], v[76:77] op_sel:[1,1,0] op_sel_hi:[0,1,1] neg_lo:[1,0,0]
    v_pk_fma_f32 v[124:125], v[126:127], v[120:121], v[124:125] op_sel:[1,1,0] op_sel_hi:[0,1,1] neg_lo:[1,0,0]
    v_pk_fma_f32 v[80:81], v[82:83], v[72:73], v[80:81] op_sel:[1,1,0] op_sel_hi:[0,1,1] neg_lo:[1,0,0]
    v_pk_fma_f32 v[128:129], v[130:131], v[120:121], v[128:129] op_sel:[1,1,0] op_sel_hi:[0,1,1] neg_lo:[1,0,0]
    v_cvt_pk_bf16_f32 v34, v82, v83
    v_cvt_pk_bf16_f32 v35, v130, v131
    v_pk_mul_f32 v[96:97], v[94:95], v[92:93] op_sel_hi:[1,0]
    v_pk_mul_f32 v[144:145], v[142:143], v[140:141] op_sel_hi:[1,0]
    v_pk_fma_f32 v[96:97], v[94:95], v[92:93], v[96:97] op_sel:[1,1,0] op_sel_hi:[0,1,1] neg_lo:[1,0,0]
    v_pk_fma_f32 v[144:145], v[142:143], v[140:141], v[144:145] op_sel:[1,1,0] op_sel_hi:[0,1,1] neg_lo:[1,0,0]
    v_cvt_pk_bf16_f32 v36, v96, -v97
    v_cvt_pk_bf16_f32 v37, v144, -v145
    ds_write_b64 v4, v[32:33] offset:4896
    ds_write_b64 v4, v[34:35] offset:13600
    ds_write_b64 v4, v[36:37] offset:25024
    v_pk_mul_f32 v[78:79], v[76:77], v[72:73] op_sel_hi:[1,0]
    v_pk_mul_f32 v[126:127], v[124:125], v[120:121] op_sel_hi:[1,0]
    v_pk_mul_f32 v[82:83], v[80:81], v[72:73] op_sel_hi:[1,0]
    v_pk_mul_f32 v[130:131], v[128:129], v[120:121] op_sel_hi:[1,0]
    v_cvt_pk_bf16_f32 v38, v76, v77
    v_cvt_pk_bf16_f32 v39, v124, v125
    v_pk_fma_f32 v[78:79], v[76:77], v[72:73], v[78:79] op_sel:[1,1,0] op_sel_hi:[0,1,1] neg_lo:[1,0,0]
    v_pk_fma_f32 v[126:127], v[124:125], v[120:121], v[126:127] op_sel:[1,1,0] op_sel_hi:[0,1,1] neg_lo:[1,0,0]
    v_pk_fma_f32 v[82:83], v[80:81], v[72:73], v[82:83] op_sel:[1,1,0] op_sel_hi:[0,1,1] neg_lo:[1,0,0]
sequential_preLN__ssm_conv_s4__glu_gated_bilinear__prompt_kernel_c_h0_1:
    s_cbranch_execz sequential_preLN__ssm_conv_s4__glu_gated_bilinear__prompt_kernel_c_h0_2
    v_pk_fma_f32 v[130:131], v[128:129], v[120:121], v[130:131] op_sel:[1,1,0] op_sel_hi:[0,1,1] neg_lo:[1,0,0]
    v_cvt_pk_bf16_f32 v40, v80, v81
    v_cvt_pk_bf16_f32 v41, v128, v129
    v_pk_mul_f32 v[98:99], v[94:95], v[94:95] op_sel_hi:[1,0]
    v_pk_mul_f32 v[146:147], v[142:143], v[142:143] op_sel_hi:[1,0]
    v_pk_fma_f32 v[98:99], v[94:95], v[94:95], v[98:99] op_sel:[1,1,0] op_sel_hi:[0,1,1] neg_lo:[1,0,0]
    v_pk_fma_f32 v[146:147], v[142:143], v[142:143], v[146:147] op_sel:[1,1,0] op_sel_hi:[0,1,1] neg_lo:[1,0,0]
    v_cvt_pk_bf16_f32 v42, v98, -v99
    v_cvt_pk_bf16_f32 v43, v146, -v147
    ds_write_b64 v4, v[38:39] offset:5440
    ds_write_b64 v4, v[40:41] offset:14144
    ds_write_b64 v4, v[42:43] offset:26112
    buffer_load_dwordx2 v[216:217], v56, s[24:27], s57 offen offset:0
    v_pk_mul_f32 v[76:77], v[78:79], v[72:73] op_sel_hi:[1,0]
    v_pk_mul_f32 v[124:125], v[126:127], v[120:121] op_sel_hi:[1,0]
    v_pk_mul_f32 v[80:81], v[82:83], v[72:73] op_sel_hi:[1,0]
    v_pk_mul_f32 v[128:129], v[130:131], v[120:121] op_sel_hi:[1,0]
    v_cvt_pk_bf16_f32 v24, v78, v79
    v_cvt_pk_bf16_f32 v25, v126, v127
    v_pk_fma_f32 v[76:77], v[78:79], v[72:73], v[76:77] op_sel:[1,1,0] op_sel_hi:[0,1,1] neg_lo:[1,0,0]
    v_pk_fma_f32 v[124:125], v[126:127], v[120:121], v[124:125] op_sel:[1,1,0] op_sel_hi:[0,1,1] neg_lo:[1,0,0]
    v_pk_fma_f32 v[80:81], v[82:83], v[72:73], v[80:81] op_sel:[1,1,0] op_sel_hi:[0,1,1] neg_lo:[1,0,0]
    v_pk_fma_f32 v[128:129], v[130:131], v[120:121], v[128:129] op_sel:[1,1,0] op_sel_hi:[0,1,1] neg_lo:[1,0,0]
    v_cvt_pk_bf16_f32 v26, v82, v83
    v_cvt_pk_bf16_f32 v27, v130, v131
    v_pk_mul_f32 v[100:101], v[96:97], v[88:89] op_sel_hi:[1,0]
    v_pk_mul_f32 v[148:149], v[144:145], v[136:137] op_sel_hi:[1,0]
    v_pk_fma_f32 v[100:101], v[96:97], v[88:89], v[100:101] op_sel:[1,1,0] op_sel_hi:[0,1,1] neg_lo:[1,0,0]
    v_pk_fma_f32 v[148:149], v[144:145], v[136:137], v[148:149] op_sel:[1,1,0] op_sel_hi:[0,1,1] neg_lo:[1,0,0]
    v_cvt_pk_bf16_f32 v32, v100, -v101
    v_cvt_pk_bf16_f32 v33, v148, -v149
    ds_write_b64 v4, v[24:25] offset:5984
    ds_write_b64 v4, v[26:27] offset:14688
    ds_write_b64 v4, v[32:33] offset:25568
    v_pk_mul_f32 v[78:79], v[76:77], v[72:73] op_sel_hi:[1,0]
    v_pk_mul_f32 v[126:127], v[124:125], v[120:121] op_sel_hi:[1,0]
    v_pk_mul_f32 v[82:83], v[80:81], v[72:73] op_sel_hi:[1,0]
    v_pk_mul_f32 v[130:131], v[128:129], v[120:121] op_sel_hi:[1,0]
    v_cvt_pk_bf16_f32 v34, v76, v77
    v_cvt_pk_bf16_f32 v35, v124, v125
sequential_preLN__ssm_conv_s4__glu_gated_bilinear__prompt_kernel_c_h0_2:
    s_cbranch_execz sequential_preLN__ssm_conv_s4__glu_gated_bilinear__prompt_kernel_c_ret
    v_pk_fma_f32 v[78:79], v[76:77], v[72:73], v[78:79] op_sel:[1,1,0] op_sel_hi:[0,1,1] neg_lo:[1,0,0]
    v_pk_fma_f32 v[126:127], v[124:125], v[120:121], v[126:127] op_sel:[1,1,0] op_sel_hi:[0,1,1] neg_lo:[1,0,0]
    v_pk_fma_f32 v[82:83], v[80:81], v[72:73], v[82:83] op_sel:[1,1,0] op_sel_hi:[0,1,1] neg_lo:[1,0,0]
    v_pk_fma_f32 v[130:131], v[128:129], v[120:121], v[130:131] op_sel:[1,1,0] op_sel_hi:[0,1,1] neg_lo:[1,0,0]
    v_cvt_pk_bf16_f32 v36, v80, v81
    v_cvt_pk_bf16_f32 v37, v128, v129
    v_pk_mul_f32 v[102:103], v[98:99], v[92:93] op_sel_hi:[1,0]
    v_pk_mul_f32 v[150:151], v[146:147], v[140:141] op_sel_hi:[1,0]
    v_pk_fma_f32 v[102:103], v[98:99], v[92:93], v[102:103] op_sel:[1,1,0] op_sel_hi:[0,1,1] neg_lo:[1,0,0]
    v_pk_fma_f32 v[150:151], v[146:147], v[140:141], v[150:151] op_sel:[1,1,0] op_sel_hi:[0,1,1] neg_lo:[1,0,0]
    v_cvt_pk_bf16_f32 v38, v102, -v103
    v_cvt_pk_bf16_f32 v39, v150, -v151
    ds_write_b64 v4, v[34:35] offset:6528
    ds_write_b64 v4, v[36:37] offset:15232
    ds_write_b64 v4, v[38:39] offset:26656
    v_pk_mul_f32 v[76:77], v[78:79], v[72:73] op_sel_hi:[1,0]
    v_pk_mul_f32 v[124:125], v[126:127], v[120:121] op_sel_hi:[1,0]
    v_pk_mul_f32 v[80:81], v[82:83], v[72:73] op_sel_hi:[1,0]
    v_pk_mul_f32 v[128:129], v[130:131], v[120:121] op_sel_hi:[1,0]
    v_cvt_pk_bf16_f32 v40, v78, v79
    v_cvt_pk_bf16_f32 v41, v126, v127
    v_pk_fma_f32 v[76:77], v[78:79], v[72:73], v[76:77] op_sel:[1,1,0] op_sel_hi:[0,1,1] neg_lo:[1,0,0]
    v_pk_fma_f32 v[124:125], v[126:127], v[120:121], v[124:125] op_sel:[1,1,0] op_sel_hi:[0,1,1] neg_lo:[1,0,0]
    v_pk_fma_f32 v[80:81], v[82:83], v[72:73], v[80:81] op_sel:[1,1,0] op_sel_hi:[0,1,1] neg_lo:[1,0,0]
    v_pk_fma_f32 v[128:129], v[130:131], v[120:121], v[128:129] op_sel:[1,1,0] op_sel_hi:[0,1,1] neg_lo:[1,0,0]
    v_cvt_pk_bf16_f32 v42, v82, v83
    v_cvt_pk_bf16_f32 v43, v130, v131
    v_pk_mul_f32 v[100:101], v[98:99], v[94:95] op_sel_hi:[1,0]
    v_pk_mul_f32 v[148:149], v[146:147], v[142:143] op_sel_hi:[1,0]
    v_pk_fma_f32 v[100:101], v[98:99], v[94:95], v[100:101] op_sel:[1,1,0] op_sel_hi:[0,1,1] neg_lo:[1,0,0]
    v_pk_fma_f32 v[148:149], v[146:147], v[142:143], v[148:149] op_sel:[1,1,0] op_sel_hi:[0,1,1] neg_lo:[1,0,0]
    v_cvt_pk_bf16_f32 v24, v100, -v101
    v_cvt_pk_bf16_f32 v25, v148, -v149
    ds_write_b64 v4, v[40:41] offset:7072
    ds_write_b64 v4, v[42:43] offset:15776
    ds_write_b64 v4, v[24:25] offset:27200
    buffer_load_dwordx2 v[218:219], v56, s[24:27], s57 offen offset:1152
    v_pk_mul_f32 v[78:79], v[76:77], v[72:73] op_sel_hi:[1,0]
    v_pk_mul_f32 v[126:127], v[124:125], v[120:121] op_sel_hi:[1,0]
    v_pk_mul_f32 v[82:83], v[80:81], v[72:73] op_sel_hi:[1,0]
    v_pk_mul_f32 v[130:131], v[128:129], v[120:121] op_sel_hi:[1,0]
    v_cvt_pk_bf16_f32 v26, v76, v77
    v_cvt_pk_bf16_f32 v27, v124, v125
    v_pk_fma_f32 v[78:79], v[76:77], v[72:73], v[78:79] op_sel:[1,1,0] op_sel_hi:[0,1,1] neg_lo:[1,0,0]
    v_pk_fma_f32 v[126:127], v[124:125], v[120:121], v[126:127] op_sel:[1,1,0] op_sel_hi:[0,1,1] neg_lo:[1,0,0]
    v_pk_fma_f32 v[82:83], v[80:81], v[72:73], v[82:83] op_sel:[1,1,0] op_sel_hi:[0,1,1] neg_lo:[1,0,0]
    v_pk_fma_f32 v[130:131], v[128:129], v[120:121], v[130:131] op_sel:[1,1,0] op_sel_hi:[0,1,1] neg_lo:[1,0,0]
    v_cvt_pk_bf16_f32 v32, v80, v81
    v_cvt_pk_bf16_f32 v33, v128, v129
    v_pk_mul_f32 v[102:103], v[98:99], v[96:97] op_sel_hi:[1,0]
    v_pk_mul_f32 v[150:151], v[146:147], v[144:145] op_sel_hi:[1,0]
    v_pk_fma_f32 v[102:103], v[98:99], v[96:97], v[102:103] op_sel:[1,1,0] op_sel_hi:[0,1,1] neg_lo:[1,0,0]
    v_pk_fma_f32 v[150:151], v[146:147], v[144:145], v[150:151] op_sel:[1,1,0] op_sel_hi:[0,1,1] neg_lo:[1,0,0]
    v_cvt_pk_bf16_f32 v34, v102, -v103
    v_cvt_pk_bf16_f32 v35, v150, -v151
    ds_write_b64 v4, v[26:27] offset:7616
    ds_write_b64 v4, v[32:33] offset:16320
    ds_write_b64 v4, v[34:35] offset:27744
    v_cvt_pk_bf16_f32 v36, v78, v79
    v_cvt_pk_bf16_f32 v37, v126, v127
    v_cvt_pk_bf16_f32 v38, v82, v83
    v_cvt_pk_bf16_f32 v39, v130, v131
    v_pk_mul_f32 v[100:101], v[98:99], v[98:99] op_sel_hi:[1,0]
    v_pk_mul_f32 v[148:149], v[146:147], v[146:147] op_sel_hi:[1,0]
    v_pk_fma_f32 v[100:101], v[98:99], v[98:99], v[100:101] op_sel:[1,1,0] op_sel_hi:[0,1,1] neg_lo:[1,0,0]
    v_pk_fma_f32 v[148:149], v[146:147], v[146:147], v[148:149] op_sel:[1,1,0] op_sel_hi:[0,1,1] neg_lo:[1,0,0]
    v_cvt_pk_bf16_f32 v40, v100, -v101
    v_cvt_pk_bf16_f32 v41, v148, -v149
    ds_write_b64 v4, v[36:37] offset:8160
    ds_write_b64 v4, v[38:39] offset:16864
    ds_write_b64 v4, v[40:41] offset:28288
    ds_read_b128 a[128:131], v5 offset:0
    ds_read_b128 a[132:135], v5 offset:17408
    ds_read_b128 a[136:139], v5 offset:8704
    ds_read_b128 a[140:143], v6 offset:26112
    ds_read_b128 a[144:147], v5 offset:64
    ds_read_b128 a[148:151], v5 offset:17472
    ds_read_b128 a[152:155], v5 offset:8768
    ds_read_b128 a[156:159], v6 offset:26176
    ds_read_b128 a[160:163], v5 offset:128
    ds_read_b128 a[164:167], v5 offset:17536
    ds_read_b128 a[168:171], v5 offset:8832
    ds_read_b128 a[172:175], v6 offset:26240
    s_waitcnt lgkmcnt(8)
    v_mfma_f32_16x16x32_bf16 v[32:35], a[132:135], a[128:131], 0
    ds_read_b128 a[176:179], v5 offset:192
    v_mov_b32 v30, 0x3f80
    v_mfma_f32_16x16x32_bf16 v[36:39], a[132:135], a[136:139], 0
    ds_read_b128 a[180:183], v5 offset:17600
    v_cndmask_b32 v30, v207, v30, s[66:67]
    v_mfma_f32_16x16x32_bf16 v[44:47], a[140:143], a[136:139], 0
    ds_read_b128 a[184:187], v5 offset:8896
    v_mul_u32_u24 v240, v30, v240
    v_mfma_f32_16x16x32_bf16 v[40:43], a[140:143], a[128:131], 0
    ds_read_b128 a[188:191], v6 offset:26304
    v_accvgpr_write_b32 a28, v240
    s_waitcnt lgkmcnt(8)
    v_mfma_f32_16x16x32_bf16 v[32:35], a[148:151], a[144:147], v[32:35]
    ds_read_b128 a[192:195], v5 offset:256
    v_mul_u32_u24 v241, v30, v241
    v_mfma_f32_16x16x32_bf16 v[36:39], a[148:151], a[152:155], v[36:39]
    ds_read_b128 a[196:199], v5 offset:17664
    v_accvgpr_write_b32 a29, v241
    v_mfma_f32_16x16x32_bf16 v[44:47], a[156:159], a[152:155], v[44:47]
    ds_read_b128 a[200:203], v5 offset:8960
    v_mul_u32_u24 v242, v30, v242
    v_mfma_f32_16x16x32_bf16 v[40:43], a[156:159], a[144:147], v[40:43]
    ds_read_b128 a[204:207], v6 offset:26368
    v_accvgpr_write_b32 a30, v242
    buffer_load_dwordx2 v[220:221], v56, s[24:27], s57 offen offset:2304
    s_waitcnt lgkmcnt(8)
    v_mfma_f32_16x16x32_bf16 v[32:35], a[164:167], a[160:163], v[32:35]
    ds_read_b128 a[208:211], v5 offset:320
    v_mul_u32_u24 v243, v30, v243
    v_mfma_f32_16x16x32_bf16 v[36:39], a[164:167], a[168:171], v[36:39]
    ds_read_b128 a[212:215], v5 offset:17728
    v_accvgpr_write_b32 a31, v243
    v_mfma_f32_16x16x32_bf16 v[44:47], a[172:175], a[168:171], v[44:47]
    ds_read_b128 a[216:219], v5 offset:9024
    s_waitcnt vmcnt(7)
    v_mfma_f32_16x16x32_bf16 v[40:43], a[172:175], a[160:163], v[40:43]
    ds_read_b128 a[220:223], v6 offset:26432
    v_lshlrev_b32 v160, 16, v208
    s_waitcnt lgkmcnt(8)
    v_mfma_f32_16x16x32_bf16 v[32:35], a[180:183], a[176:179], v[32:35]
    ds_read_b128 a[224:227], v5 offset:384
    v_and_b32 v161, s7, v208
    v_mfma_f32_16x16x32_bf16 v[36:39], a[180:183], a[184:187], v[36:39]
    ds_read_b128 a[228:231], v5 offset:17792
    v_lshlrev_b32 v162, 16, v209
    v_mfma_f32_16x16x32_bf16 v[44:47], a[188:191], a[184:187], v[44:47]
    ds_read_b128 a[232:235], v5 offset:9088
    v_and_b32 v163, s7, v209
    v_mfma_f32_16x16x32_bf16 v[40:43], a[188:191], a[176:179], v[40:43]
    ds_read_b128 a[236:239], v6 offset:26496
    s_waitcnt vmcnt(6)
    s_waitcnt lgkmcnt(8)
    v_mfma_f32_16x16x32_bf16 v[32:35], a[196:199], a[192:195], v[32:35]
    ds_read_b128 a[240:243], v5 offset:448
    v_lshlrev_b32 v164, 16, v210
    v_mfma_f32_16x16x32_bf16 v[36:39], a[196:199], a[200:203], v[36:39]
    ds_read_b128 a[244:247], v5 offset:17856
    v_and_b32 v165, s7, v210
    v_mfma_f32_16x16x32_bf16 v[44:47], a[204:207], a[200:203], v[44:47]
    ds_read_b128 a[248:251], v5 offset:9152
    v_lshlrev_b32 v166, 16, v211
    v_mfma_f32_16x16x32_bf16 v[40:43], a[204:207], a[192:195], v[40:43]
    ds_read_b128 a[252:255], v6 offset:26560
    v_and_b32 v167, s7, v211
    s_waitcnt lgkmcnt(8)
    v_mfma_f32_16x16x32_bf16 v[32:35], a[212:215], a[208:211], v[32:35]
    v_perm_b32 v96, v210, v208, s75
    v_mfma_f32_16x16x32_bf16 v[36:39], a[212:215], a[216:219], v[36:39]
    v_perm_b32 v100, v210, v208, s76
    v_mfma_f32_16x16x32_bf16 v[44:47], a[220:223], a[216:219], v[44:47]
    v_perm_b32 v104, v211, v209, s75
    v_mfma_f32_16x16x32_bf16 v[40:43], a[220:223], a[208:211], v[40:43]
    v_perm_b32 v108, v211, v209, s76
    buffer_load_dwordx2 v[222:223], v56, s[24:27], s57 offen offset:3456
    s_waitcnt lgkmcnt(4)
    v_mfma_f32_16x16x32_bf16 v[32:35], a[228:231], a[224:227], v[32:35]
    s_waitcnt vmcnt(5)
    v_mfma_f32_16x16x32_bf16 v[36:39], a[228:231], a[232:235], v[36:39]
    v_lshlrev_b32 v168, 16, v212
    v_mfma_f32_16x16x32_bf16 v[44:47], a[236:239], a[232:235], v[44:47]
    v_and_b32 v169, s7, v212
    v_mfma_f32_16x16x32_bf16 v[40:43], a[236:239], a[224:227], v[40:43]
    v_lshlrev_b32 v170, 16, v213
    s_waitcnt lgkmcnt(0)
    v_mfma_f32_16x16x32_bf16 v[32:35], a[244:247], a[240:243], v[32:35]
    v_and_b32 v171, s7, v213
    v_mfma_f32_16x16x32_bf16 v[36:39], a[244:247], a[248:251], v[36:39]
    s_waitcnt vmcnt(4)
    v_mfma_f32_16x16x32_bf16 v[44:47], a[252:255], a[248:251], v[44:47]
    v_lshlrev_b32 v172, 16, v214
    v_mfma_f32_16x16x32_bf16 v[40:43], a[252:255], a[240:243], v[40:43]
    v_and_b32 v173, s7, v214
    buffer_load_dwordx4 v[224:227], v57, s[28:31], 0 offen offset:0 sc1
    buffer_load_dwordx4 v[228:231], v57, s[28:31], 0 offen offset:1024 sc1
    buffer_load_dwordx4 v[232:235], v57, s[28:31], 0 offen offset:2048 sc1
    buffer_load_dwordx4 v[236:239], v57, s[28:31], 0 offen offset:3072 sc1
    v_lshlrev_b32 v174, 16, v215
    v_and_b32 v175, s7, v215
    v_perm_b32 v97, v214, v212, s75
    v_perm_b32 v101, v214, v212, s76
    v_perm_b32 v105, v215, v213, s75
    v_cvt_pk_bf16_f32 v64, v32, v33
    v_cvt_pk_bf16_f32 v65, v34, v35
    ds_write_b32 v7, v64
    ds_write_b32 v8, v65
    v_cvt_pk_bf16_f32 v68, v36, v37
    v_cvt_pk_bf16_f32 v69, v38, v39
    ds_write_b32 v10, v68
    ds_write_b32 v11, v69
    v_cvt_pk_bf16_f32 v70, v44, v45
    v_cvt_pk_bf16_f32 v71, v46, v47
    ds_write_b16 v9, v70 offset:1056
    ds_write_b16_d16_hi v9, v70 offset:1120
    ds_write_b16 v9, v71 offset:1184
    ds_write_b16_d16_hi v9, v71 offset:1248
    v_cvt_pk_bf16_f32 v66, v40, v41
    v_cvt_pk_bf16_f32 v67, v42, v43
    ds_write_b16 v9, v66 offset:1024
    ds_write_b16_d16_hi v9, v66 offset:1088
    ds_write_b16 v9, v67 offset:1152
    ds_write_b16_d16_hi v9, v67 offset:1216
    ds_read2_b32 v[192:193], v53 offset0:3 offset1:2
    ds_read2_b32 v[194:195], v53 offset0:1 offset1:0
    ds_read2_b32 a[80:81], v53 offset0:19 offset1:18
    ds_read2_b32 a[82:83], v53 offset0:17 offset1:16
    ds_read2_b32 a[84:85], v53 offset0:35 offset1:34
    ds_read2_b32 a[86:87], v53 offset0:33 offset1:32
    ds_read2_b32 a[88:89], v53 offset0:51 offset1:50
    ds_read2_b32 a[90:91], v53 offset0:49 offset1:48
    ds_read_b32 v32, v63 offset:1024
    ds_read2_b32 v[36:37], v54 offset0:0 offset1:1
    ds_read_b32 v38, v55
    ds_read_b64 v[40:41], v55 offset:4
    ds_read_b64 v[42:43], v55 offset:12
    s_waitcnt lgkmcnt(0)
    s_barrier
    v_perm_b32 v64, v32, v32, v51
    v_perm_b32 v65, v32, v32, v52
    v_perm_b32 v66, v32, v32, v196
    v_mov_b32 v67, v66
    s_mov_b64 exec, 0xffff
    ds_write_b128 v28, v[64:67] offset:1984
    s_mov_b64 exec, -1
    v_cndmask_b32 v192, 0, v192, s[58:59]
    v_cndmask_b32 v193, 0, v193, s[60:61]
    v_cndmask_b32 v194, 0, v194, s[62:63]
    v_cndmask_b32 v195, 0, v195, s[64:65]
    v_perm_b32 v80, v37, v37, s70
    v_perm_b32 v81, v36, v36, s71
    v_perm_b32 v82, v36, v36, s72
    v_perm_b32 v83, v36, v36, s70
    ds_write_b128 v23, v[80:83] offset:6208
    v_perm_b32 v109, v215, v213, s76
    s_waitcnt vmcnt(7)
    v_lshlrev_b32 v176, 16, v216
    v_and_b32 v177, s7, v216
    v_lshlrev_b32 v178, 16, v217
    v_and_b32 v179, s7, v217
    s_waitcnt vmcnt(6)
    v_lshlrev_b32 v180, 16, v218
    v_and_b32 v181, s7, v218
    v_lshlrev_b32 v182, 16, v219
    v_perm_b32 v84, v37, v36, s73
    v_mov_b32 v85, v81
    v_mov_b32 v86, v83
    v_mov_b32 v87, v83
    ds_write_b128 v23, v[84:87] offset:2048
    v_and_b32 v183, s7, v219
    v_perm_b32 v98, v218, v216, s75
    v_perm_b32 v102, v218, v216, s76
    v_perm_b32 v106, v219, v217, s75
    v_perm_b32 v110, v219, v217, s76
    s_waitcnt vmcnt(5)
    v_lshlrev_b32 v184, 16, v220
    v_and_b32 v185, s7, v220
    v_lshlrev_b32 v186, 16, v221
    v_and_b32 v187, s7, v221
    v_cndmask_b32 v43, v43, v42, s[68:69]
    v_perm_b32 v88, v43, v41, v48
    v_perm_b32 v89, v42, v41, v49
    v_perm_b32 v90, v41, v40, v48
    v_perm_b32 v91, v40, v40, v49
    ds_write_b128 v23, v[88:91] offset:7232
    s_waitcnt vmcnt(4)
    v_lshlrev_b32 v188, 16, v222
    v_and_b32 v189, s7, v222
    v_lshlrev_b32 v190, 16, v223
    v_and_b32 v191, s7, v223
    v_perm_b32 v99, v222, v220, s75
    v_perm_b32 v103, v222, v220, s76
    v_perm_b32 v107, v223, v221, s75
    v_perm_b32 v111, v223, v221, s76
    v_alignbit_b32 v92, v89, v88, 16
    v_alignbit_b32 v93, v90, v89, 16
    v_alignbit_b32 v94, v91, v90, 16
    v_perm_b32 v95, v38, v40, v50
    ds_write_b128 v23, v[92:95] offset:3072
    ds_read2_b32 a[0:1], v12 offset0:240 offset1:241
    ds_read2_b32 a[2:3], v12 offset0:242 offset1:243
    ds_read2_b32 a[4:5], v12 offset0:112 offset1:113
    ds_read2_b32 a[6:7], v12 offset0:114 offset1:115
    ds_read2_b32 a[8:9], v13 offset0:240 offset1:241
    ds_read2_b32 a[10:11], v13 offset0:242 offset1:243
    ds_read2_b32 a[12:13], v13 offset0:112 offset1:113
    ds_read2_b32 a[14:15], v13 offset0:114 offset1:115
    ds_read2_b32 a[16:17], v14 offset0:240 offset1:241
    ds_read2_b32 a[18:19], v14 offset0:242 offset1:243
    s_mov_b32 s74, 0x100000
sequential_preLN__ssm_conv_s4__glu_gated_bilinear__prompt_kernel_chk:
    s_waitcnt vmcnt(0)
    v_xor_b32 v44, v225, v31
    v_xor_b32 v45, v227, v31
    v_bitop3_b32 v44, v229, v31, v44 bitop3:0xbe
    v_bitop3_b32 v45, v231, v31, v45 bitop3:0xbe
    v_bitop3_b32 v44, v233, v31, v44 bitop3:0xbe
    v_bitop3_b32 v45, v235, v31, v45 bitop3:0xbe
    v_bitop3_b32 v44, v237, v31, v44 bitop3:0xbe
    v_bitop3_b32 v45, v239, v31, v45 bitop3:0xbe
    v_and_b32 v46, 1, v31
    v_xor_b32 v46, 1, v46
    v_or3_b32 v44, v44, v45, v46
    v_cmp_ne_u32 vcc, 0, v44
    s_cbranch_vccnz sequential_preLN__ssm_conv_s4__glu_gated_bilinear__prompt_kernel_again
sequential_preLN__ssm_conv_s4__glu_gated_bilinear__prompt_kernel_got:
    v_and_b32 v225, s7, v224
    v_lshlrev_b32 v224, 16, v224
    v_rcp_f32 v224, v224
    v_and_b32 v227, s7, v226
    v_lshlrev_b32 v226, 16, v226
    v_rcp_f32 v226, v226
    v_and_b32 v229, s7, v228
    v_lshlrev_b32 v228, 16, v228
    v_rcp_f32 v228, v228
    v_and_b32 v231, s7, v230
    v_lshlrev_b32 v230, 16, v230
    v_rcp_f32 v230, v230
    v_and_b32 v233, s7, v232
    v_lshlrev_b32 v232, 16, v232
    v_rcp_f32 v232, v232
    v_and_b32 v235, s7, v234
    v_lshlrev_b32 v234, 16, v234
    v_rcp_f32 v234, v234
    v_and_b32 v237, s7, v236
    v_lshlrev_b32 v236, 16, v236
    v_rcp_f32 v236, v236
    v_and_b32 v239, s7, v238
    v_lshlrev_b32 v238, 16, v238
    v_rcp_f32 v238, v238
    v_mul_f32 v225, -v225, v224
    v_mul_f32 v227, -v227, v226
    v_mul_f32 v229, -v229, v228
    v_mul_f32 v231, -v231, v230
    v_mul_f32 v233, -v233, v232
    v_mul_f32 v235, -v235, v234
    v_mul_f32 v237, -v237, v236
    v_mul_f32 v239, -v239, v238
    v_pk_fma_f32 v[160:161], v[160:161], v[224:225], v[224:225] op_sel:[0,0,1] op_sel_hi:[1,0,1]
    v_pk_fma_f32 v[164:165], v[164:165], v[226:227], v[226:227] op_sel:[0,0,1] op_sel_hi:[1,0,1]
    v_pk_fma_f32 v[168:169], v[168:169], v[228:229], v[228:229] op_sel:[0,0,1] op_sel_hi:[1,0,1]
    v_pk_fma_f32 v[172:173], v[172:173], v[230:231], v[230:231] op_sel:[0,0,1] op_sel_hi:[1,0,1]
    v_pk_fma_f32 v[176:177], v[176:177], v[232:233], v[232:233] op_sel:[0,0,1] op_sel_hi:[1,0,1]
    v_pk_fma_f32 v[180:181], v[180:181], v[234:235], v[234:235] op_sel:[0,0,1] op_sel_hi:[1,0,1]
    v_pk_fma_f32 v[184:185], v[184:185], v[236:237], v[236:237] op_sel:[0,0,1] op_sel_hi:[1,0,1]
    v_pk_fma_f32 v[188:189], v[188:189], v[238:239], v[238:239] op_sel:[0,0,1] op_sel_hi:[1,0,1]
    v_cvt_pk_bf16_f32 v240, v160, v164
    v_cvt_pk_bf16_f32 v241, v168, v172
    v_cvt_pk_bf16_f32 v242, v176, v180
    v_cvt_pk_bf16_f32 v243, v184, v188
    ds_write_b128 v58, v[240:243]
    v_cvt_pk_bf16_f32 v244, v161, v165
    v_cvt_pk_bf16_f32 v245, v169, v173
    v_cvt_pk_bf16_f32 v246, v177, v181
    v_cvt_pk_bf16_f32 v247, v185, v189
    ds_write_b128 v59, v[244:247]
    v_pk_fma_f32 v[162:163], v[162:163], v[224:225], v[224:225] op_sel:[0,0,1] op_sel_hi:[1,0,1]
    v_pk_fma_f32 v[166:167], v[166:167], v[226:227], v[226:227] op_sel:[0,0,1] op_sel_hi:[1,0,1]
    v_pk_fma_f32 v[170:171], v[170:171], v[228:229], v[228:229] op_sel:[0,0,1] op_sel_hi:[1,0,1]
    v_pk_fma_f32 v[174:175], v[174:175], v[230:231], v[230:231] op_sel:[0,0,1] op_sel_hi:[1,0,1]
    v_pk_fma_f32 v[178:179], v[178:179], v[232:233], v[232:233] op_sel:[0,0,1] op_sel_hi:[1,0,1]
    v_pk_fma_f32 v[182:183], v[182:183], v[234:235], v[234:235] op_sel:[0,0,1] op_sel_hi:[1,0,1]
    v_pk_fma_f32 v[186:187], v[186:187], v[236:237], v[236:237] op_sel:[0,0,1] op_sel_hi:[1,0,1]
    v_pk_fma_f32 v[190:191], v[190:191], v[238:239], v[238:239] op_sel:[0,0,1] op_sel_hi:[1,0,1]
    v_cvt_pk_bf16_f32 v248, v162, v166
    v_cvt_pk_bf16_f32 v249, v170, v174
    v_cvt_pk_bf16_f32 v250, v178, v182
    v_cvt_pk_bf16_f32 v251, v186, v190
    ds_write_b128 v60, v[248:251]
    v_cvt_pk_bf16_f32 v252, v163, v167
    v_cvt_pk_bf16_f32 v253, v171, v175
    v_cvt_pk_bf16_f32 v254, v179, v183
    v_cvt_pk_bf16_f32 v255, v187, v191
    ds_write_b128 v61, v[252:255]
    v_xor_b32 v58, 64, v58
    v_xor_b32 v59, 64, v59
    v_xor_b32 v60, 64, v60
    v_xor_b32 v61, 64, v61
    s_waitcnt lgkmcnt(0)
    s_barrier
    ds_read_b128 a[32:35], v16 offset:2048
    ds_read_b128 a[36:39], v16 offset:6144
    ds_read_b128 a[40:43], v16 offset:10240
    ds_read_b128 a[44:47], v16 offset:14336
    ds_read_b128 a[48:51], v16 offset:18432
    ds_read_b128 a[52:55], v16 offset:22528
    ds_read_b128 a[56:59], v16 offset:26624
    ds_read_b128 a[60:63], v16 offset:30720
    s_waitcnt lgkmcnt(7)
    v_mfma_f32_16x16x32_bf16 v[224:227], a[0:3], a[32:35], 0
    ds_read_b128 a[96:99], v17 offset:2048
    v_readfirstlane_b32 s96, v31
    s_waitcnt lgkmcnt(7)
    v_mfma_f32_16x16x32_bf16 v[228:231], a[0:3], a[36:39], 0
    ds_read2_b32 a[64:65], v12 offset0:224 offset1:225
    s_mov_b32 s20, s40
    v_mfma_f32_16x16x32_bf16 v[228:231], a[4:7], a[32:35], v[228:231]
    ds_read2_b32 a[66:67], v12 offset0:226 offset1:227
    s_and_b32 s21, s41, 0xffff
    s_waitcnt lgkmcnt(8)
    v_mfma_f32_16x16x32_bf16 v[232:235], a[0:3], a[40:43], 0
    ds_read_b128 a[100:103], v17 offset:6144
    s_mov_b32 s40, s42
    v_mfma_f32_16x16x32_bf16 v[232:235], a[4:7], a[36:39], v[232:235]
    ds_read2_b32 a[68:69], v12 offset0:96 offset1:97
    s_and_b32 s41, s43, 0xffff
    v_mfma_f32_16x16x32_bf16 v[232:235], a[8:11], a[32:35], v[232:235]
    ds_read2_b32 a[70:71], v12 offset0:98 offset1:99
    s_mov_b32 s76, s46
    s_waitcnt lgkmcnt(10)
    v_mfma_f32_16x16x32_bf16 v[236:239], a[0:3], a[44:47], 0
    ds_read_b128 a[104:107], v17 offset:10240
    s_and_b32 s77, s47, 0xffff
    v_mfma_f32_16x16x32_bf16 v[236:239], a[4:7], a[40:43], v[236:239]
    ds_read2_b32 a[72:73], v13 offset0:224 offset1:225
    s_and_b32 s3, s2, 7
    v_mfma_f32_16x16x32_bf16 v[236:239], a[8:11], a[36:39], v[236:239]
    ds_read2_b32 a[74:75], v13 offset0:226 offset1:227
    s_lshr_b32 s4, s2, 3
    v_mfma_f32_16x16x32_bf16 v[236:239], a[12:15], a[32:35], v[236:239]
    ds_read_b128 a[108:111], v17 offset:14336
    s_and_b32 s5, s3, 1
    s_waitcnt lgkmcnt(13)
    v_mfma_f32_16x16x32_bf16 v[240:243], a[0:3], a[48:51], 0
    ds_read2_b32 a[76:77], v13 offset0:96 offset1:97
    s_lshl_b32 s5, s5, 2
    v_mfma_f32_16x16x32_bf16 v[240:243], a[4:7], a[44:47], v[240:243]
    ds_read2_b32 a[78:79], v13 offset0:98 offset1:99
    s_and_b32 s6, s4, 3
    v_mfma_f32_16x16x32_bf16 v[240:243], a[8:11], a[40:43], v[240:243]
    ds_read_b128 a[112:115], v17 offset:18432
    s_add_u32 s34, s5, s6
    v_mfma_f32_16x16x32_bf16 v[240:243], a[12:15], a[36:39], v[240:243]
    ds_read_b128 a[116:119], v17 offset:22528
    s_lshr_b32 s35, s3, 1
    v_mfma_f32_16x16x32_bf16 v[240:243], a[16:19], a[32:35], v[240:243]
    ds_read_b128 a[120:123], v17 offset:26624
    s_lshr_b32 s36, s4, 2
    s_waitcnt lgkmcnt(15)
    v_mfma_f32_16x16x32_bf16 v[244:247], a[0:3], a[52:55], 0
    ds_read_b128 a[124:127], v17 offset:30720
    s_lshl_b32 s5, s35, 3
    v_mfma_f32_16x16x32_bf16 v[244:247], a[4:7], a[48:51], v[244:247]
    ds_write_b128 v58, v[96:99]
    s_add_u32 s37, s5, s36
    v_mfma_f32_16x16x32_bf16 v[244:247], a[8:11], a[44:47], v[244:247]
    ds_write_b128 v59, v[100:103]
    s_lshr_b32 s5, s37, 2
    v_mfma_f32_16x16x32_bf16 v[244:247], a[12:15], a[40:43], v[244:247]
    ds_write_b128 v60, v[104:107]
    s_lshl_b32 s6, s37, 1
    v_mfma_f32_16x16x32_bf16 v[244:247], a[16:19], a[36:39], v[244:247]
    ds_write_b128 v61, v[108:111]
    s_add_u32 s39, s5, s6
    s_waitcnt lgkmcnt(15)
    v_mfma_f32_16x16x32_bf16 v[248:251], a[0:3], a[56:59], 0
    ds_read_b128 a[128:131], v21 offset:0
    s_lshl_b32 s72, s39, 7
    v_mfma_f32_16x16x32_bf16 v[248:251], a[4:7], a[52:55], v[248:251]
    ds_read_b128 a[132:135], v15 offset:0
    v_lshrrev_b32 v5, 3, v1
    v_mfma_f32_16x16x32_bf16 v[248:251], a[8:11], a[48:51], v[248:251]
    ds_read_b128 a[136:139], v21 offset:4096
    v_and_b32 v6, 6, v5
    v_mfma_f32_16x16x32_bf16 v[248:251], a[12:15], a[44:47], v[248:251]
    ds_read_b128 a[140:143], v15 offset:4096
    v_xor_b32 v6, v6, v1
    v_mfma_f32_16x16x32_bf16 v[248:251], a[16:19], a[40:43], v[248:251]
    v_and_b32 v6, 7, v6
    v_lshlrev_b32 v6, 4, v6
    s_waitcnt lgkmcnt(15)
    v_mfma_f32_16x16x32_bf16 v[252:255], a[0:3], a[60:63], 0
    v_lshl_add_u32 v2, v5, 7, v6
    v_lshrrev_b32 v5, 3, v0
    v_mfma_f32_16x16x32_bf16 v[252:255], a[4:7], a[56:59], v[252:255]
    v_mul_u32_u24 v5, 9216, v5
    v_add_u32 v3, v5, v6
    v_mfma_f32_16x16x32_bf16 v[252:255], a[8:11], a[52:55], v[252:255]
    s_lshl_b32 s5, s34, 2
    s_add_u32 s5, s5, s33
    v_mfma_f32_16x16x32_bf16 v[252:255], a[12:15], a[48:51], v[252:255]
    s_mul_i32 s5, s5, 73728
    s_add_u32 s60, s5, 0x900000
    v_mfma_f32_16x16x32_bf16 v[252:255], a[16:19], a[44:47], v[252:255]
    s_lshl_b32 s58, s33, 10
    s_mul_i32 s59, s33, 12288
    s_waitcnt lgkmcnt(0)
    s_barrier
    v_mfma_f32_16x16x32_bf16 v[224:227], a[64:67], a[96:99], v[224:227]
    ds_read_b128 a[144:147], v21 offset:8192
    s_mov_b32 s22, 5308416
    v_mfma_f32_16x16x32_bf16 v[228:231], a[64:67], a[100:103], v[228:231]
    ds_read_b128 a[148:151], v15 offset:8192
    s_mov_b32 s23, 0x20000
    v_mfma_f32_16x16x32_bf16 v[228:231], a[68:71], a[96:99], v[228:231]
    ds_read_b128 a[152:155], v21 offset:12288
    s_mov_b32 s42, 5308416
sequential_preLN__ssm_conv_s4__glu_gated_bilinear__prompt_kernel_c_h1:
    s_cbranch_execz sequential_preLN__ssm_conv_s4__glu_gated_bilinear__prompt_kernel_c_h1_1
    v_mfma_f32_16x16x32_bf16 v[232:235], a[64:67], a[104:107], v[232:235]
    ds_read_b128 a[156:159], v15 offset:12288
    s_mov_b32 s43, 0x20000
    v_mfma_f32_16x16x32_bf16 v[232:235], a[68:71], a[100:103], v[232:235]
    ds_read_b128 a[32:35], v18 offset:2048
    s_add_u32 m0, s58, 49152
    v_mfma_f32_16x16x32_bf16 v[232:235], a[72:75], a[96:99], v[232:235]
    buffer_load_dwordx4 v3, s[20:23], s72 offen lds
    v_mfma_f32_16x16x32_bf16 v[236:239], a[64:67], a[108:111], v[236:239]
    ds_read2_b32 a[0:1], v12 offset0:208 offset1:209
    v_mfma_f32_16x16x32_bf16 v[236:239], a[68:71], a[104:107], v[236:239]
    ds_read2_b32 a[2:3], v12 offset0:210 offset1:211
    v_mfma_f32_16x16x32_bf16 v[236:239], a[72:75], a[100:103], v[236:239]
    ds_read_b128 a[36:39], v18 offset:6144
    v_mfma_f32_16x16x32_bf16 v[236:239], a[76:79], a[96:99], v[236:239]
    ds_read2_b32 a[4:5], v12 offset0:80 offset1:81
    v_mfma_f32_16x16x32_bf16 v[240:243], a[64:67], a[112:115], v[240:243]
    ds_read2_b32 a[6:7], v12 offset0:82 offset1:83
    v_mfma_f32_16x16x32_bf16 v[240:243], a[68:71], a[108:111], v[240:243]
    ds_read_b128 a[40:43], v18 offset:10240
    v_mfma_f32_16x16x32_bf16 v[240:243], a[72:75], a[104:107], v[240:243]
    ds_read2_b32 a[8:9], v13 offset0:208 offset1:209
    v_mfma_f32_16x16x32_bf16 v[240:243], a[76:79], a[100:103], v[240:243]
    ds_read2_b32 a[10:11], v13 offset0:210 offset1:211
    v_mfma_f32_16x16x32_bf16 v[244:247], a[64:67], a[116:119], v[244:247]
    ds_read_b128 a[44:47], v18 offset:14336
    v_mfma_f32_16x16x32_bf16 v[244:247], a[68:71], a[112:115], v[244:247]
    ds_read2_b32 a[12:13], v13 offset0:80 offset1:81
    v_mfma_f32_16x16x32_bf16 v[244:247], a[72:75], a[108:111], v[244:247]
    ds_read2_b32 a[14:15], v13 offset0:82 offset1:83
    v_mfma_f32_16x16x32_bf16 v[244:247], a[76:79], a[104:107], v[244:247]
    ds_read_b128 a[48:51], v18 offset:18432
    v_mfma_f32_16x16x32_bf16 v[248:251], a[64:67], a[120:123], v[248:251]
    ds_read_b128 a[52:55], v18 offset:22528
    v_mfma_f32_16x16x32_bf16 v[248:251], a[68:71], a[116:119], v[248:251]
    ds_read_b128 a[56:59], v18 offset:26624
    v_mfma_f32_16x16x32_bf16 v[248:251], a[72:75], a[112:115], v[248:251]
    ds_read_b128 a[60:63], v18 offset:30720
    v_mfma_f32_16x16x32_bf16 v[248:251], a[76:79], a[108:111], v[248:251]
    v_mfma_f32_16x16x32_bf16 v[252:255], a[64:67], a[124:127], v[252:255]
sequential_preLN__ssm_conv_s4__glu_gated_bilinear__prompt_kernel_c_h1_1:
    s_cbranch_execz sequential_preLN__ssm_conv_s4__glu_gated_bilinear__prompt_kernel_c_h1_2
    v_mfma_f32_16x16x32_bf16 v[252:255], a[68:71], a[120:123], v[252:255]
    v_mfma_f32_16x16x32_bf16 v[252:255], a[72:75], a[116:119], v[252:255]
    v_mfma_f32_16x16x32_bf16 v[252:255], a[76:79], a[112:115], v[252:255]
    s_waitcnt lgkmcnt(0)
    v_mfma_f32_16x16x32_bf16 v[64:67], a[128:131], a[20:23], 0
    ds_read_b128 a[96:99], v19 offset:2048
    s_add_u32 m0, s58, 53248
    v_mfma_f32_16x16x32_bf16 v[68:71], a[132:135], a[24:27], 0
    buffer_load_dwordx4 v3, s[40:43], s72 offen lds
    v_mfma_f32_16x16x32_bf16 v[72:75], a[136:139], a[20:23], 0
    ds_read2_b32 a[64:65], v12 offset0:192 offset1:193
    s_add_u32 s72, s72, 294912
    v_mfma_f32_16x16x32_bf16 v[76:79], a[140:143], a[24:27], 0
    ds_read2_b32 a[66:67], v12 offset0:194 offset1:195
    v_mfma_f32_16x16x32_bf16 v[80:83], a[144:147], a[20:23], 0
    ds_read_b128 a[100:103], v19 offset:6144
    v_mfma_f32_16x16x32_bf16 v[84:87], a[148:151], a[24:27], 0
    ds_read2_b32 a[68:69], v12 offset0:64 offset1:65
    v_mfma_f32_16x16x32_bf16 v[88:91], a[152:155], a[20:23], 0
    ds_read2_b32 a[70:71], v12 offset0:66 offset1:67
    s_add_u32 m0, s58, 57344
    v_mfma_f32_16x16x32_bf16 v[92:95], a[156:159], a[24:27], 0
    buffer_load_dwordx4 v3, s[20:23], s72 offen lds
    v_mfma_f32_16x16x32_bf16 v[224:227], a[0:3], a[32:35], v[224:227]
    ds_read_b128 a[104:107], v19 offset:10240
    v_mfma_f32_16x16x32_bf16 v[228:231], a[0:3], a[36:39], v[228:231]
    ds_read2_b32 a[72:73], v13 offset0:192 offset1:193
    v_mfma_f32_16x16x32_bf16 v[228:231], a[4:7], a[32:35], v[228:231]
    ds_read2_b32 a[74:75], v13 offset0:194 offset1:195
    v_cvt_pk_bf16_f32 v128, v64, v68
    v_mfma_f32_16x16x32_bf16 v[232:235], a[0:3], a[40:43], v[232:235]
    ds_read_b128 a[108:111], v19 offset:14336
    v_cvt_pk_bf16_f32 v129, v65, v69
    v_mfma_f32_16x16x32_bf16 v[232:235], a[4:7], a[36:39], v[232:235]
    ds_read2_b32 a[76:77], v13 offset0:64 offset1:65
    s_add_u32 m0, s58, 61440
    v_mfma_f32_16x16x32_bf16 v[232:235], a[8:11], a[32:35], v[232:235]
    buffer_load_dwordx4 v3, s[40:43], s72 offen lds
    v_mfma_f32_16x16x32_bf16 v[236:239], a[0:3], a[44:47], v[236:239]
    ds_read2_b32 a[78:79], v13 offset0:66 offset1:67
sequential_preLN__ssm_conv_s4__glu_gated_bilinear__prompt_kernel_c_h1_2:
    s_cbranch_execz sequential_preLN__ssm_conv_s4__glu_gated_bilinear__prompt_kernel_c_ret
    v_cvt_pk_bf16_f32 v130, v66, v70
    v_mfma_f32_16x16x32_bf16 v[236:239], a[4:7], a[40:43], v[236:239]
    ds_read_b128 a[112:115], v19 offset:18432
    v_cvt_pk_bf16_f32 v131, v67, v71
    v_mfma_f32_16x16x32_bf16 v[236:239], a[8:11], a[36:39], v[236:239]
    ds_read_b128 a[116:119], v19 offset:22528
    v_cvt_pk_bf16_f32 v132, v72, v76
    v_mfma_f32_16x16x32_bf16 v[236:239], a[12:15], a[32:35], v[236:239]
    ds_read_b128 a[120:123], v19 offset:26624
    v_cvt_pk_bf16_f32 v133, v73, v77
    v_mfma_f32_16x16x32_bf16 v[240:243], a[0:3], a[48:51], v[240:243]
    ds_read_b128 a[124:127], v19 offset:30720
    v_cvt_pk_bf16_f32 v134, v74, v78
    v_mfma_f32_16x16x32_bf16 v[240:243], a[4:7], a[44:47], v[240:243]
    ds_read_b128 a[160:163], v20 offset:0
    v_cvt_pk_bf16_f32 v135, v75, v79
    v_mfma_f32_16x16x32_bf16 v[240:243], a[8:11], a[40:43], v[240:243]
    ds_read_b128 a[164:167], v20 offset:4096
    v_cvt_pk_bf16_f32 v136, v80, v84
    v_mfma_f32_16x16x32_bf16 v[240:243], a[12:15], a[36:39], v[240:243]
    v_cvt_pk_bf16_f32 v137, v81, v85
    v_cvt_pk_bf16_f32 v138, v82, v86
    v_mfma_f32_16x16x32_bf16 v[244:247], a[0:3], a[52:55], v[244:247]
    v_cvt_pk_bf16_f32 v139, v83, v87
    v_cvt_pk_bf16_f32 v140, v88, v92
    v_mfma_f32_16x16x32_bf16 v[244:247], a[4:7], a[48:51], v[244:247]
    v_cvt_pk_bf16_f32 v141, v89, v93
    v_cvt_pk_bf16_f32 v142, v90, v94
    v_mfma_f32_16x16x32_bf16 v[244:247], a[8:11], a[44:47], v[244:247]
    v_cvt_pk_bf16_f32 v143, v91, v95
    s_add_u32 s72, s72, 294912
    v_mfma_f32_16x16x32_bf16 v[244:247], a[12:15], a[40:43], v[244:247]
    s_add_u32 m0, s58, 65536
    v_mfma_f32_16x16x32_bf16 v[248:251], a[0:3], a[56:59], v[248:251]
    buffer_load_dwordx4 v3, s[20:23], s72 offen lds
    v_mfma_f32_16x16x32_bf16 v[248:251], a[4:7], a[52:55], v[248:251]
    v_mfma_f32_16x16x32_bf16 v[248:251], a[8:11], a[48:51], v[248:251]
    v_mfma_f32_16x16x32_bf16 v[248:251], a[12:15], a[44:47], v[248:251]
    v_mfma_f32_16x16x32_bf16 v[252:255], a[0:3], a[60:63], v[252:255]
    v_mfma_f32_16x16x32_bf16 v[252:255], a[4:7], a[56:59], v[252:255]
    v_mfma_f32_16x16x32_bf16 v[252:255], a[8:11], a[52:55], v[252:255]
    v_mfma_f32_16x16x32_bf16 v[252:255], a[12:15], a[48:51], v[252:255]
    s_waitcnt lgkmcnt(0)
    v_mfma_f32_16x16x32_bf16 v[224:227], a[64:67], a[96:99], v[224:227]
    ds_read_b128 a[32:35], v16 offset:0
    s_add_u32 m0, s58, 69632
    v_mfma_f32_16x16x32_bf16 v[228:231], a[64:67], a[100:103], v[228:231]
    buffer_load_dwordx4 v3, s[40:43], s72 offen lds
    v_mfma_f32_16x16x32_bf16 v[228:231], a[68:71], a[96:99], v[228:231]
    ds_read2_b32 a[0:1], v12 offset0:176 offset1:177
    s_add_u32 s72, s72, 294912
    v_mfma_f32_16x16x32_bf16 v[232:235], a[64:67], a[104:107], v[232:235]
    ds_read2_b32 a[2:3], v12 offset0:178 offset1:179
    v_mfma_f32_16x16x32_bf16 v[232:235], a[68:71], a[100:103], v[232:235]
    ds_read_b128 a[36:39], v16 offset:4096
    v_mfma_f32_16x16x32_bf16 v[232:235], a[72:75], a[96:99], v[232:235]
    ds_read2_b32 a[4:5], v12 offset0:48 offset1:49
    v_mfma_f32_16x16x32_bf16 v[236:239], a[64:67], a[108:111], v[236:239]
    ds_read2_b32 a[6:7], v12 offset0:50 offset1:51
    s_add_u32 m0, s58, 73728
    v_mfma_f32_16x16x32_bf16 v[236:239], a[68:71], a[104:107], v[236:239]
    buffer_load_dwordx4 v3, s[20:23], s72 offen lds
    v_mfma_f32_16x16x32_bf16 v[236:239], a[72:75], a[100:103], v[236:239]
    ds_read_b128 a[40:43], v16 offset:8192
    v_mfma_f32_16x16x32_bf16 v[236:239], a[76:79], a[96:99], v[236:239]
    ds_read2_b32 a[8:9], v13 offset0:176 offset1:177
    v_mfma_f32_16x16x32_bf16 v[240:243], a[64:67], a[112:115], v[240:243]
    ds_read2_b32 a[10:11], v13 offset0:178 offset1:179
    v_mfma_f32_16x16x32_bf16 v[240:243], a[68:71], a[108:111], v[240:243]
    ds_read_b128 a[44:47], v16 offset:12288
    v_mfma_f32_16x16x32_bf16 v[240:243], a[72:75], a[104:107], v[240:243]
    ds_read2_b32 a[12:13], v13 offset0:48 offset1:49
    s_add_u32 m0, s58, 77824
    v_mfma_f32_16x16x32_bf16 v[240:243], a[76:79], a[100:103], v[240:243]
    buffer_load_dwordx4 v3, s[40:43], s72 offen lds
    v_mfma_f32_16x16x32_bf16 v[244:247], a[64:67], a[116:119], v[244:247]
    ds_read2_b32 a[14:15], v13 offset0:50 offset1:51
    s_add_u32 s72, s72, 294912
    v_mfma_f32_16x16x32_bf16 v[244:247], a[68:71], a[112:115], v[244:247]
    ds_read_b128 a[48:51], v16 offset:16384
    v_mfma_f32_16x16x32_bf16 v[244:247], a[72:75], a[108:111], v[244:247]
    ds_read_b128 a[52:55], v16 offset:20480
    v_mfma_f32_16x16x32_bf16 v[244:247], a[76:79], a[104:107], v[244:247]
    ds_read_b128 a[56:59], v16 offset:24576
    v_mfma_f32_16x16x32_bf16 v[248:251], a[64:67], a[120:123], v[248:251]
    ds_read_b128 a[60:63], v16 offset:28672
    v_mfma_f32_16x16x32_bf16 v[248:251], a[68:71], a[116:119], v[248:251]
    ds_read_b128 a[168:171], v20 offset:8192
    v_mfma_f32_16x16x32_bf16 v[248:251], a[72:75], a[112:115], v[248:251]
    ds_read_b128 a[172:175], v20 offset:12288
    v_mfma_f32_16x16x32_bf16 v[248:251], a[76:79], a[108:111], v[248:251]
    v_mfma_f32_16x16x32_bf16 v[252:255], a[64:67], a[124:127], v[252:255]
    v_mfma_f32_16x16x32_bf16 v[252:255], a[68:71], a[120:123], v[252:255]
    v_mfma_f32_16x16x32_bf16 v[252:255], a[72:75], a[116:119], v[252:255]
    v_mfma_f32_16x16x32_bf16 v[252:255], a[76:79], a[112:115], v[252:255]
    s_waitcnt lgkmcnt(0)
    v_mfma_f32_16x16x32_bf16 v[224:227], a[0:3], a[32:35], v[224:227]
    ds_read_b128 a[96:99], v17 offset:0
    s_add_u32 m0, s58, 81920
    v_mfma_f32_16x16x32_bf16 v[228:231], a[0:3], a[36:39], v[228:231]
    buffer_load_dwordx4 v3, s[20:23], s72 offen lds
    v_mfma_f32_16x16x32_bf16 v[228:231], a[4:7], a[32:35], v[228:231]
    ds_read2_b32 a[64:65], v12 offset0:160 offset1:161
    v_mfma_f32_16x16x32_bf16 v[232:235], a[0:3], a[40:43], v[232:235]
    ds_read2_b32 a[66:67], v12 offset0:162 offset1:163
    v_mfma_f32_16x16x32_bf16 v[232:235], a[4:7], a[36:39], v[232:235]
    ds_read_b128 a[100:103], v17 offset:4096
    v_mfma_f32_16x16x32_bf16 v[232:235], a[8:11], a[32:35], v[232:235]
    ds_read2_b32 a[68:69], v12 offset0:32 offset1:33
    v_mfma_f32_16x16x32_bf16 v[236:239], a[0:3], a[44:47], v[236:239]
    ds_read2_b32 a[70:71], v12 offset0:34 offset1:35
    s_add_u32 m0, s58, 86016
    v_mfma_f32_16x16x32_bf16 v[236:239], a[4:7], a[40:43], v[236:239]
    buffer_load_dwordx4 v3, s[40:43], s72 offen lds
    v_mfma_f32_16x16x32_bf16 v[236:239], a[8:11], a[36:39], v[236:239]
    ds_read_b128 a[104:107], v17 offset:8192
    s_add_u32 s72, s72, 294912
    v_mfma_f32_16x16x32_bf16 v[236:239], a[12:15], a[32:35], v[236:239]
    ds_read2_b32 a[72:73], v13 offset0:160 offset1:161
    v_mfma_f32_16x16x32_bf16 v[240:243], a[0:3], a[48:51], v[240:243]
    ds_read2_b32 a[74:75], v13 offset0:162 offset1:163
    v_mfma_f32_16x16x32_bf16 v[240:243], a[4:7], a[44:47], v[240:243]
    ds_read_b128 a[108:111], v17 offset:12288
    v_mfma_f32_16x16x32_bf16 v[240:243], a[8:11], a[40:43], v[240:243]
    ds_read2_b32 a[76:77], v13 offset0:32 offset1:33
    s_add_u32 m0, s58, 90112
    v_mfma_f32_16x16x32_bf16 v[240:243], a[12:15], a[36:39], v[240:243]
    buffer_load_dwordx4 v3, s[20:23], s72 offen lds
    v_mfma_f32_16x16x32_bf16 v[240:243], v[128:131], v[192:195], v[240:243]
    ds_read2_b32 a[78:79], v13 offset0:34 offset1:35
    v_mfma_f32_16x16x32_bf16 v[244:247], a[0:3], a[52:55], v[244:247]
    ds_read_b128 a[112:115], v17 offset:16384
    v_mfma_f32_16x16x32_bf16 v[244:247], a[4:7], a[48:51], v[244:247]
    ds_read_b128 a[116:119], v17 offset:20480
    v_mfma_f32_16x16x32_bf16 v[244:247], a[8:11], a[44:47], v[244:247]
    ds_read_b128 a[120:123], v17 offset:24576
    v_mfma_f32_16x16x32_bf16 v[244:247], a[12:15], a[40:43], v[244:247]
    ds_read_b128 a[124:127], v17 offset:28672
    s_add_u32 m0, s58, 94208
    v_mfma_f32_16x16x32_bf16 v[244:247], v[128:131], a[80:83], v[244:247]
    buffer_load_dwordx4 v3, s[40:43], s72 offen lds
    v_mfma_f32_16x16x32_bf16 v[244:247], v[132:135], v[192:195], v[244:247]
    ds_read_b128 a[176:179], v20 offset:16384
    s_add_u32 s72, s72, 294912
    v_mfma_f32_16x16x32_bf16 v[248:251], a[0:3], a[56:59], v[248:251]
    ds_read_b128 a[180:183], v20 offset:20480
    v_mfma_f32_16x16x32_bf16 v[248:251], a[4:7], a[52:55], v[248:251]
    v_mfma_f32_16x16x32_bf16 v[248:251], a[8:11], a[48:51], v[248:251]
    v_mfma_f32_16x16x32_bf16 v[248:251], a[12:15], a[44:47], v[248:251]
    s_add_u32 m0, s58, 98304
    v_mfma_f32_16x16x32_bf16 v[248:251], v[128:131], a[84:87], v[248:251]
    buffer_load_dwordx4 v3, s[20:23], s72 offen lds
    v_mfma_f32_16x16x32_bf16 v[248:251], v[132:135], a[80:83], v[248:251]
    v_mfma_f32_16x16x32_bf16 v[248:251], v[136:139], v[192:195], v[248:251]
    v_mfma_f32_16x16x32_bf16 v[252:255], a[0:3], a[60:63], v[252:255]
    v_mfma_f32_16x16x32_bf16 v[252:255], a[4:7], a[56:59], v[252:255]
    v_mfma_f32_16x16x32_bf16 v[252:255], a[8:11], a[52:55], v[252:255]
    v_mfma_f32_16x16x32_bf16 v[252:255], a[12:15], a[48:51], v[252:255]
    v_mfma_f32_16x16x32_bf16 v[252:255], v[128:131], a[88:91], v[252:255]
    v_mfma_f32_16x16x32_bf16 v[252:255], v[132:135], a[84:87], v[252:255]
    v_mfma_f32_16x16x32_bf16 v[252:255], v[136:139], a[80:83], v[252:255]
    v_mfma_f32_16x16x32_bf16 v[252:255], v[140:143], v[192:195], v[252:255]
    s_waitcnt lgkmcnt(0)
    v_mfma_f32_16x16x32_bf16 v[224:227], a[64:67], a[96:99], v[224:227]
    ds_read_b128 a[32:35], v18 offset:0
    s_add_u32 m0, s58, 102400
    v_mfma_f32_16x16x32_bf16 v[228:231], a[64:67], a[100:103], v[228:231]
    buffer_load_dwordx4 v3, s[40:43], s72 offen lds
    v_mfma_f32_16x16x32_bf16 v[228:231], a[68:71], a[96:99], v[228:231]
    ds_read2_b32 a[0:1], v12 offset0:144 offset1:145
    s_add_u32 s72, s72, 294912
    v_mfma_f32_16x16x32_bf16 v[232:235], a[64:67], a[104:107], v[232:235]
    ds_read2_b32 a[2:3], v12 offset0:146 offset1:147
    v_mfma_f32_16x16x32_bf16 v[232:235], a[68:71], a[100:103], v[232:235]
    ds_read_b128 a[36:39], v18 offset:4096
    v_mfma_f32_16x16x32_bf16 v[232:235], a[72:75], a[96:99], v[232:235]
    ds_read2_b32 a[4:5], v12 offset0:16 offset1:17
    v_mfma_f32_16x16x32_bf16 v[236:239], a[64:67], a[108:111], v[236:239]
    ds_read2_b32 a[6:7], v12 offset0:18 offset1:19
    s_add_u32 m0, s58, 106496
    v_mfma_f32_16x16x32_bf16 v[236:239], a[68:71], a[104:107], v[236:239]
    buffer_load_dwordx4 v3, s[20:23], s72 offen lds
    v_mfma_f32_16x16x32_bf16 v[236:239], a[72:75], a[100:103], v[236:239]
    ds_read_b128 a[40:43], v18 offset:8192
    v_mfma_f32_16x16x32_bf16 v[236:239], a[76:79], a[96:99], v[236:239]
    ds_read2_b32 a[8:9], v13 offset0:144 offset1:145
    v_mfma_f32_16x16x32_bf16 v[240:243], a[64:67], a[112:115], v[240:243]
    ds_read2_b32 a[10:11], v13 offset0:146 offset1:147
    v_mfma_f32_16x16x32_bf16 v[240:243], a[68:71], a[108:111], v[240:243]
    ds_read_b128 a[44:47], v18 offset:12288
    v_mfma_f32_16x16x32_bf16 v[240:243], a[72:75], a[104:107], v[240:243]
    ds_read2_b32 a[12:13], v13 offset0:16 offset1:17
    s_add_u32 m0, s58, 110592
    v_mfma_f32_16x16x32_bf16 v[240:243], a[76:79], a[100:103], v[240:243]
    buffer_load_dwordx4 v3, s[40:43], s72 offen lds
    v_mfma_f32_16x16x32_bf16 v[244:247], a[64:67], a[116:119], v[244:247]
    ds_read2_b32 a[14:15], v13 offset0:18 offset1:19
    s_add_u32 s72, s72, 294912
    v_mfma_f32_16x16x32_bf16 v[244:247], a[68:71], a[112:115], v[244:247]
    ds_read_b128 a[48:51], v18 offset:16384
    v_mfma_f32_16x16x32_bf16 v[244:247], a[72:75], a[108:111], v[244:247]
    ds_read_b128 a[52:55], v18 offset:20480
    v_mfma_f32_16x16x32_bf16 v[244:247], a[76:79], a[104:107], v[244:247]
    ds_read_b128 a[56:59], v18 offset:24576
    v_mfma_f32_16x16x32_bf16 v[248:251], a[64:67], a[120:123], v[248:251]
    ds_read_b128 a[60:63], v18 offset:28672
    v_mfma_f32_16x16x32_bf16 v[248:251], a[68:71], a[116:119], v[248:251]
    ds_read_b128 a[184:187], v20 offset:24576
    v_mfma_f32_16x16x32_bf16 v[248:251], a[72:75], a[112:115], v[248:251]
    ds_read_b128 a[188:191], v20 offset:28672
    v_mfma_f32_16x16x32_bf16 v[248:251], a[76:79], a[108:111], v[248:251]
    v_mfma_f32_16x16x32_bf16 v[252:255], a[64:67], a[124:127], v[252:255]
    v_mfma_f32_16x16x32_bf16 v[252:255], a[68:71], a[120:123], v[252:255]
    v_mfma_f32_16x16x32_bf16 v[252:255], a[72:75], a[116:119], v[252:255]
    v_mfma_f32_16x16x32_bf16 v[252:255], a[76:79], a[112:115], v[252:255]
    s_waitcnt lgkmcnt(0)
    v_mfma_f32_16x16x32_bf16 v[224:227], a[0:3], a[32:35], v[224:227]
    ds_read_b128 a[96:99], v19 offset:0
    s_add_u32 m0, s58, 114688
    v_mfma_f32_16x16x32_bf16 v[224:227], a[28:31], a[160:163], v[224:227]
    buffer_load_dwordx4 v3, s[20:23], s72 offen lds
    v_mfma_f32_16x16x32_bf16 v[228:231], a[0:3], a[36:39], v[228:231]
    ds_read2_b32 a[64:65], v12 offset0:128 offset1:129
    v_mfma_f32_16x16x32_bf16 v[228:231], a[4:7], a[32:35], v[228:231]
    ds_read2_b32 a[66:67], v12 offset0:130 offset1:131
    v_mfma_f32_16x16x32_bf16 v[228:231], a[28:31], a[164:167], v[228:231]
    ds_read_b128 a[100:103], v19 offset:4096
    v_mfma_f32_16x16x32_bf16 v[232:235], a[0:3], a[40:43], v[232:235]
    ds_read2_b32 a[68:69], v12 offset0:0 offset1:1
    v_mfma_f32_16x16x32_bf16 v[232:235], a[4:7], a[36:39], v[232:235]
    ds_read2_b32 a[70:71], v12 offset0:2 offset1:3
    s_add_u32 m0, s58, 118784
    v_mfma_f32_16x16x32_bf16 v[232:235], a[8:11], a[32:35], v[232:235]
    buffer_load_dwordx4 v3, s[40:43], s72 offen lds
    v_mfma_f32_16x16x32_bf16 v[232:235], a[28:31], a[168:171], v[232:235]
    ds_read_b128 a[104:107], v19 offset:8192
    s_add_u32 s72, s72, 294912
    v_mfma_f32_16x16x32_bf16 v[236:239], a[0:3], a[44:47], v[236:239]
    ds_read2_b32 a[72:73], v13 offset0:128 offset1:129
    v_cmp_gt_u32 vcc, 8, v0
    v_mfma_f32_16x16x32_bf16 v[236:239], a[4:7], a[40:43], v[236:239]
    ds_read2_b32 a[74:75], v13 offset0:130 offset1:131
    s_lshl_b32 s5, s2, 7
    v_mfma_f32_16x16x32_bf16 v[236:239], a[8:11], a[36:39], v[236:239]
    ds_read_b128 a[108:111], v19 offset:12288
    s_add_u32 s5, s5, 0x40000
    v_mfma_f32_16x16x32_bf16 v[236:239], a[12:15], a[32:35], v[236:239]
    ds_read2_b32 a[76:77], v13 offset0:0 offset1:1
    v_mov_b32 v46, 0x20000000
    v_mfma_f32_16x16x32_bf16 v[236:239], a[28:31], a[172:175], v[236:239]
    ds_read2_b32 a[78:79], v13 offset0:2 offset1:3
    v_lshl_add_u32 v45, v0, 15, s5
    v_mfma_f32_16x16x32_bf16 v[240:243], a[0:3], a[48:51], v[240:243]
    ds_read_b128 a[112:115], v19 offset:16384
    v_cndmask_b32 v47, v46, v45, vcc
    v_mfma_f32_16x16x32_bf16 v[240:243], a[4:7], a[44:47], v[240:243]
    ds_read_b128 a[116:119], v19 offset:20480
    s_and_b32 s13, s2, 7
    v_mfma_f32_16x16x32_bf16 v[240:243], a[8:11], a[40:43], v[240:243]
    ds_read_b128 a[120:123], v19 offset:24576
    s_lshl_b32 s13, s13, 15
    v_mfma_f32_16x16x32_bf16 v[240:243], a[12:15], a[36:39], v[240:243]
    ds_read_b128 a[124:127], v19 offset:28672
    v_min_u32 v4, 35, v1
    v_mfma_f32_16x16x32_bf16 v[240:243], a[28:31], a[176:179], v[240:243]
    s_mul_i32 s5, s33, 36
    v_add_u32 v4, s5, v4
    v_mfma_f32_16x16x32_bf16 v[244:247], a[0:3], a[52:55], v[244:247]
    v_cmp_eq_u32 vcc, s2, v4
    v_xor_b32 v5, 1, v4
    v_mfma_f32_16x16x32_bf16 v[244:247], a[4:7], a[48:51], v[244:247]
    s_mov_b32 s5, 2048
    v_cndmask_b32 v4, v4, v5, vcc
    v_mfma_f32_16x16x32_bf16 v[244:247], a[8:11], a[44:47], v[244:247]
    v_add_lshl_u32 v4, v4, s5, 7
    s_sub_u32 s5, s2, 112
    v_mfma_f32_16x16x32_bf16 v[244:247], a[12:15], a[40:43], v[244:247]
    s_lshl_b32 s5, s5, 7
    s_add_u32 s5, s5, 0x40000
    v_mfma_f32_16x16x32_bf16 v[244:247], a[28:31], a[180:183], v[244:247]
    v_mov_b32 v6, s5
    v_min_u32 v39, 27, v1
    v_mfma_f32_16x16x32_bf16 v[248:251], a[0:3], a[56:59], v[248:251]
    s_mul_i32 s5, s33, 28
    s_add_u32 s5, s5, 2192
    v_mfma_f32_16x16x32_bf16 v[248:251], a[4:7], a[52:55], v[248:251]
    v_add_lshl_u32 v39, v39, s5, 7
    v_mfma_f32_16x16x32_bf16 v[248:251], a[8:11], a[48:51], v[248:251]
    v_mfma_f32_16x16x32_bf16 v[248:251], a[12:15], a[44:47], v[248:251]
    v_mfma_f32_16x16x32_bf16 v[248:251], a[28:31], a[184:187], v[248:251]
    v_mfma_f32_16x16x32_bf16 v[252:255], a[0:3], a[60:63], v[252:255]
    v_mfma_f32_16x16x32_bf16 v[252:255], a[4:7], a[56:59], v[252:255]
    v_mfma_f32_16x16x32_bf16 v[252:255], a[8:11], a[52:55], v[252:255]
    v_mfma_f32_16x16x32_bf16 v[252:255], a[12:15], a[48:51], v[252:255]
    v_mfma_f32_16x16x32_bf16 v[252:255], a[28:31], a[188:191], v[252:255]
    s_waitcnt lgkmcnt(0)
    v_mfma_f32_16x16x32_bf16 v[224:227], a[64:67], a[96:99], v[224:227]
    v_mfma_f32_16x16x32_bf16 v[228:231], a[64:67], a[100:103], v[228:231]
    v_mfma_f32_16x16x32_bf16 v[228:231], a[68:71], a[96:99], v[228:231]
    v_mfma_f32_16x16x32_bf16 v[232:235], a[64:67], a[104:107], v[232:235]
    v_mfma_f32_16x16x32_bf16 v[232:235], a[68:71], a[100:103], v[232:235]
    v_mfma_f32_16x16x32_bf16 v[232:235], a[72:75], a[96:99], v[232:235]
    v_mfma_f32_16x16x32_bf16 v[236:239], a[64:67], a[108:111], v[236:239]
    v_mfma_f32_16x16x32_bf16 v[236:239], a[68:71], a[104:107], v[236:239]
    s_nop 0
    v_cvt_pk_bf16_f32 v112, v224, v225
    v_cvt_pk_bf16_f32 v113, v226, v227
    v_mfma_f32_16x16x32_bf16 v[236:239], a[72:75], a[100:103], v[236:239]
    v_cvt_pk_bf16_f32 v114, v228, v229
    v_cvt_pk_bf16_f32 v115, v230, v231
    v_mfma_f32_16x16x32_bf16 v[236:239], a[76:79], a[96:99], v[236:239]
    s_add_u32 s78, s79, 0
    v_mfma_f32_16x16x32_bf16 v[240:243], a[64:67], a[112:115], v[240:243]
    v_permlane16_swap_b32 v112, v114
    v_permlane16_swap_b32 v113, v115
    v_mfma_f32_16x16x32_bf16 v[240:243], a[68:71], a[108:111], v[240:243]
    buffer_store_dwordx4 v[112:115], v22, s[28:31], s78 offen sc1
    v_mfma_f32_16x16x32_bf16 v[240:243], a[72:75], a[104:107], v[240:243]
    v_mfma_f32_16x16x32_bf16 v[240:243], a[76:79], a[100:103], v[240:243]
    v_cvt_pk_bf16_f32 v116, v232, v233
    v_cvt_pk_bf16_f32 v117, v234, v235
    v_mfma_f32_16x16x32_bf16 v[244:247], a[64:67], a[116:119], v[244:247]
    v_cvt_pk_bf16_f32 v118, v236, v237
    v_cvt_pk_bf16_f32 v119, v238, v239
    v_mfma_f32_16x16x32_bf16 v[244:247], a[68:71], a[112:115], v[244:247]
    s_add_u32 s78, s79, 589824
    v_mfma_f32_16x16x32_bf16 v[244:247], a[72:75], a[108:111], v[244:247]
    v_permlane16_swap_b32 v116, v118
    v_permlane16_swap_b32 v117, v119
    v_mfma_f32_16x16x32_bf16 v[244:247], a[76:79], a[104:107], v[244:247]
    buffer_store_dwordx4 v[116:119], v22, s[28:31], s78 offen sc1
    v_mfma_f32_16x16x32_bf16 v[248:251], a[64:67], a[120:123], v[248:251]
    v_mfma_f32_16x16x32_bf16 v[248:251], a[68:71], a[116:119], v[248:251]
    v_mfma_f32_16x16x32_bf16 v[248:251], a[72:75], a[112:115], v[248:251]
    v_mfma_f32_16x16x32_bf16 v[248:251], a[76:79], a[108:111], v[248:251]
    v_cvt_pk_bf16_f32 v120, v240, v241
    v_cvt_pk_bf16_f32 v121, v242, v243
    v_mfma_f32_16x16x32_bf16 v[252:255], a[64:67], a[124:127], v[252:255]
    v_cvt_pk_bf16_f32 v122, v244, v245
    v_cvt_pk_bf16_f32 v123, v246, v247
    v_mfma_f32_16x16x32_bf16 v[252:255], a[68:71], a[120:123], v[252:255]
    s_add_u32 s78, s79, 1179648
    v_mfma_f32_16x16x32_bf16 v[252:255], a[72:75], a[116:119], v[252:255]
    v_permlane16_swap_b32 v120, v122
    v_permlane16_swap_b32 v121, v123
    v_mfma_f32_16x16x32_bf16 v[252:255], a[76:79], a[112:115], v[252:255]
    buffer_store_dwordx4 v[120:123], v22, s[28:31], s78 offen sc1
    v_cvt_pk_bf16_f32 v124, v248, v249
    v_cvt_pk_bf16_f32 v125, v250, v251
    s_nop 4
    v_cvt_pk_bf16_f32 v126, v252, v253
    v_cvt_pk_bf16_f32 v127, v254, v255
    s_add_u32 s78, s79, 1769472
    v_permlane16_swap_b32 v124, v126
    v_permlane16_swap_b32 v125, v127
    buffer_store_dwordx4 v[124:127], v22, s[28:31], s78 offen sc1
sequential_preLN__ssm_conv_s4__glu_gated_bilinear__prompt_kernel_c1:
    s_branch ffn
sequential_preLN__ssm_conv_s4__glu_gated_bilinear__prompt_kernel_again:
    s_sub_u32 s74, s74, 1
    s_cbranch_scc1 sequential_preLN__ssm_conv_s4__glu_gated_bilinear__prompt_kernel_got
    buffer_load_dwordx4 v[224:227], v57, s[28:31], 0 offen offset:0 sc1
    buffer_load_dwordx4 v[228:231], v57, s[28:31], 0 offen offset:1024 sc1
    buffer_load_dwordx4 v[232:235], v57, s[28:31], 0 offen offset:2048 sc1
    buffer_load_dwordx4 v[236:239], v57, s[28:31], 0 offen offset:3072 sc1
    s_branch sequential_preLN__ssm_conv_s4__glu_gated_bilinear__prompt_kernel_chk
sequential_preLN__ssm_conv_s4__glu_gated_bilinear__prompt_kernel_pack:
    s_sub_u32 s35, s2, 144
    s_sub_u32 s54, s2, 160
    s_waitcnt lgkmcnt(0)
    s_mov_b32 s28, s50
    s_and_b32 s29, s51, 0xffff
    v_lshrrev_b32 v72, 3, v1
    v_and_b32 v73, 6, v72
    v_xor_b32 v73, v73, v1
    v_and_b32 v73, 7, v73
    v_lshlrev_b32 v73, 4, v73
    s_lshl_b32 s3, s35, 2
    s_add_u32 s3, s3, s33
    s_max_u32 s3, s3, 16
    s_sub_u32 s3, s3, 16
    s_mul_i32 s4, s3, 21846
    s_lshr_b32 s4, s4, 16
    s_mul_i32 s5, s4, 3
    s_sub_u32 s69, s3, s5
    s_mul_i32 s70, s4, 1821
    s_lshr_b32 s70, s70, 16
    s_mul_i32 s6, s70, 36
    s_sub_u32 s71, s4, s6
    s_sub_u32 s5, s71, 4
    s_cmp_ge_u32 s71, 20
    s_cselect_b32 s5, s5, s71
    s_and_b32 s3, s5, 7
    s_lshr_b32 s66, s3, 2
    s_lshl_b32 s3, s3, 1
    s_add_u32 s66, s66, s3
    s_lshl_b32 s66, s66, 1
    s_lshr_b32 s5, s5, 3
    s_add_u32 s66, s66, s5
    s_bfe_u32 s5, s71, 0x10001
    s_mul_i32 s5, s5, 18
    s_and_b32 s3, s71, 1
    s_add_u32 s5, s5, s3
    s_add_u32 s5, s5, 16
    s_lshr_b32 s3, s71, 2
    s_cmp_eq_u32 s3, 4
    s_cselect_b32 s66, s5, s66
    s_add_u32 s66, s66, s6
    s_mul_i32 s66, s66, 36864
    s_mul_i32 s5, s69, 384
    s_add_u32 s66, s66, s5
    s_add_u32 s67, s66, 16384
    s_mul_i32 s68, s33, 12288
    s_mov_b32 s76, s44
    s_and_b32 s77, s45, 0xffff
    s_mov_b32 s79, 0x20000
    s_cmp_ge_u32 s35, 4
    s_cselect_b32 s78, 5308416, 0
    v_mul_u32_u24 v74, 1152, v72
    v_add_u32 v74, v74, v73
    v_add_u32 v75, 8192, v74
    s_mov_b32 s58, 5308416
    s_mov_b32 s59, 0x20000
    v_lshlrev_b32 v16, 4, v1
    v_lshrrev_b32 v12, 2, v1
    v_and_b32 v13, 6, v12
    v_lshlrev_b32 v13, 4, v13
    v_and_b32 v14, 3, v1
    v_lshlrev_b32 v14, 3, v14
    v_lshl_add_u32 v14, v12, 7, v14
    v_add_u32 v14, v14, v13
    s_add_u32 m0, s68, 0
    s_nop 0
    buffer_load_dwordx4 v74, s[76:79], s66 offen offset:0  lds
    s_waitcnt vmcnt(0)
    buffer_load_dwordx4 v75, s[76:79], s66 offen offset:1024  lds
    s_waitcnt vmcnt(0)
    buffer_load_dwordx4 v74, s[76:79], s67 offen offset:2048  lds
    buffer_load_dwordx4 v75, s[76:79], s67 offen offset:3072  lds
    s_add_u32 m0, s68, 4096
    s_add_u32 s66, s66, 128
    s_add_u32 s67, s67, 128
    buffer_load_dwordx4 v74, s[76:79], s66 offen offset:0  lds
    buffer_load_dwordx4 v75, s[76:79], s66 offen offset:1024  lds
    buffer_load_dwordx4 v74, s[76:79], s67 offen offset:2048  lds
    buffer_load_dwordx4 v75, s[76:79], s67 offen offset:3072  lds
    s_add_u32 m0, s68, 8192
    s_add_u32 s66, s66, 128
    s_add_u32 s67, s67, 128
    buffer_load_dwordx4 v74, s[76:79], s66 offen offset:0  lds
    buffer_load_dwordx4 v75, s[76:79], s66 offen offset:1024  lds
    buffer_load_dwordx4 v74, s[76:79], s67 offen offset:2048  lds
    buffer_load_dwordx4 v75, s[76:79], s67 offen offset:3072  lds
    v_xor_b32 v15, 0, v14
    v_add_u32 v8, s68, v15
    v_xor_b32 v15, 32, v14
    v_add_u32 v9, s68, v15
    v_xor_b32 v15, 64, v14
    v_add_u32 v10, s68, v15
    v_xor_b32 v15, 96, v14
    v_add_u32 v11, s68, v15
    s_mov_b32 s16, 0
    s_mov_b32 s17, 7
    s_cmp_ge_u32 s71, 7
    s_cselect_b32 s16, 7, s16
    s_cselect_b32 s17, 7, s17
    s_cmp_ge_u32 s71, 14
    s_cselect_b32 s16, 14, s16
    s_cselect_b32 s17, 6, s17
    s_cmp_ge_u32 s71, 20
    s_cselect_b32 s16, 20, s16
    s_cselect_b32 s17, 5, s17
    s_cmp_ge_u32 s71, 25
    s_cselect_b32 s16, 25, s16
    s_cselect_b32 s17, 5, s17
    s_cmp_ge_u32 s71, 30
    s_cselect_b32 s16, 30, s16
    s_cselect_b32 s17, 6, s17
    s_mul_i32 s4, s69, 12
    v_add_u32 v20, s4, v1
    v_mul_u32_u24 v21, 7282, v20
    v_lshrrev_b32 v21, 16, v21
    v_mul_u32_u24 v22, 9, v21
    v_sub_u32 v22, v20, v22
    s_lshl_b32 s4, s70, 1
    v_subrev_u32 v23, s4, v22
    v_cmp_eq_u32 vcc, 8, v22
    v_and_b32 v23, 7, v23
    s_mul_i32 s4, s16, 6
    v_cndmask_b32 v23, v23, v22, vcc
    v_mul_u32_u24 v24, s17, v23
    s_add_u32 s4, s4, s71
    s_lshl_b32 s5, s17, 1
    s_sub_u32 s4, s4, s5
    s_add_u32 s5, s16, s71
    s_add_u32 s5, s5, 252
    v_cmp_gt_u32 vcc, 2, v23
    v_add_u32 v25, s5, v24
    v_add_u32 v24, s4, v24
    v_cndmask_b32 v24, v24, v25, vcc
    v_lshl_add_u32 v21, v21, 2, s70
    v_mul_u32_u24 v21, 324, v21
    v_add_u32 v24, v24, v21
    s_cmp_ge_u32 s35, 4
    s_mov_b32 s4, 0x1620000
    s_cselect_b32 s4, s4, 0x20000000
    v_lshl_add_u32 v24, v24, 10, s4
    s_nop 0
    v_readlane_b32 s8, v24, 0
    v_readlane_b32 s9, v24, 1
    v_readlane_b32 s10, v24, 2
    v_readlane_b32 s11, v24, 3
    v_readlane_b32 s12, v24, 4
    v_readlane_b32 s14, v24, 5
    v_readlane_b32 s15, v24, 6
    v_readlane_b32 s16, v24, 7
    v_readlane_b32 s17, v24, 8
    v_readlane_b32 s18, v24, 9
    v_readlane_b32 s19, v24, 10
    v_readlane_b32 s24, v24, 11
    s_waitcnt vmcnt(8)
    ds_read_b64_tr_b16 a[0:1], v8 offset:0
    ds_read_b64_tr_b16 a[2:3], v8 offset:2048
    ds_read_b64_tr_b16 a[4:5], v9 offset:0
    ds_read_b64_tr_b16 a[6:7], v9 offset:2048
    ds_read_b64_tr_b16 a[8:9], v10 offset:0
    ds_read_b64_tr_b16 a[10:11], v10 offset:2048
    ds_read_b64_tr_b16 a[12:13], v11 offset:0
    ds_read_b64_tr_b16 a[14:15], v11 offset:2048
    s_waitcnt vmcnt(4)
    ds_read_b64_tr_b16 a[16:17], v8 offset:4096
    ds_read_b64_tr_b16 a[18:19], v8 offset:6144
    ds_read_b64_tr_b16 a[20:21], v9 offset:4096
    ds_read_b64_tr_b16 a[22:23], v9 offset:6144
    ds_read_b64_tr_b16 a[24:25], v10 offset:4096
    ds_read_b64_tr_b16 a[26:27], v10 offset:6144
    ds_read_b64_tr_b16 a[28:29], v11 offset:4096
    ds_read_b64_tr_b16 a[30:31], v11 offset:6144
    s_waitcnt vmcnt(0)
    ds_read_b64_tr_b16 a[32:33], v8 offset:8192
    ds_read_b64_tr_b16 a[34:35], v8 offset:10240
    ds_read_b64_tr_b16 a[36:37], v9 offset:8192
    ds_read_b64_tr_b16 a[38:39], v9 offset:10240
    ds_read_b64_tr_b16 a[40:41], v10 offset:8192
    ds_read_b64_tr_b16 a[42:43], v10 offset:10240
    ds_read_b64_tr_b16 a[44:45], v11 offset:8192
    ds_read_b64_tr_b16 a[46:47], v11 offset:10240
    s_waitcnt lgkmcnt(0)
    buffer_store_dwordx4 a[0:3], v16, s[28:31], s8 offen sc1
    buffer_store_dwordx4 a[4:7], v16, s[28:31], s9 offen sc1
    buffer_store_dwordx4 a[8:11], v16, s[28:31], s10 offen sc1
    buffer_store_dwordx4 a[12:15], v16, s[28:31], s11 offen sc1
    buffer_store_dwordx4 a[16:19], v16, s[28:31], s12 offen sc1
    buffer_store_dwordx4 a[20:23], v16, s[28:31], s14 offen sc1
    buffer_store_dwordx4 a[24:27], v16, s[28:31], s15 offen sc1
    buffer_store_dwordx4 a[28:31], v16, s[28:31], s16 offen sc1
    buffer_store_dwordx4 a[32:35], v16, s[28:31], s17 offen sc1
    buffer_store_dwordx4 a[36:39], v16, s[28:31], s18 offen sc1
    buffer_store_dwordx4 a[40:43], v16, s[28:31], s19 offen sc1
    buffer_store_dwordx4 a[44:47], v16, s[28:31], s24 offen sc1
    s_cmp_ge_u32 s35, 16
    s_cbranch_scc1 sequential_preLN__ssm_conv_s4__glu_gated_bilinear__prompt_kernel_csum
    s_lshr_b32 s64, s35, 1
    s_add_u32 s64, s64, 3
    s_and_b32 s64, s64, 7
    s_and_b32 s65, s35, 1
    s_cselect_b32 s56, s42, s40
    s_cselect_b32 s57, s43, s41
    s_and_b32 s57, s57, 0xffff
    s_mul_i32 s60, s64, 1152
    s_add_u32 s60, s60, 1024
    s_lshl_b32 s62, s33, 10
    s_add_u32 s62, s62, 49152
    v_lshrrev_b32 v70, 3, v0
    v_mul_u32_u24 v70, 9216, v70
    v_add_u32 v70, v70, v73
    s_add_u32 m0, s62, 0
    s_nop 0
    buffer_load_dwordx4 v70, s[56:59], s60 offen  lds
    s_add_u32 m0, s62, 4096
    s_add_u32 s60, s60, 294912
    buffer_load_dwordx4 v70, s[56:59], s60 offen  lds
    s_add_u32 m0, s62, 8192
    s_add_u32 s60, s60, 294912
    buffer_load_dwordx4 v70, s[56:59], s60 offen  lds
    s_add_u32 m0, s62, 12288
    s_add_u32 s60, s60, 294912
    buffer_load_dwordx4 v70, s[56:59], s60 offen  lds
    s_add_u32 m0, s62, 16384
    s_add_u32 s60, s60, 294912
    buffer_load_dwordx4 v70, s[56:59], s60 offen  lds
    s_add_u32 m0, s62, 20480
    s_add_u32 s60, s60, 294912
    buffer_load_dwordx4 v70, s[56:59], s60 offen  lds
    s_add_u32 m0, s62, 24576
    s_add_u32 s60, s60, 294912
    buffer_load_dwordx4 v70, s[56:59], s60 offen  lds
    s_add_u32 m0, s62, 28672
    s_add_u32 s60, s60, 294912
    buffer_load_dwordx4 v70, s[56:59], s60 offen  lds
    s_add_u32 m0, s62, 32768
    s_add_u32 s60, s60, 294912
    buffer_load_dwordx4 v70, s[56:59], s60 offen  lds
    s_add_u32 m0, s62, 36864
    s_add_u32 s60, s60, 294912
    buffer_load_dwordx4 v70, s[56:59], s60 offen  lds
    s_add_u32 m0, s62, 40960
    s_add_u32 s60, s60, 294912
    buffer_load_dwordx4 v70, s[56:59], s60 offen  lds
    s_add_u32 m0, s62, 45056
    s_add_u32 s60, s60, 294912
    buffer_load_dwordx4 v70, s[56:59], s60 offen  lds
    s_add_u32 m0, s62, 49152
    s_add_u32 s60, s60, 294912
    buffer_load_dwordx4 v70, s[56:59], s60 offen  lds
    s_add_u32 m0, s62, 53248
    s_add_u32 s60, s60, 294912
    buffer_load_dwordx4 v70, s[56:59], s60 offen  lds
    s_add_u32 m0, s62, 57344
    s_add_u32 s60, s60, 294912
    buffer_load_dwordx4 v70, s[56:59], s60 offen  lds
    s_add_u32 m0, s62, 61440
    s_add_u32 s60, s60, 294912
    buffer_load_dwordx4 v70, s[56:59], s60 offen  lds
    s_add_u32 m0, s62, 65536
    s_add_u32 s60, s60, 294912
    buffer_load_dwordx4 v70, s[56:59], s60 offen  lds
    s_add_u32 m0, s62, 69632
    s_add_u32 s60, s60, 294912
    buffer_load_dwordx4 v70, s[56:59], s60 offen  lds
    global_load_dword v31, v62, s[48:49] sc1
    s_lshl_b32 s4, s33, 5
    v_xor_b32 v8, s4, v14
    v_add_u32 v8, 49152, v8
    v_add_u32 v9, 36864, v8
    s_lshl_b32 s4, s64, 2
    s_add_u32 s4, s4, s33
    s_mul_i32 s4, s4, 36864
    s_lshl_b32 s5, s65, 10
    s_add_u32 s4, s4, s5
    s_add_u32 s12, s4, 0xc00000
    s_mov_b32 s22, 0x3f803f80
    v_mov_b32 v20, 0
    v_mov_b32 v21, 0
    s_waitcnt vmcnt(0)
    s_barrier
    ds_read_b64_tr_b16 v[80:81], v8 offset:0
    ds_read_b64_tr_b16 v[82:83], v8 offset:2048
    ds_read_b64_tr_b16 v[84:85], v8 offset:4096
    ds_read_b64_tr_b16 v[86:87], v8 offset:6144
    ds_read_b64_tr_b16 v[88:89], v8 offset:8192
    ds_read_b64_tr_b16 v[90:91], v8 offset:10240
    ds_read_b64_tr_b16 v[92:93], v8 offset:12288
    ds_read_b64_tr_b16 v[94:95], v8 offset:14336
    s_waitcnt lgkmcnt(6)
    v_dot2c_f32_bf16 v20, s22, v80
    v_dot2c_f32_bf16 v21, s22, v81
    v_dot2c_f32_bf16 v20, s22, v82
    v_dot2c_f32_bf16 v21, s22, v83
    ds_read_b64_tr_b16 v[96:97], v8 offset:16384
    ds_read_b64_tr_b16 v[98:99], v8 offset:18432
    s_waitcnt lgkmcnt(6)
    v_dot2c_f32_bf16 v20, s22, v84
    v_dot2c_f32_bf16 v21, s22, v85
    v_dot2c_f32_bf16 v20, s22, v86
    v_dot2c_f32_bf16 v21, s22, v87
    ds_read_b64_tr_b16 v[100:101], v8 offset:20480
    ds_read_b64_tr_b16 v[102:103], v8 offset:22528
    s_waitcnt lgkmcnt(6)
    v_dot2c_f32_bf16 v20, s22, v88
    v_dot2c_f32_bf16 v21, s22, v89
    v_dot2c_f32_bf16 v20, s22, v90
    v_dot2c_f32_bf16 v21, s22, v91
    ds_read_b64_tr_b16 v[104:105], v8 offset:24576
    ds_read_b64_tr_b16 v[106:107], v8 offset:26624
    s_waitcnt lgkmcnt(6)
    v_dot2c_f32_bf16 v20, s22, v92
    v_dot2c_f32_bf16 v21, s22, v93
    v_dot2c_f32_bf16 v20, s22, v94
    v_dot2c_f32_bf16 v21, s22, v95
    ds_read_b64_tr_b16 v[108:109], v8 offset:28672
    ds_read_b64_tr_b16 v[110:111], v8 offset:30720
    s_waitcnt lgkmcnt(6)
    v_dot2c_f32_bf16 v20, s22, v96
    v_dot2c_f32_bf16 v21, s22, v97
    v_dot2c_f32_bf16 v20, s22, v98
    v_dot2c_f32_bf16 v21, s22, v99
    ds_read_b64_tr_b16 v[112:113], v8 offset:32768
    ds_read_b64_tr_b16 v[114:115], v8 offset:34816
    s_waitcnt lgkmcnt(6)
    v_dot2c_f32_bf16 v20, s22, v100
    v_dot2c_f32_bf16 v21, s22, v101
    v_dot2c_f32_bf16 v20, s22, v102
    v_dot2c_f32_bf16 v21, s22, v103
    ds_read_b64_tr_b16 v[116:117], v9 offset:0
    ds_read_b64_tr_b16 v[118:119], v9 offset:2048
    s_waitcnt lgkmcnt(6)
    v_dot2c_f32_bf16 v20, s22, v104
    v_dot2c_f32_bf16 v21, s22, v105
    v_dot2c_f32_bf16 v20, s22, v106
    v_dot2c_f32_bf16 v21, s22, v107
    ds_read_b64_tr_b16 v[120:121], v9 offset:4096
    ds_read_b64_tr_b16 v[122:123], v9 offset:6144
    s_waitcnt lgkmcnt(6)
    v_dot2c_f32_bf16 v20, s22, v108
    v_dot2c_f32_bf16 v21, s22, v109
    v_dot2c_f32_bf16 v20, s22, v110
    v_dot2c_f32_bf16 v21, s22, v111
    ds_read_b64_tr_b16 v[124:125], v9 offset:8192
    ds_read_b64_tr_b16 v[126:127], v9 offset:10240
    s_waitcnt lgkmcnt(6)
    v_dot2c_f32_bf16 v20, s22, v112
    v_dot2c_f32_bf16 v21, s22, v113
    v_dot2c_f32_bf16 v20, s22, v114
    v_dot2c_f32_bf16 v21, s22, v115
    ds_read_b64_tr_b16 v[128:129], v9 offset:12288
    ds_read_b64_tr_b16 v[130:131], v9 offset:14336
    s_waitcnt lgkmcnt(6)
    v_dot2c_f32_bf16 v20, s22, v116
    v_dot2c_f32_bf16 v21, s22, v117
    v_dot2c_f32_bf16 v20, s22, v118
    v_dot2c_f32_bf16 v21, s22, v119
    ds_read_b64_tr_b16 v[132:133], v9 offset:16384
    ds_read_b64_tr_b16 v[134:135], v9 offset:18432
    s_waitcnt lgkmcnt(6)
    v_dot2c_f32_bf16 v20, s22, v120
    v_dot2c_f32_bf16 v21, s22, v121
    v_dot2c_f32_bf16 v20, s22, v122
    v_dot2c_f32_bf16 v21, s22, v123
    ds_read_b64_tr_b16 v[136:137], v9 offset:20480
    ds_read_b64_tr_b16 v[138:139], v9 offset:22528
    s_waitcnt lgkmcnt(6)
    v_dot2c_f32_bf16 v20, s22, v124
    v_dot2c_f32_bf16 v21, s22, v125
    v_dot2c_f32_bf16 v20, s22, v126
    v_dot2c_f32_bf16 v21, s22, v127
    ds_read_b64_tr_b16 v[140:141], v9 offset:24576
    ds_read_b64_tr_b16 v[142:143], v9 offset:26624
    s_waitcnt lgkmcnt(6)
    v_dot2c_f32_bf16 v20, s22, v128
    v_dot2c_f32_bf16 v21, s22, v129
    v_dot2c_f32_bf16 v20, s22, v130
    v_dot2c_f32_bf16 v21, s22, v131
    ds_read_b64_tr_b16 v[144:145], v9 offset:28672
    ds_read_b64_tr_b16 v[146:147], v9 offset:30720
    s_waitcnt lgkmcnt(6)
    v_dot2c_f32_bf16 v20, s22, v132
    v_dot2c_f32_bf16 v21, s22, v133
    v_dot2c_f32_bf16 v20, s22, v134
    v_dot2c_f32_bf16 v21, s22, v135
    ds_read_b64_tr_b16 v[148:149], v9 offset:32768
    ds_read_b64_tr_b16 v[150:151], v9 offset:34816
    s_waitcnt lgkmcnt(6)
    v_dot2c_f32_bf16 v20, s22, v136
    v_dot2c_f32_bf16 v21, s22, v137
    v_dot2c_f32_bf16 v20, s22, v138
    v_dot2c_f32_bf16 v21, s22, v139
    s_waitcnt lgkmcnt(4)
    v_dot2c_f32_bf16 v20, s22, v140
    v_dot2c_f32_bf16 v21, s22, v141
    v_dot2c_f32_bf16 v20, s22, v142
    v_dot2c_f32_bf16 v21, s22, v143
    s_waitcnt lgkmcnt(2)
    v_dot2c_f32_bf16 v20, s22, v144
    v_dot2c_f32_bf16 v21, s22, v145
    v_dot2c_f32_bf16 v20, s22, v146
    v_dot2c_f32_bf16 v21, s22, v147
    s_waitcnt lgkmcnt(0)
    v_dot2c_f32_bf16 v20, s22, v148
    v_dot2c_f32_bf16 v21, s22, v149
    v_dot2c_f32_bf16 v20, s22, v150
    v_dot2c_f32_bf16 v21, s22, v151
    s_nop 2
    v_add_f32 v20, v20, v21
    v_mov_b32 v21, v20
    s_nop 1
    v_permlane32_swap_b32 v20, v21
    v_add_f32 v20, v20, v21
    v_mov_b32 v21, v20
    s_nop 1
    v_permlane16_swap_b32 v20, v21
    v_add_f32 v20, v20, v21
    v_mul_f32 v20, 0xbae38e39, v20
    v_lshlrev_b32 v32, 16, v80
    v_and_b32 v33, s7, v80
    v_lshlrev_b32 v34, 16, v81
    v_and_b32 v35, s7, v81
    v_lshlrev_b32 v36, 16, v82
    v_and_b32 v37, s7, v82
    v_lshlrev_b32 v38, 16, v83
    v_and_b32 v39, s7, v83
    v_pk_add_f32 v[32:33], v[32:33], v[20:21] op_sel_hi:[1,0]
    v_pk_add_f32 v[34:35], v[34:35], v[20:21] op_sel_hi:[1,0]
    v_pk_add_f32 v[36:37], v[36:37], v[20:21] op_sel_hi:[1,0]
    v_pk_add_f32 v[38:39], v[38:39], v[20:21] op_sel_hi:[1,0]
    v_cvt_pk_bf16_f32 v80, v32, v33
    v_cvt_pk_bf16_f32 v81, v34, v35
    v_cvt_pk_bf16_f32 v82, v36, v37
    v_cvt_pk_bf16_f32 v83, v38, v39
    buffer_store_dwordx4 v[80:83], v16, s[28:31], s12 offen sc1
    s_add_u32 s12, s12, 2048
    v_lshlrev_b32 v32, 16, v84
    v_and_b32 v33, s7, v84
    v_lshlrev_b32 v34, 16, v85
    v_and_b32 v35, s7, v85
    v_lshlrev_b32 v36, 16, v86
    v_and_b32 v37, s7, v86
    v_lshlrev_b32 v38, 16, v87
    v_and_b32 v39, s7, v87
    v_pk_add_f32 v[32:33], v[32:33], v[20:21] op_sel_hi:[1,0]
    v_pk_add_f32 v[34:35], v[34:35], v[20:21] op_sel_hi:[1,0]
    v_pk_add_f32 v[36:37], v[36:37], v[20:21] op_sel_hi:[1,0]
    v_pk_add_f32 v[38:39], v[38:39], v[20:21] op_sel_hi:[1,0]
    v_cvt_pk_bf16_f32 v84, v32, v33
    v_cvt_pk_bf16_f32 v85, v34, v35
    v_cvt_pk_bf16_f32 v86, v36, v37
    v_cvt_pk_bf16_f32 v87, v38, v39
    buffer_store_dwordx4 v[84:87], v16, s[28:31], s12 offen sc1
    s_add_u32 s12, s12, 2048
    v_lshlrev_b32 v32, 16, v88
    v_and_b32 v33, s7, v88
    v_lshlrev_b32 v34, 16, v89
    v_and_b32 v35, s7, v89
    v_lshlrev_b32 v36, 16, v90
    v_and_b32 v37, s7, v90
    v_lshlrev_b32 v38, 16, v91
    v_and_b32 v39, s7, v91
    v_pk_add_f32 v[32:33], v[32:33], v[20:21] op_sel_hi:[1,0]
    v_pk_add_f32 v[34:35], v[34:35], v[20:21] op_sel_hi:[1,0]
    v_pk_add_f32 v[36:37], v[36:37], v[20:21] op_sel_hi:[1,0]
    v_pk_add_f32 v[38:39], v[38:39], v[20:21] op_sel_hi:[1,0]
    v_cvt_pk_bf16_f32 v88, v32, v33
    v_cvt_pk_bf16_f32 v89, v34, v35
    v_cvt_pk_bf16_f32 v90, v36, v37
    v_cvt_pk_bf16_f32 v91, v38, v39
    buffer_store_dwordx4 v[88:91], v16, s[28:31], s12 offen sc1
    s_add_u32 s12, s12, 2048
    v_lshlrev_b32 v32, 16, v92
    v_and_b32 v33, s7, v92
    v_lshlrev_b32 v34, 16, v93
    v_and_b32 v35, s7, v93
    v_lshlrev_b32 v36, 16, v94
    v_and_b32 v37, s7, v94
    v_lshlrev_b32 v38, 16, v95
    v_and_b32 v39, s7, v95
    v_pk_add_f32 v[32:33], v[32:33], v[20:21] op_sel_hi:[1,0]
    v_pk_add_f32 v[34:35], v[34:35], v[20:21] op_sel_hi:[1,0]
    v_pk_add_f32 v[36:37], v[36:37], v[20:21] op_sel_hi:[1,0]
    v_pk_add_f32 v[38:39], v[38:39], v[20:21] op_sel_hi:[1,0]
    v_cvt_pk_bf16_f32 v92, v32, v33
    v_cvt_pk_bf16_f32 v93, v34, v35
    v_cvt_pk_bf16_f32 v94, v36, v37
    v_cvt_pk_bf16_f32 v95, v38, v39
    buffer_store_dwordx4 v[92:95], v16, s[28:31], s12 offen sc1
    s_add_u32 s12, s12, 2048
    v_lshlrev_b32 v32, 16, v96
    v_and_b32 v33, s7, v96
    v_lshlrev_b32 v34, 16, v97
    v_and_b32 v35, s7, v97
    v_lshlrev_b32 v36, 16, v98
    v_and_b32 v37, s7, v98
    v_lshlrev_b32 v38, 16, v99
    v_and_b32 v39, s7, v99
    v_pk_add_f32 v[32:33], v[32:33], v[20:21] op_sel_hi:[1,0]
    v_pk_add_f32 v[34:35], v[34:35], v[20:21] op_sel_hi:[1,0]
    v_pk_add_f32 v[36:37], v[36:37], v[20:21] op_sel_hi:[1,0]
    v_pk_add_f32 v[38:39], v[38:39], v[20:21] op_sel_hi:[1,0]
    v_cvt_pk_bf16_f32 v96, v32, v33
    v_cvt_pk_bf16_f32 v97, v34, v35
    v_cvt_pk_bf16_f32 v98, v36, v37
    v_cvt_pk_bf16_f32 v99, v38, v39
    buffer_store_dwordx4 v[96:99], v16, s[28:31], s12 offen sc1
    s_add_u32 s12, s12, 2048
    v_lshlrev_b32 v32, 16, v100
    v_and_b32 v33, s7, v100
    v_lshlrev_b32 v34, 16, v101
    v_and_b32 v35, s7, v101
    v_lshlrev_b32 v36, 16, v102
    v_and_b32 v37, s7, v102
    v_lshlrev_b32 v38, 16, v103
    v_and_b32 v39, s7, v103
    v_pk_add_f32 v[32:33], v[32:33], v[20:21] op_sel_hi:[1,0]
    v_pk_add_f32 v[34:35], v[34:35], v[20:21] op_sel_hi:[1,0]
    v_pk_add_f32 v[36:37], v[36:37], v[20:21] op_sel_hi:[1,0]
    v_pk_add_f32 v[38:39], v[38:39], v[20:21] op_sel_hi:[1,0]
    v_cvt_pk_bf16_f32 v100, v32, v33
    v_cvt_pk_bf16_f32 v101, v34, v35
    v_cvt_pk_bf16_f32 v102, v36, v37
    v_cvt_pk_bf16_f32 v103, v38, v39
    buffer_store_dwordx4 v[100:103], v16, s[28:31], s12 offen sc1
    s_add_u32 s12, s12, 2048
    v_lshlrev_b32 v32, 16, v104
    v_and_b32 v33, s7, v104
    v_lshlrev_b32 v34, 16, v105
    v_and_b32 v35, s7, v105
    v_lshlrev_b32 v36, 16, v106
    v_and_b32 v37, s7, v106
    v_lshlrev_b32 v38, 16, v107
    v_and_b32 v39, s7, v107
    v_pk_add_f32 v[32:33], v[32:33], v[20:21] op_sel_hi:[1,0]
    v_pk_add_f32 v[34:35], v[34:35], v[20:21] op_sel_hi:[1,0]
    v_pk_add_f32 v[36:37], v[36:37], v[20:21] op_sel_hi:[1,0]
    v_pk_add_f32 v[38:39], v[38:39], v[20:21] op_sel_hi:[1,0]
    v_cvt_pk_bf16_f32 v104, v32, v33
    v_cvt_pk_bf16_f32 v105, v34, v35
    v_cvt_pk_bf16_f32 v106, v36, v37
    v_cvt_pk_bf16_f32 v107, v38, v39
    buffer_store_dwordx4 v[104:107], v16, s[28:31], s12 offen sc1
    s_add_u32 s12, s12, 2048
    v_lshlrev_b32 v32, 16, v108
    v_and_b32 v33, s7, v108
    v_lshlrev_b32 v34, 16, v109
    v_and_b32 v35, s7, v109
    v_lshlrev_b32 v36, 16, v110
    v_and_b32 v37, s7, v110
    v_lshlrev_b32 v38, 16, v111
    v_and_b32 v39, s7, v111
    v_pk_add_f32 v[32:33], v[32:33], v[20:21] op_sel_hi:[1,0]
    v_pk_add_f32 v[34:35], v[34:35], v[20:21] op_sel_hi:[1,0]
    v_pk_add_f32 v[36:37], v[36:37], v[20:21] op_sel_hi:[1,0]
    v_pk_add_f32 v[38:39], v[38:39], v[20:21] op_sel_hi:[1,0]
    v_cvt_pk_bf16_f32 v108, v32, v33
    v_cvt_pk_bf16_f32 v109, v34, v35
    v_cvt_pk_bf16_f32 v110, v36, v37
    v_cvt_pk_bf16_f32 v111, v38, v39
    buffer_store_dwordx4 v[108:111], v16, s[28:31], s12 offen sc1
    s_add_u32 s12, s12, 2048
    v_lshlrev_b32 v32, 16, v112
    v_and_b32 v33, s7, v112
    v_lshlrev_b32 v34, 16, v113
    v_and_b32 v35, s7, v113
    v_lshlrev_b32 v36, 16, v114
    v_and_b32 v37, s7, v114
    v_lshlrev_b32 v38, 16, v115
    v_and_b32 v39, s7, v115
    v_pk_add_f32 v[32:33], v[32:33], v[20:21] op_sel_hi:[1,0]
    v_pk_add_f32 v[34:35], v[34:35], v[20:21] op_sel_hi:[1,0]
    v_pk_add_f32 v[36:37], v[36:37], v[20:21] op_sel_hi:[1,0]
    v_pk_add_f32 v[38:39], v[38:39], v[20:21] op_sel_hi:[1,0]
    v_cvt_pk_bf16_f32 v112, v32, v33
    v_cvt_pk_bf16_f32 v113, v34, v35
    v_cvt_pk_bf16_f32 v114, v36, v37
    v_cvt_pk_bf16_f32 v115, v38, v39
    buffer_store_dwordx4 v[112:115], v16, s[28:31], s12 offen sc1
    s_add_u32 s12, s12, 2048
    v_lshlrev_b32 v32, 16, v116
    v_and_b32 v33, s7, v116
    v_lshlrev_b32 v34, 16, v117
    v_and_b32 v35, s7, v117
    v_lshlrev_b32 v36, 16, v118
    v_and_b32 v37, s7, v118
    v_lshlrev_b32 v38, 16, v119
    v_and_b32 v39, s7, v119
    v_pk_add_f32 v[32:33], v[32:33], v[20:21] op_sel_hi:[1,0]
    v_pk_add_f32 v[34:35], v[34:35], v[20:21] op_sel_hi:[1,0]
    v_pk_add_f32 v[36:37], v[36:37], v[20:21] op_sel_hi:[1,0]
    v_pk_add_f32 v[38:39], v[38:39], v[20:21] op_sel_hi:[1,0]
    v_cvt_pk_bf16_f32 v116, v32, v33
    v_cvt_pk_bf16_f32 v117, v34, v35
    v_cvt_pk_bf16_f32 v118, v36, v37
    v_cvt_pk_bf16_f32 v119, v38, v39
    buffer_store_dwordx4 v[116:119], v16, s[28:31], s12 offen sc1
    s_add_u32 s12, s12, 2048
    v_lshlrev_b32 v32, 16, v120
    v_and_b32 v33, s7, v120
    v_lshlrev_b32 v34, 16, v121
    v_and_b32 v35, s7, v121
    v_lshlrev_b32 v36, 16, v122
    v_and_b32 v37, s7, v122
    v_lshlrev_b32 v38, 16, v123
    v_and_b32 v39, s7, v123
    v_pk_add_f32 v[32:33], v[32:33], v[20:21] op_sel_hi:[1,0]
    v_pk_add_f32 v[34:35], v[34:35], v[20:21] op_sel_hi:[1,0]
    v_pk_add_f32 v[36:37], v[36:37], v[20:21] op_sel_hi:[1,0]
    v_pk_add_f32 v[38:39], v[38:39], v[20:21] op_sel_hi:[1,0]
    v_cvt_pk_bf16_f32 v120, v32, v33
    v_cvt_pk_bf16_f32 v121, v34, v35
    v_cvt_pk_bf16_f32 v122, v36, v37
    v_cvt_pk_bf16_f32 v123, v38, v39
    buffer_store_dwordx4 v[120:123], v16, s[28:31], s12 offen sc1
    s_add_u32 s12, s12, 2048
    v_lshlrev_b32 v32, 16, v124
    v_and_b32 v33, s7, v124
    v_lshlrev_b32 v34, 16, v125
    v_and_b32 v35, s7, v125
    v_lshlrev_b32 v36, 16, v126
    v_and_b32 v37, s7, v126
    v_lshlrev_b32 v38, 16, v127
    v_and_b32 v39, s7, v127
    v_pk_add_f32 v[32:33], v[32:33], v[20:21] op_sel_hi:[1,0]
    v_pk_add_f32 v[34:35], v[34:35], v[20:21] op_sel_hi:[1,0]
    v_pk_add_f32 v[36:37], v[36:37], v[20:21] op_sel_hi:[1,0]
    v_pk_add_f32 v[38:39], v[38:39], v[20:21] op_sel_hi:[1,0]
    v_cvt_pk_bf16_f32 v124, v32, v33
    v_cvt_pk_bf16_f32 v125, v34, v35
    v_cvt_pk_bf16_f32 v126, v36, v37
    v_cvt_pk_bf16_f32 v127, v38, v39
    buffer_store_dwordx4 v[124:127], v16, s[28:31], s12 offen sc1
    s_add_u32 s12, s12, 2048
    v_lshlrev_b32 v32, 16, v128
    v_and_b32 v33, s7, v128
    v_lshlrev_b32 v34, 16, v129
    v_and_b32 v35, s7, v129
    v_lshlrev_b32 v36, 16, v130
    v_and_b32 v37, s7, v130
    v_lshlrev_b32 v38, 16, v131
    v_and_b32 v39, s7, v131
    v_pk_add_f32 v[32:33], v[32:33], v[20:21] op_sel_hi:[1,0]
    v_pk_add_f32 v[34:35], v[34:35], v[20:21] op_sel_hi:[1,0]
    v_pk_add_f32 v[36:37], v[36:37], v[20:21] op_sel_hi:[1,0]
    v_pk_add_f32 v[38:39], v[38:39], v[20:21] op_sel_hi:[1,0]
    v_cvt_pk_bf16_f32 v128, v32, v33
    v_cvt_pk_bf16_f32 v129, v34, v35
    v_cvt_pk_bf16_f32 v130, v36, v37
    v_cvt_pk_bf16_f32 v131, v38, v39
    buffer_store_dwordx4 v[128:131], v16, s[28:31], s12 offen sc1
    s_add_u32 s12, s12, 2048
    v_lshlrev_b32 v32, 16, v132
    v_and_b32 v33, s7, v132
    v_lshlrev_b32 v34, 16, v133
    v_and_b32 v35, s7, v133
    v_lshlrev_b32 v36, 16, v134
    v_and_b32 v37, s7, v134
    v_lshlrev_b32 v38, 16, v135
    v_and_b32 v39, s7, v135
    v_pk_add_f32 v[32:33], v[32:33], v[20:21] op_sel_hi:[1,0]
    v_pk_add_f32 v[34:35], v[34:35], v[20:21] op_sel_hi:[1,0]
    v_pk_add_f32 v[36:37], v[36:37], v[20:21] op_sel_hi:[1,0]
    v_pk_add_f32 v[38:39], v[38:39], v[20:21] op_sel_hi:[1,0]
    v_cvt_pk_bf16_f32 v132, v32, v33
    v_cvt_pk_bf16_f32 v133, v34, v35
    v_cvt_pk_bf16_f32 v134, v36, v37
    v_cvt_pk_bf16_f32 v135, v38, v39
    buffer_store_dwordx4 v[132:135], v16, s[28:31], s12 offen sc1
    s_add_u32 s12, s12, 2048
    v_lshlrev_b32 v32, 16, v136
    v_and_b32 v33, s7, v136
    v_lshlrev_b32 v34, 16, v137
    v_and_b32 v35, s7, v137
    v_lshlrev_b32 v36, 16, v138
    v_and_b32 v37, s7, v138
    v_lshlrev_b32 v38, 16, v139
    v_and_b32 v39, s7, v139
    v_pk_add_f32 v[32:33], v[32:33], v[20:21] op_sel_hi:[1,0]
    v_pk_add_f32 v[34:35], v[34:35], v[20:21] op_sel_hi:[1,0]
    v_pk_add_f32 v[36:37], v[36:37], v[20:21] op_sel_hi:[1,0]
    v_pk_add_f32 v[38:39], v[38:39], v[20:21] op_sel_hi:[1,0]
    v_cvt_pk_bf16_f32 v136, v32, v33
    v_cvt_pk_bf16_f32 v137, v34, v35
    v_cvt_pk_bf16_f32 v138, v36, v37
    v_cvt_pk_bf16_f32 v139, v38, v39
    buffer_store_dwordx4 v[136:139], v16, s[28:31], s12 offen sc1
    s_add_u32 s12, s12, 2048
    v_lshlrev_b32 v32, 16, v140
    v_and_b32 v33, s7, v140
    v_lshlrev_b32 v34, 16, v141
    v_and_b32 v35, s7, v141
    v_lshlrev_b32 v36, 16, v142
    v_and_b32 v37, s7, v142
    v_lshlrev_b32 v38, 16, v143
    v_and_b32 v39, s7, v143
    v_pk_add_f32 v[32:33], v[32:33], v[20:21] op_sel_hi:[1,0]
    v_pk_add_f32 v[34:35], v[34:35], v[20:21] op_sel_hi:[1,0]
    v_pk_add_f32 v[36:37], v[36:37], v[20:21] op_sel_hi:[1,0]
    v_pk_add_f32 v[38:39], v[38:39], v[20:21] op_sel_hi:[1,0]
    v_cvt_pk_bf16_f32 v140, v32, v33
    v_cvt_pk_bf16_f32 v141, v34, v35
    v_cvt_pk_bf16_f32 v142, v36, v37
    v_cvt_pk_bf16_f32 v143, v38, v39
    buffer_store_dwordx4 v[140:143], v16, s[28:31], s12 offen sc1
    s_add_u32 s12, s12, 2048
    v_lshlrev_b32 v32, 16, v144
    v_and_b32 v33, s7, v144
    v_lshlrev_b32 v34, 16, v145
    v_and_b32 v35, s7, v145
    v_lshlrev_b32 v36, 16, v146
    v_and_b32 v37, s7, v146
    v_lshlrev_b32 v38, 16, v147
    v_and_b32 v39, s7, v147
    v_pk_add_f32 v[32:33], v[32:33], v[20:21] op_sel_hi:[1,0]
    v_pk_add_f32 v[34:35], v[34:35], v[20:21] op_sel_hi:[1,0]
    v_pk_add_f32 v[36:37], v[36:37], v[20:21] op_sel_hi:[1,0]
    v_pk_add_f32 v[38:39], v[38:39], v[20:21] op_sel_hi:[1,0]
    v_cvt_pk_bf16_f32 v144, v32, v33
    v_cvt_pk_bf16_f32 v145, v34, v35
    v_cvt_pk_bf16_f32 v146, v36, v37
    v_cvt_pk_bf16_f32 v147, v38, v39
    buffer_store_dwordx4 v[144:147], v16, s[28:31], s12 offen sc1
    s_add_u32 s12, s12, 2048
    v_lshlrev_b32 v32, 16, v148
    v_and_b32 v33, s7, v148
    v_lshlrev_b32 v34, 16, v149
    v_and_b32 v35, s7, v149
    v_lshlrev_b32 v36, 16, v150
    v_and_b32 v37, s7, v150
    v_lshlrev_b32 v38, 16, v151
    v_and_b32 v39, s7, v151
    v_pk_add_f32 v[32:33], v[32:33], v[20:21] op_sel_hi:[1,0]
    v_pk_add_f32 v[34:35], v[34:35], v[20:21] op_sel_hi:[1,0]
    v_pk_add_f32 v[36:37], v[36:37], v[20:21] op_sel_hi:[1,0]
    v_pk_add_f32 v[38:39], v[38:39], v[20:21] op_sel_hi:[1,0]
    v_cvt_pk_bf16_f32 v148, v32, v33
    v_cvt_pk_bf16_f32 v149, v34, v35
    v_cvt_pk_bf16_f32 v150, v36, v37
    v_cvt_pk_bf16_f32 v151, v38, v39
    buffer_store_dwordx4 v[148:151], v16, s[28:31], s12 offen sc1
    s_add_u32 s12, s12, 2048
    s_branch sequential_preLN__ssm_conv_s4__glu_gated_bilinear__prompt_kernel_tail
sequential_preLN__ssm_conv_s4__glu_gated_bilinear__prompt_kernel_csum:
    s_and_b32 s64, s54, 7
    s_lshr_b32 s63, s54, 4
    s_bfe_u32 s65, s54, 0x10003
    s_cselect_b32 s56, s42, s40
    s_cselect_b32 s57, s43, s41
    s_and_b32 s57, s57, 0xffff
    s_mul_i32 s60, s63, 96
    s_cmp_eq_u32 s63, 5
    s_cselect_b32 s60, 480, s60
    s_add_u32 s60, s60, s33
    s_mul_i32 s60, s60, 9216
    s_mul_i32 s4, s64, 1152
    s_add_u32 s60, s60, s4
    global_load_dword v29, v62, s[48:49] sc1
    s_movk_i32 s22, 0x3f80
    s_mov_b32 s23, 0x3f800000
    v_mov_b32 v20, 0
    v_mov_b32 v21, 0
    v_mov_b32 v22, 0
    v_mov_b32 v23, 0
    v_mov_b32 v24, 0
    v_mov_b32 v25, 0
    v_mov_b32 v26, 0
    v_mov_b32 v27, 0
    buffer_load_dwordx4 v[80:83], v16, s[56:59], s60 offen
    s_add_u32 s60, s60, 36864
    buffer_load_dwordx4 v[84:87], v16, s[56:59], s60 offen
    s_add_u32 s60, s60, 36864
    buffer_load_dwordx4 v[88:91], v16, s[56:59], s60 offen
    s_add_u32 s60, s60, 36864
    buffer_load_dwordx4 v[92:95], v16, s[56:59], s60 offen
    s_add_u32 s60, s60, 36864
    buffer_load_dwordx4 v[96:99], v16, s[56:59], s60 offen
    s_add_u32 s60, s60, 36864
    buffer_load_dwordx4 v[100:103], v16, s[56:59], s60 offen
    s_add_u32 s60, s60, 36864
    buffer_load_dwordx4 v[104:107], v16, s[56:59], s60 offen
    s_add_u32 s60, s60, 36864
    buffer_load_dwordx4 v[108:111], v16, s[56:59], s60 offen
    s_add_u32 s60, s60, 36864
    buffer_load_dwordx4 v[112:115], v16, s[56:59], s60 offen
    s_add_u32 s60, s60, 36864
    buffer_load_dwordx4 v[116:119], v16, s[56:59], s60 offen
    s_add_u32 s60, s60, 36864
    buffer_load_dwordx4 v[120:123], v16, s[56:59], s60 offen
    s_add_u32 s60, s60, 36864
    buffer_load_dwordx4 v[124:127], v16, s[56:59], s60 offen
    s_add_u32 s60, s60, 36864
    buffer_load_dwordx4 v[128:131], v16, s[56:59], s60 offen
    s_add_u32 s60, s60, 36864
    s_waitcnt vmcnt(12)
    v_dot2c_f32_bf16 v20, s22, v80
    v_dot2c_f32_bf16 v21, s23, v80
    v_dot2c_f32_bf16 v22, s22, v81
    v_dot2c_f32_bf16 v23, s23, v81
    v_dot2c_f32_bf16 v24, s22, v82
    v_dot2c_f32_bf16 v25, s23, v82
    v_dot2c_f32_bf16 v26, s22, v83
    v_dot2c_f32_bf16 v27, s23, v83
    buffer_load_dwordx4 v[132:135], v16, s[56:59], s60 offen
    s_add_u32 s60, s60, 36864
    s_waitcnt vmcnt(12)
    v_dot2c_f32_bf16 v20, s22, v84
    v_dot2c_f32_bf16 v21, s23, v84
    v_dot2c_f32_bf16 v22, s22, v85
    v_dot2c_f32_bf16 v23, s23, v85
    v_dot2c_f32_bf16 v24, s22, v86
    v_dot2c_f32_bf16 v25, s23, v86
    v_dot2c_f32_bf16 v26, s22, v87
    v_dot2c_f32_bf16 v27, s23, v87
    buffer_load_dwordx4 v[136:139], v16, s[56:59], s60 offen
    s_add_u32 s60, s60, 36864
    s_waitcnt vmcnt(12)
    v_dot2c_f32_bf16 v20, s22, v88
    v_dot2c_f32_bf16 v21, s23, v88
    v_dot2c_f32_bf16 v22, s22, v89
    v_dot2c_f32_bf16 v23, s23, v89
    v_dot2c_f32_bf16 v24, s22, v90
    v_dot2c_f32_bf16 v25, s23, v90
    v_dot2c_f32_bf16 v26, s22, v91
    v_dot2c_f32_bf16 v27, s23, v91
    buffer_load_dwordx4 v[140:143], v16, s[56:59], s60 offen
    s_add_u32 s60, s60, 36864
    s_waitcnt vmcnt(12)
    v_dot2c_f32_bf16 v20, s22, v92
    v_dot2c_f32_bf16 v21, s23, v92
    v_dot2c_f32_bf16 v22, s22, v93
    v_dot2c_f32_bf16 v23, s23, v93
    v_dot2c_f32_bf16 v24, s22, v94
    v_dot2c_f32_bf16 v25, s23, v94
    v_dot2c_f32_bf16 v26, s22, v95
    v_dot2c_f32_bf16 v27, s23, v95
    buffer_load_dwordx4 v[144:147], v16, s[56:59], s60 offen
    s_add_u32 s60, s60, 36864
    s_waitcnt vmcnt(12)
    v_dot2c_f32_bf16 v20, s22, v96
    v_dot2c_f32_bf16 v21, s23, v96
    v_dot2c_f32_bf16 v22, s22, v97
    v_dot2c_f32_bf16 v23, s23, v97
    v_dot2c_f32_bf16 v24, s22, v98
    v_dot2c_f32_bf16 v25, s23, v98
    v_dot2c_f32_bf16 v26, s22, v99
    v_dot2c_f32_bf16 v27, s23, v99
    buffer_load_dwordx4 v[148:151], v16, s[56:59], s60 offen
    s_add_u32 s60, s60, 36864
    s_waitcnt vmcnt(12)
    v_dot2c_f32_bf16 v20, s22, v100
    v_dot2c_f32_bf16 v21, s23, v100
    v_dot2c_f32_bf16 v22, s22, v101
    v_dot2c_f32_bf16 v23, s23, v101
    v_dot2c_f32_bf16 v24, s22, v102
    v_dot2c_f32_bf16 v25, s23, v102
    v_dot2c_f32_bf16 v26, s22, v103
    v_dot2c_f32_bf16 v27, s23, v103
    buffer_load_dwordx4 v[152:155], v16, s[56:59], s60 offen
    s_add_u32 s60, s60, 36864
    s_waitcnt vmcnt(12)
    v_dot2c_f32_bf16 v20, s22, v104
    v_dot2c_f32_bf16 v21, s23, v104
    v_dot2c_f32_bf16 v22, s22, v105
    v_dot2c_f32_bf16 v23, s23, v105
    v_dot2c_f32_bf16 v24, s22, v106
    v_dot2c_f32_bf16 v25, s23, v106
    v_dot2c_f32_bf16 v26, s22, v107
    v_dot2c_f32_bf16 v27, s23, v107
    buffer_load_dwordx4 v[156:159], v16, s[56:59], s60 offen
    s_add_u32 s60, s60, 36864
    s_waitcnt vmcnt(12)
    v_dot2c_f32_bf16 v20, s22, v108
    v_dot2c_f32_bf16 v21, s23, v108
    v_dot2c_f32_bf16 v22, s22, v109
    v_dot2c_f32_bf16 v23, s23, v109
    v_dot2c_f32_bf16 v24, s22, v110
    v_dot2c_f32_bf16 v25, s23, v110
    v_dot2c_f32_bf16 v26, s22, v111
    v_dot2c_f32_bf16 v27, s23, v111
    buffer_load_dwordx4 v[160:163], v16, s[56:59], s60 offen
    s_add_u32 s60, s60, 36864
    s_waitcnt vmcnt(12)
    v_dot2c_f32_bf16 v20, s22, v112
    v_dot2c_f32_bf16 v21, s23, v112
    v_dot2c_f32_bf16 v22, s22, v113
    v_dot2c_f32_bf16 v23, s23, v113
    v_dot2c_f32_bf16 v24, s22, v114
    v_dot2c_f32_bf16 v25, s23, v114
    v_dot2c_f32_bf16 v26, s22, v115
    v_dot2c_f32_bf16 v27, s23, v115
    buffer_load_dwordx4 v[164:167], v16, s[56:59], s60 offen
    s_add_u32 s60, s60, 36864
    s_waitcnt vmcnt(12)
    v_dot2c_f32_bf16 v20, s22, v116
    v_dot2c_f32_bf16 v21, s23, v116
    v_dot2c_f32_bf16 v22, s22, v117
    v_dot2c_f32_bf16 v23, s23, v117
    v_dot2c_f32_bf16 v24, s22, v118
    v_dot2c_f32_bf16 v25, s23, v118
    v_dot2c_f32_bf16 v26, s22, v119
    v_dot2c_f32_bf16 v27, s23, v119
    buffer_load_dwordx4 v[168:171], v16, s[56:59], s60 offen
    s_add_u32 s60, s60, 36864
    s_waitcnt vmcnt(12)
    v_dot2c_f32_bf16 v20, s22, v120
    v_dot2c_f32_bf16 v21, s23, v120
    v_dot2c_f32_bf16 v22, s22, v121
    v_dot2c_f32_bf16 v23, s23, v121
    v_dot2c_f32_bf16 v24, s22, v122
    v_dot2c_f32_bf16 v25, s23, v122
    v_dot2c_f32_bf16 v26, s22, v123
    v_dot2c_f32_bf16 v27, s23, v123
    buffer_load_dwordx4 v[172:175], v16, s[56:59], s60 offen
    s_add_u32 s60, s60, 36864
    s_waitcnt vmcnt(12)
    v_dot2c_f32_bf16 v20, s22, v124
    v_dot2c_f32_bf16 v21, s23, v124
    v_dot2c_f32_bf16 v22, s22, v125
    v_dot2c_f32_bf16 v23, s23, v125
    v_dot2c_f32_bf16 v24, s22, v126
    v_dot2c_f32_bf16 v25, s23, v126
    v_dot2c_f32_bf16 v26, s22, v127
    v_dot2c_f32_bf16 v27, s23, v127
    s_waitcnt vmcnt(11)
    v_dot2c_f32_bf16 v20, s22, v128
    v_dot2c_f32_bf16 v21, s23, v128
    v_dot2c_f32_bf16 v22, s22, v129
    v_dot2c_f32_bf16 v23, s23, v129
    v_dot2c_f32_bf16 v24, s22, v130
    v_dot2c_f32_bf16 v25, s23, v130
    v_dot2c_f32_bf16 v26, s22, v131
    v_dot2c_f32_bf16 v27, s23, v131
    s_waitcnt vmcnt(10)
    v_dot2c_f32_bf16 v20, s22, v132
    v_dot2c_f32_bf16 v21, s23, v132
    v_dot2c_f32_bf16 v22, s22, v133
    v_dot2c_f32_bf16 v23, s23, v133
    v_dot2c_f32_bf16 v24, s22, v134
    v_dot2c_f32_bf16 v25, s23, v134
    v_dot2c_f32_bf16 v26, s22, v135
    v_dot2c_f32_bf16 v27, s23, v135
    s_waitcnt vmcnt(9)
    v_dot2c_f32_bf16 v20, s22, v136
    v_dot2c_f32_bf16 v21, s23, v136
    v_dot2c_f32_bf16 v22, s22, v137
    v_dot2c_f32_bf16 v23, s23, v137
    v_dot2c_f32_bf16 v24, s22, v138
    v_dot2c_f32_bf16 v25, s23, v138
    v_dot2c_f32_bf16 v26, s22, v139
    v_dot2c_f32_bf16 v27, s23, v139
    s_waitcnt vmcnt(8)
    v_dot2c_f32_bf16 v20, s22, v140
    v_dot2c_f32_bf16 v21, s23, v140
    v_dot2c_f32_bf16 v22, s22, v141
    v_dot2c_f32_bf16 v23, s23, v141
    v_dot2c_f32_bf16 v24, s22, v142
    v_dot2c_f32_bf16 v25, s23, v142
    v_dot2c_f32_bf16 v26, s22, v143
    v_dot2c_f32_bf16 v27, s23, v143
    s_waitcnt vmcnt(7)
    v_dot2c_f32_bf16 v20, s22, v144
    v_dot2c_f32_bf16 v21, s23, v144
    v_dot2c_f32_bf16 v22, s22, v145
    v_dot2c_f32_bf16 v23, s23, v145
    v_dot2c_f32_bf16 v24, s22, v146
    v_dot2c_f32_bf16 v25, s23, v146
    v_dot2c_f32_bf16 v26, s22, v147
    v_dot2c_f32_bf16 v27, s23, v147
    s_waitcnt vmcnt(6)
    v_dot2c_f32_bf16 v20, s22, v148
    v_dot2c_f32_bf16 v21, s23, v148
    v_dot2c_f32_bf16 v22, s22, v149
    v_dot2c_f32_bf16 v23, s23, v149
    v_dot2c_f32_bf16 v24, s22, v150
    v_dot2c_f32_bf16 v25, s23, v150
    v_dot2c_f32_bf16 v26, s22, v151
    v_dot2c_f32_bf16 v27, s23, v151
    s_waitcnt vmcnt(5)
    v_dot2c_f32_bf16 v20, s22, v152
    v_dot2c_f32_bf16 v21, s23, v152
    v_dot2c_f32_bf16 v22, s22, v153
    v_dot2c_f32_bf16 v23, s23, v153
    v_dot2c_f32_bf16 v24, s22, v154
    v_dot2c_f32_bf16 v25, s23, v154
    v_dot2c_f32_bf16 v26, s22, v155
    v_dot2c_f32_bf16 v27, s23, v155
    s_waitcnt vmcnt(4)
    v_dot2c_f32_bf16 v20, s22, v156
    v_dot2c_f32_bf16 v21, s23, v156
    v_dot2c_f32_bf16 v22, s22, v157
    v_dot2c_f32_bf16 v23, s23, v157
    v_dot2c_f32_bf16 v24, s22, v158
    v_dot2c_f32_bf16 v25, s23, v158
    v_dot2c_f32_bf16 v26, s22, v159
    v_dot2c_f32_bf16 v27, s23, v159
    s_waitcnt vmcnt(3)
    v_dot2c_f32_bf16 v20, s22, v160
    v_dot2c_f32_bf16 v21, s23, v160
    v_dot2c_f32_bf16 v22, s22, v161
    v_dot2c_f32_bf16 v23, s23, v161
    v_dot2c_f32_bf16 v24, s22, v162
    v_dot2c_f32_bf16 v25, s23, v162
    v_dot2c_f32_bf16 v26, s22, v163
    v_dot2c_f32_bf16 v27, s23, v163
    s_waitcnt vmcnt(2)
    v_dot2c_f32_bf16 v20, s22, v164
    v_dot2c_f32_bf16 v21, s23, v164
    v_dot2c_f32_bf16 v22, s22, v165
    v_dot2c_f32_bf16 v23, s23, v165
    v_dot2c_f32_bf16 v24, s22, v166
    v_dot2c_f32_bf16 v25, s23, v166
    v_dot2c_f32_bf16 v26, s22, v167
    v_dot2c_f32_bf16 v27, s23, v167
    s_waitcnt vmcnt(1)
    v_dot2c_f32_bf16 v20, s22, v168
    v_dot2c_f32_bf16 v21, s23, v168
    v_dot2c_f32_bf16 v22, s22, v169
    v_dot2c_f32_bf16 v23, s23, v169
    v_dot2c_f32_bf16 v24, s22, v170
    v_dot2c_f32_bf16 v25, s23, v170
    v_dot2c_f32_bf16 v26, s22, v171
    v_dot2c_f32_bf16 v27, s23, v171
    s_waitcnt vmcnt(0)
    v_dot2c_f32_bf16 v20, s22, v172
    v_dot2c_f32_bf16 v21, s23, v172
    v_dot2c_f32_bf16 v22, s22, v173
    v_dot2c_f32_bf16 v23, s23, v173
    v_dot2c_f32_bf16 v24, s22, v174
    v_dot2c_f32_bf16 v25, s23, v174
    v_dot2c_f32_bf16 v26, s22, v175
    v_dot2c_f32_bf16 v27, s23, v175
    s_cmp_ge_u32 s54, 16
    s_cbranch_scc1 sequential_preLN__ssm_conv_s4__glu_gated_bilinear__prompt_kernel_nocp2
    s_lshr_b32 s4, s54, 3
    s_lshl_b32 s4, s4, 2
    s_add_u32 s4, s4, s33
    s_getpc_b64 s[18:19]
sequential_preLN__ssm_conv_s4__glu_gated_bilinear__prompt_kernel_cp2:
    s_add_u32 s18, s18, ffn-sequential_preLN__ssm_conv_s4__glu_gated_bilinear__prompt_kernel_cp2
    s_addc_u32 s19, s19, 0
    v_lshl_add_u32 v5, s4, 6, v1
    v_lshlrev_b32 v5, 7, v5
    v_min_u32 v5, ffn_last-ffn-4, v5
    global_load_dword v60, v5, s[18:19]
sequential_preLN__ssm_conv_s4__glu_gated_bilinear__prompt_kernel_nocp2:
    v_mov_b32 v31, v29
    v_lshlrev_b32 v5, 5, v0
    ds_write_b128 v5, v[20:23] offset:49152
    ds_write_b128 v5, v[24:27] offset:49168
    v_lshlrev_b32 v6, 3, v0
    s_mul_i32 s4, s65, 18432
    s_mul_i32 s5, s64, 2304
    s_add_u32 s4, s4, s5
    s_mul_i32 s5, s63, 36864
    s_add_u32 s4, s4, s5
    s_add_u32 s4, s4, 0x480000
    s_waitcnt lgkmcnt(0)
    s_barrier
    ds_read_b64 v[32:33], v6 offset:49152
    ds_read_b64 v[34:35], v6 offset:51200
    ds_read_b64 v[36:37], v6 offset:53248
    ds_read_b64 v[38:39], v6 offset:55296
    s_waitcnt lgkmcnt(0)
    v_pk_add_f32 v[32:33], v[32:33], v[34:35]
    v_pk_add_f32 v[36:37], v[36:37], v[38:39]
    v_pk_add_f32 v[32:33], v[32:33], v[36:37]
    v_mul_f32 v32, 0xbae38e39, v32
    v_mul_f32 v33, 0xbae38e39, v33
    buffer_store_dwordx2 v[32:33], v6, s[28:31], s4 offen sc1
sequential_preLN__ssm_conv_s4__glu_gated_bilinear__prompt_kernel_tail:
    v_cmp_ne_u32 vcc, 0, v31
    s_cbranch_vccz sequential_preLN__ssm_conv_s4__glu_gated_bilinear__prompt_kernel_tag2_s
sequential_preLN__ssm_conv_s4__glu_gated_bilinear__prompt_kernel_tag2_b:
    s_branch ffn_bg
sequential_preLN__ssm_conv_s4__glu_gated_bilinear__prompt_kernel_tag1_s:
    s_mov_b32 s4, 0x100000
sequential_preLN__ssm_conv_s4__glu_gated_bilinear__prompt_kernel_tag1_l:
    s_sub_u32 s4, s4, 1
    s_cbranch_scc1 sequential_preLN__ssm_conv_s4__glu_gated_bilinear__prompt_kernel_tag1_b
    global_load_dword v31, v62, s[48:49] sc1
    s_sleep 4
    s_waitcnt vmcnt(0)
    v_cmp_ne_u32 vcc, 0, v31
    s_cbranch_vccz sequential_preLN__ssm_conv_s4__glu_gated_bilinear__prompt_kernel_tag1_l
    s_branch sequential_preLN__ssm_conv_s4__glu_gated_bilinear__prompt_kernel_tag1_b
sequential_preLN__ssm_conv_s4__glu_gated_bilinear__prompt_kernel_tag2_s:
    s_mov_b32 s4, 0x100000
sequential_preLN__ssm_conv_s4__glu_gated_bilinear__prompt_kernel_tag2_l:
    s_sub_u32 s4, s4, 1
    s_cbranch_scc1 sequential_preLN__ssm_conv_s4__glu_gated_bilinear__prompt_kernel_tag2_b
    global_load_dword v31, v62, s[48:49] sc1
    s_sleep 4
    s_waitcnt vmcnt(0)
    v_cmp_ne_u32 vcc, 0, v31
    s_cbranch_vccz sequential_preLN__ssm_conv_s4__glu_gated_bilinear__prompt_kernel_tag2_l
    s_branch sequential_preLN__ssm_conv_s4__glu_gated_bilinear__prompt_kernel_tag2_b
sequential_preLN__ssm_conv_s4__glu_gated_bilinear__prompt_kernel_last:
ffn:
    s_and_b32 s15, s36, 3
    s_lshl_b32 s5, s15, 5
    v_lshrrev_b32 v40, 2, v1
    v_and_b32 v41, 6, v40
    v_lshlrev_b32 v41, 4, v41
    v_and_b32 v42, 3, v1
    v_lshlrev_b32 v43, 3, v42
    v_lshl_add_u32 v44, v40, 7, v43
    v_add_u32 v44, v44, v41
    v_xor_b32 v45, s5, v44
    v_xor_b32 v46, 0, v45
    v_add_u32 v8, s59, v46
    v_xor_b32 v46, 0, v44
    v_add_u32 v12, 49152, v46
    v_add_u32 v16, 106496, v46
    v_xor_b32 v46, 32, v45
    v_add_u32 v9, s59, v46
    v_xor_b32 v46, 32, v44
    v_add_u32 v13, 49152, v46
    v_add_u32 v17, 106496, v46
    v_xor_b32 v46, 64, v45
    v_add_u32 v10, s59, v46
    v_xor_b32 v46, 64, v44
    v_add_u32 v14, 49152, v46
    v_add_u32 v18, 106496, v46
    v_xor_b32 v46, 96, v45
    v_add_u32 v11, s59, v46
    v_xor_b32 v46, 96, v44
    v_add_u32 v15, 49152, v46
    v_add_u32 v19, 106496, v46
    v_mov_b32 v20, 0x3f803f80
    v_mov_b32 v21, 0x3f803f80
    v_mov_b32 v22, 0x3f803f80
    v_mov_b32 v23, 0x3f803f80
    v_lshlrev_b32 v24, 4, v1
    v_add_u32 v25, 57344, v24
    v_add_u32 v26, 114688, v24
    v_cmp_eq_u32 s[64:65], 1, v42
    v_cmp_eq_u32 s[66:67], 2, v42
    v_cmp_eq_u32 s[68:69], 3, v42
    v_lshlrev_b32 v27, 3, v1
    s_lshr_b32 s45, s36, 1
    s_and_b32 s44, s36, 1
    s_mul_i32 s38, s35, 36
    s_lshl_b32 s17, s34, 1
    s_add_u32 s17, s17, s44
    s_lshl_b32 s17, s17, 2
    s_add_u32 s17, s17, s33
    s_lshl_b32 s5, s34, 3
    s_lshl_b32 s6, s33, 1
    s_add_u32 s5, s5, s6
    s_mul_i32 s5, s5, 144
    s_add_u32 s5, s5, s38
    s_add_u32 s5, s5, s36
    s_lshl_b32 s5, s5, 11
    s_add_u32 s5, s5, 0x1b40000
    s_xor_b32 s6, s15, 0
    s_lshr_b32 s7, s6, 1
    s_mul_i32 s7, s7, 292864
    s_lshl_b32 s6, s6, 10
    s_add_u32 s6, s6, s7
    s_add_u32 s70, s5, s6
    s_xor_b32 s6, s15, 1
    s_lshr_b32 s7, s6, 1
    s_mul_i32 s7, s7, 292864
    s_lshl_b32 s6, s6, 10
    s_add_u32 s6, s6, s7
    s_add_u32 s71, s5, s6
    s_xor_b32 s6, s15, 2
    s_lshr_b32 s7, s6, 1
    s_mul_i32 s7, s7, 292864
    s_lshl_b32 s6, s6, 10
    s_add_u32 s6, s6, s7
    s_add_u32 s73, s5, s6
    s_xor_b32 s6, s15, 3
    s_lshr_b32 s7, s6, 1
    s_mul_i32 s7, s7, 292864
    s_lshl_b32 s6, s6, 10
    s_add_u32 s6, s6, s7
    s_add_u32 s74, s5, s6
    s_add_u32 s6, s45, 8
    s_sub_u32 s6, s6, s36
    s_lshl_b32 s6, s6, 11
    s_lshl_b32 s7, s44, 9
    s_add_u32 s16, s6, s7
    s_sub_u32 s18, 24576, s16
    s_lshl_b32 s5, s34, 3
    s_add_u32 s5, s5, s36
    s_mul_i32 s5, s5, 147456
    s_mul_i32 s6, s33, 9216
    s_waitcnt vmcnt(0)
    s_barrier
    buffer_store_dword v31, v47, s[28:31], 0 offen sc1
    s_add_u32 s5, s5, s6
    s_add_u32 s5, s5, 0x2d40000
    s_add_u32 s6, s35, 0
    s_and_b32 s6, s6, 3
    s_mul_i32 s6, s6, 36864
    s_add_u32 s50, s5, s6
    s_add_u32 s6, s35, 1
    s_and_b32 s6, s6, 3
    s_mul_i32 s6, s6, 36864
    s_add_u32 s51, s5, s6
    s_add_u32 s6, s35, 2
    s_and_b32 s6, s6, 3
    s_mul_i32 s6, s6, 36864
    s_add_u32 s52, s5, s6
    s_add_u32 s52, s52, 3072
    s_add_u32 s6, s35, 3
    s_and_b32 s6, s6, 3
    s_mul_i32 s6, s6, 36864
    s_add_u32 s53, s5, s6
    s_add_u32 s53, s53, 6144
    s_sub_u32 s46, s33, s35
    s_and_b32 s46, s46, 3
    s_mul_i32 s6, s33, 36864
    s_add_u32 s54, s5, s6
    s_mul_i32 s6, s46, 3072
    s_add_u32 s54, s54, s6
    s_sub_u32 s54, s54, 1024
    s_add_u32 s55, s50, 3072
    s_add_u32 s56, s50, 6144
    s_min_u32 s6, s46, 1
    s_mul_i32 s47, s6, 0x20000000
    s_sub_u32 s48, 0x20000000, s47
    s_mov_b32 s78, 2359296
    s_mov_b32 s79, 0x20000
    s_mul_i32 s5, s17, 36864
    s_mul_i32 s6, s45, 288
    s_add_u32 s61, s5, s6
    s_lshl_b32 s6, s35, 6
    s_add_u32 s62, s61, s6
    s_add_u32 s63, s62, 18432
    s_mul_i32 s5, s17, 144
    s_add_u32 s5, s5, s38
    s_lshl_b32 s5, s5, 11
    s_add_u32 s57, s5, 0x1b40000
    s_mul_i32 s5, s45, 18432
    s_lshr_b32 s6, s17, 1
    s_mul_i32 s6, s6, 73728
    s_add_u32 s5, s5, s6
    s_and_b32 s6, s17, 1
    s_lshl_b32 s6, s6, 6
    s_add_u32 s5, s5, s6
    s_add_u32 s5, s5, 0x900000
    s_lshl_b32 s6, s35, 12
    s_add_u32 s8, s5, s6
    s_add_u32 s9, s8, 2048
    s_add_u32 s10, s5, 16384
    s_mul_i32 s75, s33, 3072
    s_add_u32 s75, s75, 0
    s_lshl_b32 s49, s34, 11
    s_add_u32 s49, s49, 0xb60000
    s_sub_u32 s12, s49, 0x4000
    v_cmp_eq_u32 vcc, 0, v1
    s_lshl_b32 s5, s35, 9
    s_lshl_b32 s6, s33, 7
    s_lshl_b32 s7, s36, 2
    s_add_u32 s6, s6, s7
    s_add_u32 s7, s5, s6
    v_mov_b32 v46, 0x20000000
    v_mov_b32 v45, s7
    v_cndmask_b32 v33, v46, v45, vcc
    s_bfe_u32 s7, s17, 0x20001
    s_lshl_b32 s7, s7, 7
    s_add_u32 s14, s7, s5
    v_cmp_gt_u32 vcc, 8, v1
    v_lshl_add_u32 v32, v1, 2, s14
    v_lshl_add_u32 v45, v42, 9, s6
    v_cndmask_b32 v32, v45, v32, vcc
    v_add_u32 v34, s47, v24
    s_lshl_b32 s5, s45, 2
    s_add_u32 s5, s5, s35
    s_mul_i32 s5, s5, 331776
    s_add_u32 s5, s5, 0x161d000
    v_add_u32 v30, s5, v24
    s_mul_i32 s5, s37, 36864
    s_add_u32 s5, s5, 0xbeb000
    v_add_u32 v31, s5, v24
    v_and_b32 v40, 15, v1
    v_lshrrev_b32 v44, 4, v1
    v_lshlrev_b32 v35, 4, v44
    v_add_u32 v35, 159744, v35
    s_lshl_b32 s5, s34, 2
    s_add_u32 s5, s5, s35
    s_lshl_b32 s5, s5, 10
    s_add_u32 s19, s5, 0xb40000
    s_lshl_b32 s5, s33, 2
    s_add_u32 s5, s5, s15
    s_lshl_b32 s5, s5, 6
    v_lshl_add_u32 v45, v40, 2, s5
    s_and_b32 s5, s17, 7
    s_lshl_b32 s5, s5, 7
    v_lshl_add_u32 v37, v40, 2, s5
    v_lshrrev_b32 v40, 2, v40
    v_cmp_eq_u32 vcc, v40, v44
    s_lshl_b32 s5, s34, 2
    s_add_u32 s5, s5, s35
    s_lshl_b32 s5, s5, 1
    s_lshr_b32 s6, s36, 2
    s_add_u32 s5, s5, s6
    s_lshl_b32 s5, s5, 2
    s_add_u32 s5, s5, s33
    s_lshl_b32 s5, s5, 2
    s_add_u32 s5, s5, s15
    s_lshl_b32 s5, s5, 7
    s_add_u32 s24, s5, 0x100000
    s_xor_b32 s25, s24, 128
    s_xor_b32 s26, s24, 256
    s_xor_b32 s27, s24, 384
    s_lshr_b32 s5, s33, 1
    s_add_u32 s5, s5, s39
    s_lshl_b32 s5, s5, 8
    s_and_b32 s6, s33, 1
    s_mul_i32 s6, s6, 18432
    s_add_u32 s5, s5, s6
    s_add_u32 s32, s5, 0x480000
    v_lshlrev_b32 v29, 2, v1
    v_cndmask_b32 v36, v46, v45, vcc
    v_lshlrev_b32 v28, 2, v0
    v_add_u32 v28, 159744, v28
ffn_hop:
    s_mov_b64 exec, 0
    s_cmp_eq_u32 s33, 0
    s_cbranch_scc1 ffn_c_h0
    s_cmp_eq_u32 s33, 1
    s_cbranch_scc1 ffn_c_h1
    s_cmp_eq_u32 s33, 2
    s_cbranch_scc1 ffn_c_h2
    s_branch ffn_c_h3
ffn_c_ret:
    s_mov_b64 exec, -1
    s_cmp_ge_u32 s2, 144
    s_cbranch_scc1 ffn_hb
    s_mov_b32 s11, 0x100000
ffn_q2:
    buffer_load_dword v5, v4, s[28:31], s13 offen sc1
    s_waitcnt vmcnt(0)
    v_cmp_ne_u32 vcc, s96, v5
    s_cbranch_vccnz ffn_p1
ffn_p2:
    s_barrier
    s_add_u32 m0, s59, 0
    s_nop 0
    buffer_load_dwordx4 v2, s[28:31], s60 offen offset:0 sc1 lds
    buffer_load_dwordx4 v2, s[28:31], s60 offen offset:1024 sc1 lds
    buffer_load_dwordx4 v2, s[28:31], s60 offen offset:2048 sc1 lds
    buffer_load_dwordx4 v2, s[28:31], s60 offen offset:3072 sc1 lds
    s_add_u32 s60, s60, 4096
    s_add_u32 m0, s59, 4096
    s_nop 0
    buffer_load_dwordx4 v2, s[28:31], s60 offen offset:0 sc1 lds
    buffer_load_dwordx4 v2, s[28:31], s60 offen offset:1024 sc1 lds
    buffer_load_dwordx4 v2, s[28:31], s60 offen offset:2048 sc1 lds
    buffer_load_dwordx4 v2, s[28:31], s60 offen offset:3072 sc1 lds
    s_add_u32 s60, s60, 4096
    s_add_u32 m0, s59, 8192
    s_nop 0
    buffer_load_dwordx4 v2, s[28:31], s60 offen offset:0 sc1 lds
    buffer_load_dwordx4 v2, s[28:31], s60 offen offset:1024 sc1 lds
    buffer_load_dwordx4 v2, s[28:31], s60 offen offset:2048 sc1 lds
    buffer_load_dwordx4 v2, s[28:31], s60 offen offset:3072 sc1 lds
    s_add_u32 s60, s60, 4096
ffn_c0:
    ds_read_b64_tr_b16 v[64:65], v12 offset:0
    ds_read_b64_tr_b16 v[66:67], v12 offset:2048
    ds_read_b64_tr_b16 v[68:69], v12 offset:4096
    ds_read_b64_tr_b16 v[70:71], v12 offset:6144
    ds_read_b64_tr_b16 v[72:73], v13 offset:0
    ds_read_b64_tr_b16 v[74:75], v13 offset:2048
    ds_read_b64_tr_b16 v[76:77], v13 offset:4096
    ds_read_b64_tr_b16 v[78:79], v13 offset:6144
    s_waitcnt vmcnt(8)
    ds_read_b64_tr_b16 a[0:1], v8 offset:0
    ds_read_b64_tr_b16 a[4:5], v9 offset:0
    ds_read_b64_tr_b16 a[8:9], v10 offset:0
    ds_read_b64_tr_b16 a[12:13], v11 offset:0
    ds_read_b64_tr_b16 a[2:3], v8 offset:2048
    ds_read_b64_tr_b16 a[6:7], v9 offset:2048
    ds_read_b64_tr_b16 a[10:11], v10 offset:2048
    ds_read_b64_tr_b16 a[14:15], v11 offset:2048
    s_waitcnt lgkmcnt(0)
    v_mfma_f32_16x16x32_bf16 v[108:111], v[64:67], a[12:15], 0
    ds_read_b64_tr_b16 v[80:81], v14 offset:0
    s_add_u32 m0, s59, 0
    v_mfma_f32_16x16x32_bf16 v[104:107], v[64:67], a[8:11], 0
    buffer_load_dwordx4 v2, s[28:31], s60 offen offset:0 sc1 lds
    v_mfma_f32_16x16x32_bf16 v[100:103], v[64:67], a[4:7], 0
    ds_read_b64_tr_b16 v[82:83], v14 offset:2048
    v_mfma_f32_16x16x32_bf16 v[96:99], v[64:67], a[0:3], 0
    ds_read_b64_tr_b16 v[84:85], v14 offset:4096
    v_mfma_f32_16x16x32_bf16 v[112:115], v[68:71], a[0:3], 0
    ds_read_b64_tr_b16 v[86:87], v14 offset:6144
    v_mfma_f32_16x16x32_bf16 v[116:119], v[68:71], a[4:7], 0
    buffer_load_dwordx4 v2, s[28:31], s60 offen offset:1024 sc1 lds
    v_mfma_f32_16x16x32_bf16 v[120:123], v[68:71], a[8:11], 0
    ds_read_b64_tr_b16 v[88:89], v15 offset:0
    v_mfma_f32_16x16x32_bf16 v[124:127], v[68:71], a[12:15], 0
    ds_read_b64_tr_b16 v[90:91], v15 offset:2048
    v_mfma_f32_16x16x32_bf16 v[140:143], v[72:75], a[12:15], 0
    ds_read_b64_tr_b16 v[92:93], v15 offset:4096
    v_mfma_f32_16x16x32_bf16 v[136:139], v[72:75], a[8:11], 0
    buffer_load_dwordx4 v2, s[28:31], s60 offen offset:2048 sc1 lds
    v_mfma_f32_16x16x32_bf16 v[132:135], v[72:75], a[4:7], 0
    ds_read_b64_tr_b16 v[94:95], v15 offset:6144
    v_mfma_f32_16x16x32_bf16 v[128:131], v[72:75], a[0:3], 0
    v_mfma_f32_16x16x32_bf16 v[144:147], v[76:79], a[0:3], 0
    v_mfma_f32_16x16x32_bf16 v[148:151], v[76:79], a[4:7], 0
    buffer_load_dwordx4 v2, s[28:31], s60 offen offset:3072 sc1 lds
    v_mfma_f32_16x16x32_bf16 v[152:155], v[76:79], a[8:11], 0
    s_add_u32 s60, s60, 4096
    v_mfma_f32_16x16x32_bf16 v[156:159], v[76:79], a[12:15], 0
    s_waitcnt lgkmcnt(0)
    v_mfma_f32_16x16x32_bf16 v[172:175], v[80:83], a[12:15], 0
    ds_read_b64_tr_b16 v[64:65], v12 offset:8192
    ds_read_b64_tr_b16 v[66:67], v12 offset:10240
    v_mfma_f32_16x16x32_bf16 v[168:171], v[80:83], a[8:11], 0
    ds_read_b64_tr_b16 v[68:69], v12 offset:12288
    s_add_u32 m0, s58, 122880
    v_mfma_f32_16x16x32_bf16 v[164:167], v[80:83], a[4:7], 0
    buffer_load_dwordx4 v3, s[20:23], s72 offen lds
    v_mfma_f32_16x16x32_bf16 v[160:163], v[80:83], a[0:3], 0
    ds_read_b64_tr_b16 v[70:71], v12 offset:14336
    ds_read_b64_tr_b16 v[72:73], v13 offset:8192
    v_mfma_f32_16x16x32_bf16 v[176:179], v[84:87], a[0:3], 0
    ds_read_b64_tr_b16 v[74:75], v13 offset:10240
    ds_read_b64_tr_b16 v[76:77], v13 offset:12288
    v_mfma_f32_16x16x32_bf16 v[180:183], v[84:87], a[4:7], 0
    ds_read_b64_tr_b16 v[78:79], v13 offset:14336
    s_add_u32 m0, s58, 126976
    v_mfma_f32_16x16x32_bf16 v[184:187], v[84:87], a[8:11], 0
    buffer_load_dwordx4 v3, s[40:43], s72 offen lds
    v_mfma_f32_16x16x32_bf16 v[188:191], v[84:87], a[12:15], 0
    s_add_u32 s72, s72, 294912
    s_waitcnt vmcnt(12)
    v_mfma_f32_16x16x32_bf16 v[204:207], v[88:91], a[12:15], 0
    ds_read_b64_tr_b16 a[16:17], v8 offset:4096
    ds_read_b64_tr_b16 a[20:21], v9 offset:4096
    v_mfma_f32_16x16x32_bf16 v[200:203], v[88:91], a[8:11], 0
    ds_read_b64_tr_b16 a[24:25], v10 offset:4096
    s_add_u32 m0, s58, 131072
    v_mfma_f32_16x16x32_bf16 v[196:199], v[88:91], a[4:7], 0
    buffer_load_dwordx4 v3, s[20:23], s72 offen lds
    v_mfma_f32_16x16x32_bf16 v[192:195], v[88:91], a[0:3], 0
    ds_read_b64_tr_b16 a[28:29], v11 offset:4096
    s_waitcnt vmcnt(11)
    v_mfma_f32_16x16x32_bf16 v[208:211], v[92:95], a[0:3], 0
    ds_read_b64_tr_b16 a[18:19], v8 offset:6144
    ds_read_b64_tr_b16 a[22:23], v9 offset:6144
    v_mfma_f32_16x16x32_bf16 v[212:215], v[92:95], a[4:7], 0
    ds_read_b64_tr_b16 a[26:27], v10 offset:6144
    ds_read_b64_tr_b16 a[30:31], v11 offset:6144
    v_mfma_f32_16x16x32_bf16 v[216:219], v[92:95], a[8:11], 0
    v_mfma_f32_16x16x32_bf16 v[220:223], v[92:95], a[12:15], 0
    s_add_u32 m0, s58, 135168
    s_waitcnt lgkmcnt(0)
    v_mfma_f32_16x16x32_bf16 v[108:111], v[64:67], a[28:31], v[108:111]
    buffer_load_dwordx4 v3, s[40:43], s72 offen lds
    v_mfma_f32_16x16x32_bf16 v[104:107], v[64:67], a[24:27], v[104:107]
    s_add_u32 s72, s72, 294912
    ds_read_b64_tr_b16 v[80:81], v14 offset:8192
    v_mfma_f32_16x16x32_bf16 v[100:103], v[64:67], a[20:23], v[100:103]
    ds_read_b64_tr_b16 v[82:83], v14 offset:10240
    v_mfma_f32_16x16x32_bf16 v[96:99], v[64:67], a[16:19], v[96:99]
    ds_read_b64_tr_b16 v[84:85], v14 offset:12288
    s_add_u32 m0, s59, 4096
    v_mfma_f32_16x16x32_bf16 v[112:115], v[68:71], a[16:19], v[112:115]
    buffer_load_dwordx4 v2, s[28:31], s60 offen offset:0 sc1 lds
    v_mfma_f32_16x16x32_bf16 v[116:119], v[68:71], a[20:23], v[116:119]
    ds_read_b64_tr_b16 v[86:87], v14 offset:14336
    v_mfma_f32_16x16x32_bf16 v[120:123], v[68:71], a[24:27], v[120:123]
    ds_read_b64_tr_b16 v[88:89], v15 offset:8192
    v_mfma_f32_16x16x32_bf16 v[124:127], v[68:71], a[28:31], v[124:127]
    ds_read_b64_tr_b16 v[90:91], v15 offset:10240
    v_mfma_f32_16x16x32_bf16 v[140:143], v[72:75], a[28:31], v[140:143]
    buffer_load_dwordx4 v2, s[28:31], s60 offen offset:1024 sc1 lds
    v_mfma_f32_16x16x32_bf16 v[136:139], v[72:75], a[24:27], v[136:139]
    ds_read_b64_tr_b16 v[92:93], v15 offset:12288
    v_mfma_f32_16x16x32_bf16 v[132:135], v[72:75], a[20:23], v[132:135]
    ds_read_b64_tr_b16 v[94:95], v15 offset:14336
    v_mfma_f32_16x16x32_bf16 v[128:131], v[72:75], a[16:19], v[128:131]
    v_mfma_f32_16x16x32_bf16 v[144:147], v[76:79], a[16:19], v[144:147]
    buffer_load_dwordx4 v2, s[28:31], s60 offen offset:2048 sc1 lds
    v_mfma_f32_16x16x32_bf16 v[148:151], v[76:79], a[20:23], v[148:151]
    v_mfma_f32_16x16x32_bf16 v[152:155], v[76:79], a[24:27], v[152:155]
    v_mfma_f32_16x16x32_bf16 v[156:159], v[76:79], a[28:31], v[156:159]
    s_waitcnt lgkmcnt(0)
    v_mfma_f32_16x16x32_bf16 v[172:175], v[80:83], a[28:31], v[172:175]
    ds_read_b64_tr_b16 v[64:65], v12 offset:16384
    ds_read_b64_tr_b16 v[66:67], v12 offset:18432
    v_mfma_f32_16x16x32_bf16 v[168:171], v[80:83], a[24:27], v[168:171]
    buffer_load_dword v38, v39, s[28:31], s13 offen sc1
    v_mfma_f32_16x16x32_bf16 v[164:167], v[80:83], a[20:23], v[164:167]
    ds_read_b64_tr_b16 v[68:69], v12 offset:20480
    ds_read_b64_tr_b16 v[70:71], v12 offset:22528
    v_mfma_f32_16x16x32_bf16 v[160:163], v[80:83], a[16:19], v[160:163]
    ds_read_b64_tr_b16 v[72:73], v13 offset:16384
    ds_read_b64_tr_b16 v[74:75], v13 offset:18432
    v_mfma_f32_16x16x32_bf16 v[176:179], v[84:87], a[16:19], v[176:179]
    ds_read_b64_tr_b16 v[76:77], v13 offset:20480
    ds_read_b64_tr_b16 v[78:79], v13 offset:22528
    v_mfma_f32_16x16x32_bf16 v[180:183], v[84:87], a[20:23], v[180:183]
    buffer_load_dwordx4 v2, s[28:31], s60 offen offset:3072 sc1 lds
    v_mfma_f32_16x16x32_bf16 v[184:187], v[84:87], a[24:27], v[184:187]
    s_add_u32 s60, s60, 4096
    s_waitcnt vmcnt(15)
    v_mfma_f32_16x16x32_bf16 v[188:191], v[84:87], a[28:31], v[188:191]
    ds_read_b64_tr_b16 a[32:33], v8 offset:8192
    ds_read_b64_tr_b16 a[36:37], v9 offset:8192
    v_mfma_f32_16x16x32_bf16 v[204:207], v[88:91], a[28:31], v[204:207]
    ds_read_b64_tr_b16 a[40:41], v10 offset:8192
    s_add_u32 m0, s58, 139264
    v_mfma_f32_16x16x32_bf16 v[200:203], v[88:91], a[24:27], v[200:203]
    buffer_load_dwordx4 v3, s[20:23], s72 offen lds
    v_mfma_f32_16x16x32_bf16 v[196:199], v[88:91], a[20:23], v[196:199]
    ds_read_b64_tr_b16 a[44:45], v11 offset:8192
    s_waitcnt vmcnt(14)
    v_mfma_f32_16x16x32_bf16 v[192:195], v[88:91], a[16:19], v[192:195]
    ds_read_b64_tr_b16 a[34:35], v8 offset:10240
    ds_read_b64_tr_b16 a[38:39], v9 offset:10240
    v_mfma_f32_16x16x32_bf16 v[208:211], v[92:95], a[16:19], v[208:211]
    ds_read_b64_tr_b16 a[42:43], v10 offset:10240
    ds_read_b64_tr_b16 a[46:47], v11 offset:10240
    v_mfma_f32_16x16x32_bf16 v[212:215], v[92:95], a[20:23], v[212:215]
    s_add_u32 m0, s58, 143360
    v_mfma_f32_16x16x32_bf16 v[216:219], v[92:95], a[24:27], v[216:219]
    buffer_load_dwordx4 v3, s[40:43], s72 offen lds
    v_mfma_f32_16x16x32_bf16 v[220:223], v[92:95], a[28:31], v[220:223]
    s_add_u32 s72, s72, 294912
    s_waitcnt lgkmcnt(0)
    v_mfma_f32_16x16x32_bf16 v[108:111], v[64:67], a[44:47], v[108:111]
ffn_c_h0:
    s_cbranch_execz ffn_c_h0_1
    ds_read_b64_tr_b16 v[80:81], v14 offset:16384
    ds_read_b64_tr_b16 v[82:83], v14 offset:18432
    v_mfma_f32_16x16x32_bf16 v[104:107], v[64:67], a[40:43], v[104:107]
    ds_read_b64_tr_b16 v[84:85], v14 offset:20480
    s_add_u32 m0, s59, 8192
    v_mfma_f32_16x16x32_bf16 v[100:103], v[64:67], a[36:39], v[100:103]
    buffer_load_dwordx4 v2, s[28:31], s60 offen offset:0 sc1 lds
    v_mfma_f32_16x16x32_bf16 v[96:99], v[64:67], a[32:35], v[96:99]
    ds_read_b64_tr_b16 v[86:87], v14 offset:22528
    ds_read_b64_tr_b16 v[88:89], v15 offset:16384
    v_mfma_f32_16x16x32_bf16 v[112:115], v[68:71], a[32:35], v[112:115]
    ds_read_b64_tr_b16 v[90:91], v15 offset:18432
    ds_read_b64_tr_b16 v[92:93], v15 offset:20480
    v_mfma_f32_16x16x32_bf16 v[116:119], v[68:71], a[36:39], v[116:119]
    ds_read_b64_tr_b16 v[94:95], v15 offset:22528
    s_waitcnt vmcnt(14)
    v_mfma_f32_16x16x32_bf16 v[120:123], v[68:71], a[40:43], v[120:123]
    buffer_load_dwordx4 v2, s[28:31], s60 offen offset:1024 sc1 lds
    v_mfma_f32_16x16x32_bf16 v[124:127], v[68:71], a[44:47], v[124:127]
    ds_read_b64_tr_b16 a[48:49], v8 offset:0
    ds_read_b64_tr_b16 a[52:53], v9 offset:0
    v_mfma_f32_16x16x32_bf16 v[140:143], v[72:75], a[44:47], v[140:143]
    ds_read_b64_tr_b16 a[56:57], v10 offset:0
    ds_read_b64_tr_b16 a[60:61], v11 offset:0
    v_mfma_f32_16x16x32_bf16 v[136:139], v[72:75], a[40:43], v[136:139]
    s_waitcnt vmcnt(13)
    ds_read_b64_tr_b16 a[50:51], v8 offset:2048
    v_mfma_f32_16x16x32_bf16 v[132:135], v[72:75], a[36:39], v[132:135]
    ds_read_b64_tr_b16 a[54:55], v9 offset:2048
    ds_read_b64_tr_b16 a[58:59], v10 offset:2048
    v_mfma_f32_16x16x32_bf16 v[128:131], v[72:75], a[32:35], v[128:131]
    buffer_load_dwordx4 v2, s[28:31], s60 offen offset:2048 sc1 lds
    v_mfma_f32_16x16x32_bf16 v[144:147], v[76:79], a[32:35], v[144:147]
    ds_read_b64_tr_b16 a[62:63], v11 offset:2048
    v_mfma_f32_16x16x32_bf16 v[148:151], v[76:79], a[36:39], v[148:151]
    v_mfma_f32_16x16x32_bf16 v[152:155], v[76:79], a[40:43], v[152:155]
    v_mfma_f32_16x16x32_bf16 v[156:159], v[76:79], a[44:47], v[156:159]
    s_waitcnt lgkmcnt(0)
    v_mfma_f32_16x16x32_bf16 v[48:51], v[20:23], a[0:3], 0
    buffer_load_dwordx4 v2, s[28:31], s60 offen offset:3072 sc1 lds
    v_mfma_f32_16x16x32_bf16 v[48:51], v[20:23], a[16:19], v[48:51]
ffn_c_h0_1:
    s_cbranch_execz ffn_c_h0_2
    s_add_u32 s60, s60, 4096
    ds_read_b64_tr_b16 v[64:65], v12 offset:24576
    v_mfma_f32_16x16x32_bf16 v[48:51], v[20:23], a[32:35], v[48:51]
    ds_read_b64_tr_b16 v[66:67], v12 offset:26624
    v_mfma_f32_16x16x32_bf16 v[48:51], v[20:23], a[48:51], v[48:51]
    ds_read_b64_tr_b16 v[68:69], v12 offset:28672
    s_add_u32 m0, s59, 0
    v_mfma_f32_16x16x32_bf16 v[172:175], v[80:83], a[44:47], v[172:175]
    buffer_load_dwordx4 v2, s[28:31], s60 offen offset:0 sc1 lds
    v_mfma_f32_16x16x32_bf16 v[168:171], v[80:83], a[40:43], v[168:171]
    ds_read_b64_tr_b16 v[70:71], v12 offset:30720
    v_mfma_f32_16x16x32_bf16 v[164:167], v[80:83], a[36:39], v[164:167]
    ds_read_b64_tr_b16 v[72:73], v13 offset:24576
    v_mfma_f32_16x16x32_bf16 v[160:163], v[80:83], a[32:35], v[160:163]
    ds_read_b64_tr_b16 v[74:75], v13 offset:26624
    v_mfma_f32_16x16x32_bf16 v[176:179], v[84:87], a[32:35], v[176:179]
    buffer_load_dwordx4 v2, s[28:31], s60 offen offset:1024 sc1 lds
    v_mfma_f32_16x16x32_bf16 v[180:183], v[84:87], a[36:39], v[180:183]
    ds_read_b64_tr_b16 v[76:77], v13 offset:28672
    v_mfma_f32_16x16x32_bf16 v[184:187], v[84:87], a[40:43], v[184:187]
    ds_read_b64_tr_b16 v[78:79], v13 offset:30720
    v_mfma_f32_16x16x32_bf16 v[188:191], v[84:87], a[44:47], v[188:191]
    v_mfma_f32_16x16x32_bf16 v[204:207], v[88:91], a[44:47], v[204:207]
    buffer_load_dwordx4 v2, s[28:31], s60 offen offset:2048 sc1 lds
    v_mfma_f32_16x16x32_bf16 v[200:203], v[88:91], a[40:43], v[200:203]
    v_mfma_f32_16x16x32_bf16 v[196:199], v[88:91], a[36:39], v[196:199]
    v_mfma_f32_16x16x32_bf16 v[192:195], v[88:91], a[32:35], v[192:195]
    v_mfma_f32_16x16x32_bf16 v[208:211], v[92:95], a[32:35], v[208:211]
    v_mfma_f32_16x16x32_bf16 v[212:215], v[92:95], a[36:39], v[212:215]
    buffer_load_dwordx4 v2, s[28:31], s60 offen offset:3072 sc1 lds
    v_mfma_f32_16x16x32_bf16 v[216:219], v[92:95], a[40:43], v[216:219]
    s_add_u32 s60, s60, 4096
    v_mfma_f32_16x16x32_bf16 v[220:223], v[92:95], a[44:47], v[220:223]
    s_waitcnt lgkmcnt(0)
    v_mfma_f32_16x16x32_bf16 v[44:47], a[0:3], a[0:3], 0
    ds_read_b64_tr_b16 v[80:81], v14 offset:24576
    s_add_u32 m0, s58, 147456
    v_mfma_f32_16x16x32_bf16 v[44:47], a[16:19], a[16:19], v[44:47]
    buffer_load_dwordx4 v3, s[20:23], s72 offen lds
    v_mfma_f32_16x16x32_bf16 v[44:47], a[32:35], a[32:35], v[44:47]
    ds_read_b64_tr_b16 v[82:83], v14 offset:26624
ffn_c_h0_2:
    s_cbranch_execz ffn_c_h4
    ds_read_b64_tr_b16 v[84:85], v14 offset:28672
    v_mfma_f32_16x16x32_bf16 v[44:47], a[48:51], a[48:51], v[44:47]
    ds_read_b64_tr_b16 v[86:87], v14 offset:30720
    ds_read_b64_tr_b16 v[88:89], v15 offset:24576
    v_mfma_f32_16x16x32_bf16 v[108:111], v[64:67], a[60:63], v[108:111]
    ds_read_b64_tr_b16 v[90:91], v15 offset:26624
    s_add_u32 m0, s58, 151552
    v_mfma_f32_16x16x32_bf16 v[104:107], v[64:67], a[56:59], v[104:107]
    buffer_load_dwordx4 v3, s[40:43], s72 offen lds
    v_mfma_f32_16x16x32_bf16 v[100:103], v[64:67], a[52:55], v[100:103]
    s_add_u32 s72, s72, 294912
    ds_read_b64_tr_b16 v[92:93], v15 offset:28672
    v_mfma_f32_16x16x32_bf16 v[96:99], v[64:67], a[48:51], v[96:99]
    ds_read_b64_tr_b16 v[94:95], v15 offset:30720
    s_waitcnt vmcnt(15)
    v_mfma_f32_16x16x32_bf16 v[112:115], v[68:71], a[48:51], v[112:115]
    ds_read_b64_tr_b16 a[64:65], v8 offset:4096
    ds_read_b64_tr_b16 a[68:69], v9 offset:4096
    v_mfma_f32_16x16x32_bf16 v[116:119], v[68:71], a[52:55], v[116:119]
    s_waitcnt vmcnt(13)
    ds_read_b64_tr_b16 a[72:73], v10 offset:4096
    v_mfma_f32_16x16x32_bf16 v[120:123], v[68:71], a[56:59], v[120:123]
    v_cmp_ne_u32 vcc, s96, v38
    ds_read_b64_tr_b16 a[76:77], v11 offset:4096
    v_mfma_f32_16x16x32_bf16 v[124:127], v[68:71], a[60:63], v[124:127]
    s_cbranch_vccnz ffn_b1
ffn_b2:
    s_add_u32 m0, s58, 155648
    v_mfma_f32_16x16x32_bf16 v[140:143], v[72:75], a[60:63], v[140:143]
    buffer_load_dwordx4 v3, s[20:23], s72 offen lds
    v_mfma_f32_16x16x32_bf16 v[136:139], v[72:75], a[56:59], v[136:139]
    s_waitcnt vmcnt(13)
    ds_read_b64_tr_b16 a[66:67], v8 offset:6144
    v_mfma_f32_16x16x32_bf16 v[132:135], v[72:75], a[52:55], v[132:135]
    ds_read_b64_tr_b16 a[70:71], v9 offset:6144
    ds_read_b64_tr_b16 a[74:75], v10 offset:6144
    v_mfma_f32_16x16x32_bf16 v[128:131], v[72:75], a[48:51], v[128:131]
    ds_read_b64_tr_b16 a[78:79], v11 offset:6144
    v_and_b32 v38, 15, v1
    v_mfma_f32_16x16x32_bf16 v[144:147], v[76:79], a[48:51], v[144:147]
    v_lshlrev_b32 v38, 3, v38
    v_lshrrev_b32 v39, 4, v1
    v_mfma_f32_16x16x32_bf16 v[148:151], v[76:79], a[52:55], v[148:151]
    v_lshl_add_u32 v39, v39, 29, v38
    v_mfma_f32_16x16x32_bf16 v[152:155], v[76:79], a[56:59], v[152:155]
    v_mfma_f32_16x16x32_bf16 v[156:159], v[76:79], a[60:63], v[156:159]
    s_waitcnt lgkmcnt(0)
    v_mfma_f32_16x16x32_bf16 v[172:175], v[80:83], a[60:63], v[172:175]
    ds_read_b64_tr_b16 v[64:65], v12 offset:32768
    s_add_u32 m0, s59, 4096
    v_mfma_f32_16x16x32_bf16 v[168:171], v[80:83], a[56:59], v[168:171]
    buffer_load_dwordx4 v2, s[28:31], s60 offen offset:0 sc1 lds
    v_mfma_f32_16x16x32_bf16 v[164:167], v[80:83], a[52:55], v[164:167]
    ds_read_b64_tr_b16 v[66:67], v12 offset:34816
    ds_read_b64_tr_b16 v[68:69], v12 offset:40960
    v_mfma_f32_16x16x32_bf16 v[160:163], v[80:83], a[48:51], v[160:163]
    ds_read_b64_tr_b16 v[70:71], v12 offset:43008
    ds_read_b64_tr_b16 v[72:73], v12 offset:36864
    v_mfma_f32_16x16x32_bf16 v[176:179], v[84:87], a[48:51], v[176:179]
    ds_read_b64_tr_b16 v[74:75], v12 offset:38912
    ds_read_b64_tr_b16 v[76:77], v12 offset:45056
    v_mfma_f32_16x16x32_bf16 v[180:183], v[84:87], a[52:55], v[180:183]
    buffer_load_dwordx4 v2, s[28:31], s60 offen offset:1024 sc1 lds
    v_mfma_f32_16x16x32_bf16 v[184:187], v[84:87], a[56:59], v[184:187]
    ds_read_b64_tr_b16 v[78:79], v12 offset:47104
    s_waitcnt vmcnt(11)
    v_mfma_f32_16x16x32_bf16 v[188:191], v[84:87], a[60:63], v[188:191]
    ds_read_b64_tr_b16 a[80:81], v8 offset:8192
    ds_read_b64_tr_b16 a[84:85], v9 offset:8192
    v_mfma_f32_16x16x32_bf16 v[204:207], v[88:91], a[60:63], v[204:207]
    ds_read_b64_tr_b16 a[88:89], v10 offset:8192
    ds_read_b64_tr_b16 a[92:93], v11 offset:8192
    v_mfma_f32_16x16x32_bf16 v[200:203], v[88:91], a[56:59], v[200:203]
    buffer_load_dwordx4 v2, s[28:31], s60 offen offset:2048 sc1 lds
    v_mfma_f32_16x16x32_bf16 v[196:199], v[88:91], a[52:55], v[196:199]
    s_waitcnt vmcnt(10)
    ds_read_b64_tr_b16 a[82:83], v8 offset:10240
    v_mfma_f32_16x16x32_bf16 v[192:195], v[88:91], a[48:51], v[192:195]
    ds_read_b64_tr_b16 a[86:87], v9 offset:10240
    ds_read_b64_tr_b16 a[90:91], v10 offset:10240
    v_mfma_f32_16x16x32_bf16 v[208:211], v[92:95], a[48:51], v[208:211]
    ds_read_b64_tr_b16 a[94:95], v11 offset:10240
    v_mfma_f32_16x16x32_bf16 v[212:215], v[92:95], a[52:55], v[212:215]
    buffer_load_dwordx4 v2, s[28:31], s60 offen offset:3072 sc1 lds
    v_mfma_f32_16x16x32_bf16 v[216:219], v[92:95], a[56:59], v[216:219]
    s_add_u32 s60, s60, 4096
    v_mfma_f32_16x16x32_bf16 v[220:223], v[92:95], a[60:63], v[220:223]
    s_waitcnt lgkmcnt(0)
    v_mfma_f32_16x16x32_bf16 v[108:111], v[64:67], a[76:79], v[108:111]
    ds_read_b64_tr_b16 v[80:81], v13 offset:32768
    ds_read_b64_tr_b16 v[82:83], v13 offset:34816
    v_mfma_f32_16x16x32_bf16 v[108:111], v[68:71], a[92:95], v[108:111]
    ds_read_b64_tr_b16 v[84:85], v13 offset:40960
    s_add_u32 m0, s59, 8192
    v_mfma_f32_16x16x32_bf16 v[104:107], v[68:71], a[88:91], v[104:107]
    buffer_load_dwordx4 v2, s[28:31], s60 offen offset:0 sc1 lds
    v_mfma_f32_16x16x32_bf16 v[104:107], v[64:67], a[72:75], v[104:107]
    ds_read_b64_tr_b16 v[86:87], v13 offset:43008
    ds_read_b64_tr_b16 v[88:89], v13 offset:36864
    v_mfma_f32_16x16x32_bf16 v[100:103], v[64:67], a[68:71], v[100:103]
    ds_read_b64_tr_b16 v[90:91], v13 offset:38912
    ds_read_b64_tr_b16 v[92:93], v13 offset:45056
    v_mfma_f32_16x16x32_bf16 v[100:103], v[68:71], a[84:87], v[100:103]
    ds_read_b64_tr_b16 v[94:95], v13 offset:47104
    s_waitcnt vmcnt(10)
    v_mfma_f32_16x16x32_bf16 v[96:99], v[68:71], a[80:83], v[96:99]
    buffer_load_dwordx4 v2, s[28:31], s60 offen offset:1024 sc1 lds
    v_mfma_f32_16x16x32_bf16 v[96:99], v[64:67], a[64:67], v[96:99]
    ds_read_b64_tr_b16 a[96:97], v8 offset:0
    ds_read_b64_tr_b16 a[100:101], v9 offset:0
    v_mfma_f32_16x16x32_bf16 v[112:115], v[72:75], a[64:67], v[112:115]
    ds_read_b64_tr_b16 a[104:105], v10 offset:0
    ds_read_b64_tr_b16 a[108:109], v11 offset:0
    v_mfma_f32_16x16x32_bf16 v[112:115], v[76:79], a[80:83], v[112:115]
    v_mfma_f32_16x16x32_bf16 v[116:119], v[76:79], a[84:87], v[116:119]
    buffer_load_dwordx4 v2, s[28:31], s60 offen offset:2048 sc1 lds
    v_mfma_f32_16x16x32_bf16 v[116:119], v[72:75], a[68:71], v[116:119]
    v_mfma_f32_16x16x32_bf16 v[120:123], v[72:75], a[72:75], v[120:123]
    v_mfma_f32_16x16x32_bf16 v[120:123], v[76:79], a[88:91], v[120:123]
    v_mfma_f32_16x16x32_bf16 v[124:127], v[76:79], a[92:95], v[124:127]
    v_mfma_f32_16x16x32_bf16 v[124:127], v[72:75], a[76:79], v[124:127]
    s_waitcnt lgkmcnt(0)
    v_mfma_f32_16x16x32_bf16 v[140:143], v[80:83], a[76:79], v[140:143]
    buffer_load_dwordx4 v2, s[28:31], s60 offen offset:3072 sc1 lds
    v_mfma_f32_16x16x32_bf16 v[140:143], v[84:87], a[92:95], v[140:143]
    s_add_u32 s60, s60, 4096
    ds_read_b64_tr_b16 v[64:65], v14 offset:32768
    v_mfma_f32_16x16x32_bf16 v[136:139], v[84:87], a[88:91], v[136:139]
    ds_read_b64_tr_b16 v[66:67], v14 offset:34816
    ds_read_b64_tr_b16 v[68:69], v14 offset:40960
    v_mfma_f32_16x16x32_bf16 v[136:139], v[80:83], a[72:75], v[136:139]
    ds_read_b64_tr_b16 v[70:71], v14 offset:43008
    s_add_u32 m0, s59, 0
    v_mfma_f32_16x16x32_bf16 v[132:135], v[80:83], a[68:71], v[132:135]
    buffer_load_dwordx4 v2, s[28:31], s60 offen offset:0 sc1 lds
    v_mfma_f32_16x16x32_bf16 v[132:135], v[84:87], a[84:87], v[132:135]
    ds_read_b64_tr_b16 v[72:73], v14 offset:36864
    ds_read_b64_tr_b16 v[74:75], v14 offset:38912
    v_mfma_f32_16x16x32_bf16 v[128:131], v[84:87], a[80:83], v[128:131]
    ds_read_b64_tr_b16 v[76:77], v14 offset:45056
    ds_read_b64_tr_b16 v[78:79], v14 offset:47104
    v_mfma_f32_16x16x32_bf16 v[128:131], v[80:83], a[64:67], v[128:131]
    s_waitcnt vmcnt(12)
    ds_read_b64_tr_b16 a[98:99], v8 offset:2048
    v_mfma_f32_16x16x32_bf16 v[144:147], v[88:91], a[64:67], v[144:147]
    buffer_load_dwordx4 v2, s[28:31], s60 offen offset:1024 sc1 lds
    v_mfma_f32_16x16x32_bf16 v[144:147], v[92:95], a[80:83], v[144:147]
    ds_read_b64_tr_b16 a[102:103], v9 offset:2048
    ds_read_b64_tr_b16 a[106:107], v10 offset:2048
    v_mfma_f32_16x16x32_bf16 v[148:151], v[92:95], a[84:87], v[148:151]
    ds_read_b64_tr_b16 a[110:111], v11 offset:2048
    v_mfma_f32_16x16x32_bf16 v[148:151], v[88:91], a[68:71], v[148:151]
    v_mfma_f32_16x16x32_bf16 v[152:155], v[88:91], a[72:75], v[152:155]
    v_mfma_f32_16x16x32_bf16 v[152:155], v[92:95], a[88:91], v[152:155]
    v_mfma_f32_16x16x32_bf16 v[156:159], v[92:95], a[92:95], v[156:159]
    v_mfma_f32_16x16x32_bf16 v[156:159], v[88:91], a[76:79], v[156:159]
    s_waitcnt lgkmcnt(0)
    v_mfma_f32_16x16x32_bf16 v[172:175], v[64:67], a[76:79], v[172:175]
    ds_read_b64_tr_b16 v[80:81], v15 offset:32768
    v_mfma_f32_16x16x32_bf16 v[172:175], v[68:71], a[92:95], v[172:175]
    buffer_load_dwordx4 v2, s[28:31], s60 offen offset:2048 sc1 lds
    v_mfma_f32_16x16x32_bf16 v[168:171], v[68:71], a[88:91], v[168:171]
    ds_read_b64_tr_b16 v[82:83], v15 offset:34816
    v_mfma_f32_16x16x32_bf16 v[168:171], v[64:67], a[72:75], v[168:171]
    ds_read_b64_tr_b16 v[84:85], v15 offset:40960
    v_mfma_f32_16x16x32_bf16 v[164:167], v[64:67], a[68:71], v[164:167]
    ds_read_b64_tr_b16 v[86:87], v15 offset:43008
    v_mfma_f32_16x16x32_bf16 v[164:167], v[68:71], a[84:87], v[164:167]
    buffer_load_dwordx4 v2, s[28:31], s60 offen offset:3072 sc1 lds
    v_mfma_f32_16x16x32_bf16 v[160:163], v[68:71], a[80:83], v[160:163]
    s_add_u32 s60, s60, 4096
    ds_read_b64_tr_b16 v[88:89], v15 offset:36864
    v_mfma_f32_16x16x32_bf16 v[160:163], v[64:67], a[64:67], v[160:163]
    ds_read_b64_tr_b16 v[90:91], v15 offset:38912
    v_mfma_f32_16x16x32_bf16 v[176:179], v[72:75], a[64:67], v[176:179]
    ds_read_b64_tr_b16 v[92:93], v15 offset:45056
    v_mfma_f32_16x16x32_bf16 v[176:179], v[76:79], a[80:83], v[176:179]
    ds_read_b64_tr_b16 v[94:95], v15 offset:47104
    v_mfma_f32_16x16x32_bf16 v[180:183], v[76:79], a[84:87], v[180:183]
    v_mfma_f32_16x16x32_bf16 v[180:183], v[72:75], a[68:71], v[180:183]
    v_mfma_f32_16x16x32_bf16 v[184:187], v[72:75], a[72:75], v[184:187]
    v_mfma_f32_16x16x32_bf16 v[184:187], v[76:79], a[88:91], v[184:187]
    v_mfma_f32_16x16x32_bf16 v[188:191], v[76:79], a[92:95], v[188:191]
    v_mfma_f32_16x16x32_bf16 v[188:191], v[72:75], a[76:79], v[188:191]
    s_waitcnt lgkmcnt(0)
    v_mfma_f32_16x16x32_bf16 v[204:207], v[80:83], a[76:79], v[204:207]
    s_barrier
    ds_read_b64_tr_b16 v[64:65], v12 offset:49152
    v_mfma_f32_16x16x32_bf16 v[204:207], v[84:87], a[92:95], v[204:207]
    buffer_load_dword v40, v29, s[28:31], s32 offen sc1
    v_mfma_f32_16x16x32_bf16 v[200:203], v[84:87], a[88:91], v[200:203]
    s_add_u32 s32, s32, 36864
    ds_read_b64_tr_b16 v[66:67], v12 offset:51200
    v_mfma_f32_16x16x32_bf16 v[200:203], v[80:83], a[72:75], v[200:203]
    ds_read_b64_tr_b16 v[68:69], v16 offset:0
    ds_read_b64_tr_b16 v[70:71], v16 offset:2048
    v_mfma_f32_16x16x32_bf16 v[196:199], v[80:83], a[68:71], v[196:199]
    ds_read_b64_tr_b16 v[72:73], v12 offset:53248
    ds_read_b64_tr_b16 v[74:75], v12 offset:55296
    v_mfma_f32_16x16x32_bf16 v[196:199], v[84:87], a[84:87], v[196:199]
    buffer_load_dword v41, v29, s[28:31], s32 offen sc1
    v_mfma_f32_16x16x32_bf16 v[192:195], v[84:87], a[80:83], v[192:195]
    s_add_u32 s32, s32, 36864
    ds_read_b64_tr_b16 v[76:77], v16 offset:4096
    v_mfma_f32_16x16x32_bf16 v[192:195], v[80:83], a[64:67], v[192:195]
    ds_read_b64_tr_b16 v[78:79], v16 offset:6144
    s_waitcnt vmcnt(12)
    v_mfma_f32_16x16x32_bf16 v[208:211], v[88:91], a[64:67], v[208:211]
    ds_read_b64_tr_b16 a[112:113], v8 offset:4096
    ds_read_b64_tr_b16 a[116:117], v9 offset:4096
    v_mfma_f32_16x16x32_bf16 v[208:211], v[92:95], a[80:83], v[208:211]
    buffer_load_dword v42, v29, s[28:31], s32 offen sc1
    v_mfma_f32_16x16x32_bf16 v[212:215], v[92:95], a[84:87], v[212:215]
    s_add_u32 s32, s32, 36864
    ds_read_b64_tr_b16 a[120:121], v10 offset:4096
    v_mfma_f32_16x16x32_bf16 v[212:215], v[88:91], a[68:71], v[212:215]
    ds_read_b64_tr_b16 a[124:125], v11 offset:4096
    s_waitcnt vmcnt(11)
    v_mfma_f32_16x16x32_bf16 v[216:219], v[88:91], a[72:75], v[216:219]
    ds_read_b64_tr_b16 a[114:115], v8 offset:6144
    ds_read_b64_tr_b16 a[118:119], v9 offset:6144
    v_mfma_f32_16x16x32_bf16 v[216:219], v[92:95], a[88:91], v[216:219]
    buffer_load_dword v43, v29, s[28:31], s32 offen sc1
    v_mfma_f32_16x16x32_bf16 v[220:223], v[92:95], a[92:95], v[220:223]
    s_add_u32 s32, s32, 36864
    ds_read_b64_tr_b16 a[122:123], v10 offset:6144
    v_mfma_f32_16x16x32_bf16 v[220:223], v[88:91], a[76:79], v[220:223]
    ds_read_b64_tr_b16 a[126:127], v11 offset:6144
    s_waitcnt lgkmcnt(0)
    v_mfma_f32_16x16x32_bf16 v[48:51], v[20:23], a[64:67], v[48:51]
    ds_read_b64_tr_b16 v[80:81], v13 offset:49152
    ds_read_b64_tr_b16 v[82:83], v13 offset:51200
    v_mfma_f32_16x16x32_bf16 v[48:51], v[20:23], a[80:83], v[48:51]
    ds_read_b64_tr_b16 v[84:85], v17 offset:0
    s_add_u32 m0, s59, 4096
    v_mfma_f32_16x16x32_bf16 v[48:51], v[20:23], a[96:99], v[48:51]
    buffer_load_dwordx4 v2, s[28:31], s60 offen offset:0 sc1 lds
    v_mfma_f32_16x16x32_bf16 v[48:51], v[20:23], a[112:115], v[48:51]
    ds_read_b64_tr_b16 v[86:87], v17 offset:2048
    ds_read_b64_tr_b16 v[88:89], v13 offset:53248
    v_mfma_f32_16x16x32_bf16 v[108:111], v[64:67], a[108:111], v[108:111]
    ds_read_b64_tr_b16 v[90:91], v13 offset:55296
    ds_read_b64_tr_b16 v[92:93], v17 offset:4096
    v_mfma_f32_16x16x32_bf16 v[108:111], v[68:71], a[124:127], v[108:111]
    ds_read_b64_tr_b16 v[94:95], v17 offset:6144
    s_waitcnt vmcnt(11)
    v_mfma_f32_16x16x32_bf16 v[104:107], v[68:71], a[120:123], v[104:107]
    buffer_load_dwordx4 v2, s[28:31], s60 offen offset:1024 sc1 lds
    v_mfma_f32_16x16x32_bf16 v[104:107], v[64:67], a[104:107], v[104:107]
    ds_read_b64_tr_b16 a[128:129], v8 offset:8192
    ds_read_b64_tr_b16 a[132:133], v9 offset:8192
    v_mfma_f32_16x16x32_bf16 v[100:103], v[64:67], a[100:103], v[100:103]
    ds_read_b64_tr_b16 a[136:137], v10 offset:8192
    ds_read_b64_tr_b16 a[140:141], v11 offset:8192
    v_mfma_f32_16x16x32_bf16 v[100:103], v[68:71], a[116:119], v[100:103]
    s_waitcnt vmcnt(10)
    ds_read_b64_tr_b16 a[130:131], v8 offset:10240
    v_mfma_f32_16x16x32_bf16 v[96:99], v[68:71], a[112:115], v[96:99]
    buffer_load_dwordx4 v2, s[28:31], s60 offen offset:2048 sc1 lds
    v_mfma_f32_16x16x32_bf16 v[96:99], v[64:67], a[96:99], v[96:99]
    ds_read_b64_tr_b16 a[134:135], v9 offset:10240
    ds_read_b64_tr_b16 a[138:139], v10 offset:10240
    v_mfma_f32_16x16x32_bf16 v[112:115], v[72:75], a[96:99], v[112:115]
    ds_read_b64_tr_b16 a[142:143], v11 offset:10240
    v_mfma_f32_16x16x32_bf16 v[112:115], v[76:79], a[112:115], v[112:115]
    v_mfma_f32_16x16x32_bf16 v[116:119], v[76:79], a[116:119], v[116:119]
    v_mfma_f32_16x16x32_bf16 v[116:119], v[72:75], a[100:103], v[116:119]
    buffer_load_dwordx4 v2, s[28:31], s60 offen offset:3072 sc1 lds
    v_mfma_f32_16x16x32_bf16 v[120:123], v[72:75], a[104:107], v[120:123]
    s_add_u32 s60, s60, 4096
    v_mfma_f32_16x16x32_bf16 v[120:123], v[76:79], a[120:123], v[120:123]
    v_mfma_f32_16x16x32_bf16 v[124:127], v[76:79], a[124:127], v[124:127]
    v_mfma_f32_16x16x32_bf16 v[124:127], v[72:75], a[108:111], v[124:127]
    s_waitcnt lgkmcnt(0)
    v_mfma_f32_16x16x32_bf16 v[44:47], a[64:67], a[64:67], v[44:47]
    buffer_load_dword v4, v29, s[28:31], s32 offen sc1
    v_mfma_f32_16x16x32_bf16 v[44:47], a[80:83], a[80:83], v[44:47]
    s_add_u32 s32, s32, 36864
    ds_read_b64_tr_b16 v[64:65], v14 offset:49152
    v_mfma_f32_16x16x32_bf16 v[44:47], a[96:99], a[96:99], v[44:47]
    ds_read_b64_tr_b16 v[66:67], v14 offset:51200
    ds_read_b64_tr_b16 v[68:69], v18 offset:0
    v_mfma_f32_16x16x32_bf16 v[44:47], a[112:115], a[112:115], v[44:47]
    ds_read_b64_tr_b16 v[70:71], v18 offset:2048
    s_add_u32 m0, s59, 8192
    v_mfma_f32_16x16x32_bf16 v[140:143], v[80:83], a[108:111], v[140:143]
    buffer_load_dwordx4 v2, s[28:31], s60 offen offset:0 sc1 lds
    v_mfma_f32_16x16x32_bf16 v[140:143], v[84:87], a[124:127], v[140:143]
    ds_read_b64_tr_b16 v[72:73], v14 offset:53248
    ds_read_b64_tr_b16 v[74:75], v14 offset:55296
    v_mfma_f32_16x16x32_bf16 v[136:139], v[84:87], a[120:123], v[136:139]
    ds_read_b64_tr_b16 v[76:77], v18 offset:4096
    ds_read_b64_tr_b16 v[78:79], v18 offset:6144
    v_mfma_f32_16x16x32_bf16 v[136:139], v[80:83], a[104:107], v[136:139]
    s_waitcnt vmcnt(12)
    ds_read_b64_tr_b16 a[144:145], v8 offset:0
    v_mfma_f32_16x16x32_bf16 v[132:135], v[80:83], a[100:103], v[132:135]
    buffer_load_dwordx4 v2, s[28:31], s60 offen offset:1024 sc1 lds
    v_mfma_f32_16x16x32_bf16 v[132:135], v[84:87], a[116:119], v[132:135]
    ds_read_b64_tr_b16 a[148:149], v9 offset:0
    ds_read_b64_tr_b16 a[152:153], v10 offset:0
    v_mfma_f32_16x16x32_bf16 v[128:131], v[84:87], a[112:115], v[128:131]
    ds_read_b64_tr_b16 a[156:157], v11 offset:0
    s_waitcnt vmcnt(11)
    v_mfma_f32_16x16x32_bf16 v[128:131], v[80:83], a[96:99], v[128:131]
    ds_read_b64_tr_b16 a[146:147], v8 offset:2048
    ds_read_b64_tr_b16 a[150:151], v9 offset:2048
    v_mfma_f32_16x16x32_bf16 v[144:147], v[88:91], a[96:99], v[144:147]
    buffer_load_dwordx4 v2, s[28:31], s60 offen offset:2048 sc1 lds
    v_mfma_f32_16x16x32_bf16 v[144:147], v[92:95], a[112:115], v[144:147]
    ds_read_b64_tr_b16 a[154:155], v10 offset:2048
    ds_read_b64_tr_b16 a[158:159], v11 offset:2048
    v_mfma_f32_16x16x32_bf16 v[148:151], v[92:95], a[116:119], v[148:151]
    v_mfma_f32_16x16x32_bf16 v[148:151], v[88:91], a[100:103], v[148:151]
    v_mfma_f32_16x16x32_bf16 v[152:155], v[88:91], a[104:107], v[152:155]
    v_mfma_f32_16x16x32_bf16 v[152:155], v[92:95], a[120:123], v[152:155]
    buffer_load_dwordx4 v2, s[28:31], s60 offen offset:3072 sc1 lds
    v_mfma_f32_16x16x32_bf16 v[156:159], v[92:95], a[124:127], v[156:159]
    s_add_u32 s60, s60, 4096
    v_mfma_f32_16x16x32_bf16 v[156:159], v[88:91], a[108:111], v[156:159]
    s_waitcnt lgkmcnt(0)
    v_mfma_f32_16x16x32_bf16 v[172:175], v[64:67], a[108:111], v[172:175]
    ds_read_b64_tr_b16 v[80:81], v15 offset:49152
    s_add_u32 m0, s59, 0
    v_mfma_f32_16x16x32_bf16 v[172:175], v[68:71], a[124:127], v[172:175]
    buffer_load_dwordx4 v2, s[28:31], s60 offen offset:0 sc1 lds
    v_mfma_f32_16x16x32_bf16 v[168:171], v[68:71], a[120:123], v[168:171]
    ds_read_b64_tr_b16 v[82:83], v15 offset:51200
    v_mfma_f32_16x16x32_bf16 v[168:171], v[64:67], a[104:107], v[168:171]
    ds_read_b64_tr_b16 v[84:85], v19 offset:0
    v_mfma_f32_16x16x32_bf16 v[164:167], v[64:67], a[100:103], v[164:167]
    ds_read_b64_tr_b16 v[86:87], v19 offset:2048
    v_mfma_f32_16x16x32_bf16 v[164:167], v[68:71], a[116:119], v[164:167]
    buffer_load_dwordx4 v2, s[28:31], s60 offen offset:1024 sc1 lds
    v_mfma_f32_16x16x32_bf16 v[160:163], v[68:71], a[112:115], v[160:163]
    ds_read_b64_tr_b16 v[88:89], v15 offset:53248
    v_mfma_f32_16x16x32_bf16 v[160:163], v[64:67], a[96:99], v[160:163]
    ds_read_b64_tr_b16 v[90:91], v15 offset:55296
    v_mfma_f32_16x16x32_bf16 v[176:179], v[72:75], a[96:99], v[176:179]
    ds_read_b64_tr_b16 v[92:93], v19 offset:4096
    v_mfma_f32_16x16x32_bf16 v[176:179], v[76:79], a[112:115], v[176:179]
    ds_read_b64_tr_b16 v[94:95], v19 offset:6144
    v_mfma_f32_16x16x32_bf16 v[180:183], v[76:79], a[116:119], v[180:183]
    buffer_load_dwordx4 v2, s[28:31], s60 offen offset:2048 sc1 lds
    v_mfma_f32_16x16x32_bf16 v[180:183], v[72:75], a[100:103], v[180:183]
    v_mfma_f32_16x16x32_bf16 v[184:187], v[72:75], a[104:107], v[184:187]
    v_mfma_f32_16x16x32_bf16 v[184:187], v[76:79], a[120:123], v[184:187]
    v_mfma_f32_16x16x32_bf16 v[188:191], v[76:79], a[124:127], v[188:191]
    buffer_load_dwordx4 v2, s[28:31], s60 offen offset:3072 sc1 lds
    v_mfma_f32_16x16x32_bf16 v[188:191], v[72:75], a[108:111], v[188:191]
    s_add_u32 s60, s60, 4096
    s_waitcnt lgkmcnt(0)
    v_mfma_f32_16x16x32_bf16 v[204:207], v[80:83], a[108:111], v[204:207]
    ds_read_b64_tr_b16 v[64:65], v16 offset:8192
    ds_read_b64_tr_b16 v[66:67], v16 offset:10240
    v_mfma_f32_16x16x32_bf16 v[204:207], v[84:87], a[124:127], v[204:207]
    ds_read_b64_tr_b16 v[68:69], v16 offset:16384
    ds_read_b64_tr_b16 v[70:71], v16 offset:18432
    v_mfma_f32_16x16x32_bf16 v[200:203], v[84:87], a[120:123], v[200:203]
    buffer_load_dword v5, v29, s[28:31], s32 offen sc1
    v_mfma_f32_16x16x32_bf16 v[200:203], v[80:83], a[104:107], v[200:203]
    ds_read_b64_tr_b16 v[72:73], v16 offset:12288
    ds_read_b64_tr_b16 v[74:75], v16 offset:14336
    v_mfma_f32_16x16x32_bf16 v[196:199], v[80:83], a[100:103], v[196:199]
    ds_read_b64_tr_b16 v[76:77], v16 offset:20480
    ds_read_b64_tr_b16 v[78:79], v16 offset:22528
    v_mfma_f32_16x16x32_bf16 v[196:199], v[84:87], a[116:119], v[196:199]
    s_waitcnt vmcnt(12)
    ds_read_b64_tr_b16 a[160:161], v8 offset:4096
    v_mfma_f32_16x16x32_bf16 v[192:195], v[84:87], a[112:115], v[192:195]
    ds_read_b64_tr_b16 a[164:165], v9 offset:4096
    s_add_u32 m0, s58, 49152
    v_mfma_f32_16x16x32_bf16 v[192:195], v[80:83], a[96:99], v[192:195]
    buffer_load_dwordx4 v3, s[40:43], s72 offen lds
    v_mfma_f32_16x16x32_bf16 v[208:211], v[88:91], a[96:99], v[208:211]
    s_add_u32 s72, s72, 294912
    ds_read_b64_tr_b16 a[168:169], v10 offset:4096
    v_mfma_f32_16x16x32_bf16 v[208:211], v[92:95], a[112:115], v[208:211]
    ds_read_b64_tr_b16 a[172:173], v11 offset:4096
    v_mfma_f32_16x16x32_bf16 v[212:215], v[92:95], a[116:119], v[212:215]
    s_add_u32 m0, s58, 53248
    v_mfma_f32_16x16x32_bf16 v[212:215], v[88:91], a[100:103], v[212:215]
    buffer_load_dwordx4 v3, s[20:23], s72 offen lds
    v_mfma_f32_16x16x32_bf16 v[216:219], v[88:91], a[104:107], v[216:219]
    v_mfma_f32_16x16x32_bf16 v[216:219], v[92:95], a[120:123], v[216:219]
    v_mfma_f32_16x16x32_bf16 v[220:223], v[92:95], a[124:127], v[220:223]
    v_mfma_f32_16x16x32_bf16 v[220:223], v[88:91], a[108:111], v[220:223]
    s_add_u32 m0, s58, 57344
    s_waitcnt lgkmcnt(0)
    v_mfma_f32_16x16x32_bf16 v[108:111], v[64:67], a[140:143], v[108:111]
    buffer_load_dwordx4 v3, s[40:43], s72 offen lds
    v_mfma_f32_16x16x32_bf16 v[108:111], v[68:71], a[156:159], v[108:111]
    s_add_u32 s72, s72, 294912
    ds_read_b64_tr_b16 v[80:81], v17 offset:8192
    v_mfma_f32_16x16x32_bf16 v[104:107], v[68:71], a[152:155], v[104:107]
    ds_read_b64_tr_b16 v[82:83], v17 offset:10240
    ds_read_b64_tr_b16 v[84:85], v17 offset:16384
    v_mfma_f32_16x16x32_bf16 v[104:107], v[64:67], a[136:139], v[104:107]
    ds_read_b64_tr_b16 v[86:87], v17 offset:18432
    s_add_u32 m0, s59, 4096
    v_mfma_f32_16x16x32_bf16 v[100:103], v[64:67], a[132:135], v[100:103]
    buffer_load_dwordx4 v2, s[28:31], s60 offen offset:0 sc1 lds
    v_mfma_f32_16x16x32_bf16 v[100:103], v[68:71], a[148:151], v[100:103]
    ds_read_b64_tr_b16 v[88:89], v17 offset:12288
    ds_read_b64_tr_b16 v[90:91], v17 offset:14336
    v_mfma_f32_16x16x32_bf16 v[96:99], v[68:71], a[144:147], v[96:99]
    ds_read_b64_tr_b16 v[92:93], v17 offset:20480
    ds_read_b64_tr_b16 v[94:95], v17 offset:22528
    v_mfma_f32_16x16x32_bf16 v[96:99], v[64:67], a[128:131], v[96:99]
    s_waitcnt vmcnt(14)
    ds_read_b64_tr_b16 a[162:163], v8 offset:6144
    v_mfma_f32_16x16x32_bf16 v[112:115], v[72:75], a[128:131], v[112:115]
    buffer_load_dwordx4 v2, s[28:31], s60 offen offset:1024 sc1 lds
    v_mfma_f32_16x16x32_bf16 v[112:115], v[76:79], a[144:147], v[112:115]
    ds_read_b64_tr_b16 a[166:167], v9 offset:6144
    ds_read_b64_tr_b16 a[170:171], v10 offset:6144
    v_mfma_f32_16x16x32_bf16 v[116:119], v[76:79], a[148:151], v[116:119]
    ds_read_b64_tr_b16 a[174:175], v11 offset:6144
    s_waitcnt vmcnt(12)
    v_mfma_f32_16x16x32_bf16 v[116:119], v[72:75], a[132:135], v[116:119]
    ds_read_b64_tr_b16 a[176:177], v8 offset:8192
    s_add_u32 m0, s58, 61440
    v_mfma_f32_16x16x32_bf16 v[120:123], v[72:75], a[136:139], v[120:123]
    buffer_load_dwordx4 v3, s[20:23], s72 offen lds
    v_mfma_f32_16x16x32_bf16 v[120:123], v[76:79], a[152:155], v[120:123]
    ds_read_b64_tr_b16 a[180:181], v9 offset:8192
    ds_read_b64_tr_b16 a[184:185], v10 offset:8192
    v_mfma_f32_16x16x32_bf16 v[124:127], v[76:79], a[156:159], v[124:127]
    ds_read_b64_tr_b16 a[188:189], v11 offset:8192
    v_mfma_f32_16x16x32_bf16 v[124:127], v[72:75], a[140:143], v[124:127]
    s_waitcnt lgkmcnt(0)
    v_mfma_f32_16x16x32_bf16 v[140:143], v[80:83], a[140:143], v[140:143]
    ds_read_b64_tr_b16 v[64:65], v18 offset:8192
    s_add_u32 m0, s59, 4096
    v_mfma_f32_16x16x32_bf16 v[140:143], v[84:87], a[156:159], v[140:143]
    buffer_load_dwordx4 v2, s[28:31], s60 offen offset:2048 sc1 lds
    v_mfma_f32_16x16x32_bf16 v[136:139], v[84:87], a[152:155], v[136:139]
    ds_read_b64_tr_b16 v[66:67], v18 offset:10240
    ds_read_b64_tr_b16 v[68:69], v18 offset:16384
    v_mfma_f32_16x16x32_bf16 v[136:139], v[80:83], a[136:139], v[136:139]
    ds_read_b64_tr_b16 v[70:71], v18 offset:18432
    ds_read_b64_tr_b16 v[72:73], v18 offset:12288
    v_mfma_f32_16x16x32_bf16 v[132:135], v[80:83], a[132:135], v[132:135]
    ds_read_b64_tr_b16 v[74:75], v18 offset:14336
    ds_read_b64_tr_b16 v[76:77], v18 offset:20480
    v_mfma_f32_16x16x32_bf16 v[132:135], v[84:87], a[148:151], v[132:135]
    buffer_load_dwordx4 v2, s[28:31], s60 offen offset:3072 sc1 lds
    v_mfma_f32_16x16x32_bf16 v[128:131], v[84:87], a[144:147], v[128:131]
    s_add_u32 s60, s60, 4096
    ds_read_b64_tr_b16 v[78:79], v18 offset:22528
ffn_c_h1:
    s_cbranch_execz ffn_c_h1_1
    v_mfma_f32_16x16x32_bf16 v[128:131], v[80:83], a[128:131], v[128:131]
    s_waitcnt vmcnt(13)
    ds_read_b64_tr_b16 a[178:179], v8 offset:10240
    v_mfma_f32_16x16x32_bf16 v[144:147], v[88:91], a[128:131], v[144:147]
    ds_read_b64_tr_b16 a[182:183], v9 offset:10240
    s_add_u32 m0, s59, 8192
    v_mfma_f32_16x16x32_bf16 v[144:147], v[92:95], a[144:147], v[144:147]
    buffer_load_dwordx4 v2, s[28:31], s60 offen offset:0 sc1 lds
    v_mfma_f32_16x16x32_bf16 v[148:151], v[92:95], a[148:151], v[148:151]
    ds_read_b64_tr_b16 a[186:187], v10 offset:10240
    ds_read_b64_tr_b16 a[190:191], v11 offset:10240
    v_mfma_f32_16x16x32_bf16 v[148:151], v[88:91], a[132:135], v[148:151]
    v_mfma_f32_16x16x32_bf16 v[152:155], v[88:91], a[136:139], v[152:155]
    v_mfma_f32_16x16x32_bf16 v[152:155], v[92:95], a[152:155], v[152:155]
    v_mfma_f32_16x16x32_bf16 v[156:159], v[92:95], a[156:159], v[156:159]
    buffer_load_dwordx4 v2, s[28:31], s60 offen offset:1024 sc1 lds
    v_mfma_f32_16x16x32_bf16 v[156:159], v[88:91], a[140:143], v[156:159]
    s_waitcnt lgkmcnt(0)
    v_mfma_f32_16x16x32_bf16 v[48:51], v[20:23], a[128:131], v[48:51]
    ds_read_b64_tr_b16 v[80:81], v19 offset:8192
    ds_read_b64_tr_b16 v[82:83], v19 offset:10240
    v_mfma_f32_16x16x32_bf16 v[48:51], v[20:23], a[144:147], v[48:51]
    ds_read_b64_tr_b16 v[84:85], v19 offset:16384
    ds_read_b64_tr_b16 v[86:87], v19 offset:18432
    v_mfma_f32_16x16x32_bf16 v[48:51], v[20:23], a[160:163], v[48:51]
    buffer_load_dwordx4 v2, s[28:31], s60 offen offset:2048 sc1 lds
    v_mfma_f32_16x16x32_bf16 v[48:51], v[20:23], a[176:179], v[48:51]
    ds_read_b64_tr_b16 v[88:89], v19 offset:12288
    ds_read_b64_tr_b16 v[90:91], v19 offset:14336
    v_mfma_f32_16x16x32_bf16 v[172:175], v[64:67], a[140:143], v[172:175]
    ds_read_b64_tr_b16 v[92:93], v19 offset:20480
    ds_read_b64_tr_b16 v[94:95], v19 offset:22528
    v_mfma_f32_16x16x32_bf16 v[172:175], v[68:71], a[156:159], v[172:175]
    s_waitcnt vmcnt(14)
    ds_read_b64_tr_b16 a[192:193], v8 offset:0
    v_mfma_f32_16x16x32_bf16 v[168:171], v[68:71], a[152:155], v[168:171]
    buffer_load_dwordx4 v2, s[28:31], s60 offen offset:3072 sc1 lds
    v_mfma_f32_16x16x32_bf16 v[168:171], v[64:67], a[136:139], v[168:171]
    s_add_u32 s60, s60, 4096
    ds_read_b64_tr_b16 a[196:197], v9 offset:0
    v_mfma_f32_16x16x32_bf16 v[164:167], v[64:67], a[132:135], v[164:167]
ffn_c_h1_1:
    s_cbranch_execz ffn_c_h1_2
    ds_read_b64_tr_b16 a[200:201], v10 offset:0
    ds_read_b64_tr_b16 a[204:205], v11 offset:0
    v_mfma_f32_16x16x32_bf16 v[164:167], v[68:71], a[148:151], v[164:167]
    s_waitcnt vmcnt(13)
    ds_read_b64_tr_b16 a[194:195], v8 offset:2048
    v_mfma_f32_16x16x32_bf16 v[160:163], v[68:71], a[144:147], v[160:163]
    ds_read_b64_tr_b16 a[198:199], v9 offset:2048
    s_add_u32 m0, s58, 65536
    v_mfma_f32_16x16x32_bf16 v[160:163], v[64:67], a[128:131], v[160:163]
    buffer_load_dwordx4 v3, s[40:43], s72 offen lds
    v_mfma_f32_16x16x32_bf16 v[176:179], v[72:75], a[128:131], v[176:179]
    s_add_u32 s72, s72, 294912
    ds_read_b64_tr_b16 a[202:203], v10 offset:2048
    v_mfma_f32_16x16x32_bf16 v[176:179], v[76:79], a[144:147], v[176:179]
    ds_read_b64_tr_b16 a[206:207], v11 offset:2048
    v_mfma_f32_16x16x32_bf16 v[180:183], v[76:79], a[148:151], v[180:183]
    s_add_u32 m0, s58, 69632
    v_mfma_f32_16x16x32_bf16 v[180:183], v[72:75], a[132:135], v[180:183]
    buffer_load_dwordx4 v3, s[20:23], s72 offen lds
    v_mfma_f32_16x16x32_bf16 v[184:187], v[72:75], a[136:139], v[184:187]
    v_mfma_f32_16x16x32_bf16 v[184:187], v[76:79], a[152:155], v[184:187]
    v_mfma_f32_16x16x32_bf16 v[188:191], v[76:79], a[156:159], v[188:191]
    v_mfma_f32_16x16x32_bf16 v[188:191], v[72:75], a[140:143], v[188:191]
    s_add_u32 m0, s58, 73728
    s_waitcnt lgkmcnt(0)
    v_mfma_f32_16x16x32_bf16 v[44:47], a[128:131], a[128:131], v[44:47]
    buffer_load_dwordx4 v3, s[40:43], s72 offen lds
    v_mfma_f32_16x16x32_bf16 v[44:47], a[144:147], a[144:147], v[44:47]
    s_add_u32 s72, s72, 294912
    s_waitcnt vmcnt(14)
    v_mfma_f32_16x16x32_bf16 v[44:47], a[160:163], a[160:163], v[44:47]
    s_barrier
    ds_read_b64_tr_b16 v[64:65], v16 offset:24576
    v_mfma_f32_16x16x32_bf16 v[44:47], a[176:179], a[176:179], v[44:47]
    ds_read_b64_tr_b16 v[66:67], v16 offset:26624
    s_add_u32 m0, s59, 0
    v_mfma_f32_16x16x32_bf16 v[204:207], v[80:83], a[140:143], v[204:207]
    buffer_load_dwordx4 v2, s[28:31], s60 offen offset:0 sc1 lds
    v_mfma_f32_16x16x32_bf16 v[204:207], v[84:87], a[156:159], v[204:207]
    ds_read_b64_tr_b16 v[68:69], v16 offset:32768
    ds_read_b64_tr_b16 v[70:71], v16 offset:34816
    v_mfma_f32_16x16x32_bf16 v[200:203], v[84:87], a[152:155], v[200:203]
ffn_c_h1_2:
    s_cbranch_execz ffn_c_h5
    ds_read_b64_tr_b16 v[72:73], v16 offset:40960
    ds_read_b64_tr_b16 v[74:75], v16 offset:43008
    v_mfma_f32_16x16x32_bf16 v[200:203], v[80:83], a[136:139], v[200:203]
    ds_read_b64_tr_b16 v[76:77], v16 offset:49152
    ds_read_b64_tr_b16 v[78:79], v16 offset:51200
    v_mfma_f32_16x16x32_bf16 v[196:199], v[80:83], a[132:135], v[196:199]
    buffer_load_dwordx4 v2, s[28:31], s60 offen offset:1024 sc1 lds
    v_mfma_f32_16x16x32_bf16 v[196:199], v[84:87], a[148:151], v[196:199]
    s_waitcnt vmcnt(12)
    ds_read_b64_tr_b16 a[208:209], v8 offset:4096
    v_mfma_f32_16x16x32_bf16 v[192:195], v[84:87], a[144:147], v[192:195]
    ds_read_b64_tr_b16 a[212:213], v9 offset:4096
    ds_read_b64_tr_b16 a[216:217], v10 offset:4096
    v_mfma_f32_16x16x32_bf16 v[192:195], v[80:83], a[128:131], v[192:195]
    ds_read_b64_tr_b16 a[220:221], v11 offset:4096
    s_waitcnt vmcnt(9)
    v_mfma_f32_16x16x32_bf16 v[208:211], v[88:91], a[128:131], v[208:211]
    buffer_load_dwordx4 v2, s[28:31], s60 offen offset:2048 sc1 lds
    v_mfma_f32_16x16x32_bf16 v[208:211], v[92:95], a[144:147], v[208:211]
    ds_read_b64_tr_b16 a[210:211], v8 offset:6144
    ds_read_b64_tr_b16 a[214:215], v9 offset:6144
    v_mfma_f32_16x16x32_bf16 v[212:215], v[92:95], a[148:151], v[212:215]
    ds_read_b64_tr_b16 a[218:219], v10 offset:6144
    ds_read_b64_tr_b16 a[222:223], v11 offset:6144
    v_mfma_f32_16x16x32_bf16 v[212:215], v[88:91], a[132:135], v[212:215]
    v_mfma_f32_16x16x32_bf16 v[216:219], v[88:91], a[136:139], v[216:219]
    v_mfma_f32_16x16x32_bf16 v[216:219], v[92:95], a[152:155], v[216:219]
    buffer_load_dwordx4 v2, s[28:31], s60 offen offset:3072 sc1 lds
    v_mfma_f32_16x16x32_bf16 v[220:223], v[92:95], a[156:159], v[220:223]
    s_add_u32 s60, s60, 4096
    v_mfma_f32_16x16x32_bf16 v[220:223], v[88:91], a[140:143], v[220:223]
    s_waitcnt lgkmcnt(0)
    v_mfma_f32_16x16x32_bf16 v[48:51], v[20:23], a[192:195], v[48:51]
    ds_read_b64_tr_b16 v[80:81], v16 offset:28672
    s_add_u32 m0, s59, 4096
    v_mfma_f32_16x16x32_bf16 v[48:51], v[20:23], a[208:211], v[48:51]
    buffer_load_dwordx4 v2, s[28:31], s60 offen offset:0 sc1 lds
    v_mfma_f32_16x16x32_bf16 v[108:111], v[64:67], a[172:175], v[108:111]
    ds_read_b64_tr_b16 v[82:83], v16 offset:30720
    v_mfma_f32_16x16x32_bf16 v[108:111], v[68:71], a[188:191], v[108:111]
    ds_read_b64_tr_b16 v[84:85], v16 offset:36864
    v_mfma_f32_16x16x32_bf16 v[108:111], v[72:75], a[204:207], v[108:111]
    ds_read_b64_tr_b16 v[86:87], v16 offset:38912
    v_mfma_f32_16x16x32_bf16 v[108:111], v[76:79], a[220:223], v[108:111]
    buffer_load_dwordx4 v2, s[28:31], s60 offen offset:1024 sc1 lds
    v_mfma_f32_16x16x32_bf16 v[104:107], v[76:79], a[216:219], v[104:107]
    ds_read_b64_tr_b16 v[88:89], v16 offset:45056
    v_mfma_f32_16x16x32_bf16 v[104:107], v[72:75], a[200:203], v[104:107]
    ds_read_b64_tr_b16 v[90:91], v16 offset:47104
    v_mfma_f32_16x16x32_bf16 v[104:107], v[68:71], a[184:187], v[104:107]
    v_mov_b32 v49, s96
    ds_read_b64_tr_b16 v[92:93], v12 offset:0
    v_mfma_f32_16x16x32_bf16 v[104:107], v[64:67], a[168:171], v[104:107]
    ds_read_b64_tr_b16 v[94:95], v12 offset:2048
    v_mfma_f32_16x16x32_bf16 v[100:103], v[64:67], a[164:167], v[100:103]
    buffer_store_dwordx2 v[48:49], v39, s[28:31], s24 offen sc1
    v_mfma_f32_16x16x32_bf16 v[100:103], v[68:71], a[180:183], v[100:103]
    v_mfma_f32_16x16x32_bf16 v[100:103], v[72:75], a[196:199], v[100:103]
    v_mfma_f32_16x16x32_bf16 v[100:103], v[76:79], a[212:215], v[100:103]
    v_mfma_f32_16x16x32_bf16 v[96:99], v[76:79], a[208:211], v[96:99]
    buffer_load_dwordx4 v2, s[28:31], s60 offen offset:2048 sc1 lds
    v_mfma_f32_16x16x32_bf16 v[96:99], v[72:75], a[192:195], v[96:99]
    v_mfma_f32_16x16x32_bf16 v[96:99], v[68:71], a[176:179], v[96:99]
    v_mfma_f32_16x16x32_bf16 v[96:99], v[64:67], a[160:163], v[96:99]
    s_waitcnt lgkmcnt(0)
    v_mfma_f32_16x16x32_bf16 v[44:47], a[192:195], a[192:195], v[44:47]
    buffer_load_dwordx4 v2, s[28:31], s60 offen offset:3072 sc1 lds
    v_mfma_f32_16x16x32_bf16 v[44:47], a[208:211], a[208:211], v[44:47]
    s_add_u32 s60, s60, 4096
    ds_read_b64_tr_b16 v[64:65], v17 offset:24576
    v_mfma_f32_16x16x32_bf16 v[124:127], v[80:83], a[172:175], v[124:127]
    ds_read_b64_tr_b16 v[66:67], v17 offset:26624
    ds_read_b64_tr_b16 v[68:69], v17 offset:32768
    v_mfma_f32_16x16x32_bf16 v[124:127], v[84:87], a[188:191], v[124:127]
    ds_read_b64_tr_b16 v[70:71], v17 offset:34816
    ds_read_b64_tr_b16 v[72:73], v17 offset:40960
    v_mfma_f32_16x16x32_bf16 v[124:127], v[88:91], a[204:207], v[124:127]
    ds_read_b64_tr_b16 v[74:75], v17 offset:43008
    s_add_u32 m0, s58, 77824
    v_mfma_f32_16x16x32_bf16 v[124:127], v[92:95], a[220:223], v[124:127]
    buffer_load_dwordx4 v3, s[20:23], s72 offen lds
    v_mfma_f32_16x16x32_bf16 v[120:123], v[92:95], a[216:219], v[120:123]
    ds_read_b64_tr_b16 v[76:77], v17 offset:49152
    ds_read_b64_tr_b16 v[78:79], v17 offset:51200
    v_mfma_f32_16x16x32_bf16 v[120:123], v[88:91], a[200:203], v[120:123]
    s_waitcnt vmcnt(15)
    ds_read_b64_tr_b16 a[224:225], v8 offset:8192
    v_mfma_f32_16x16x32_bf16 v[120:123], v[84:87], a[184:187], v[120:123]
    ds_read_b64_tr_b16 a[228:229], v9 offset:8192
    s_add_u32 m0, s58, 81920
    v_mfma_f32_16x16x32_bf16 v[120:123], v[80:83], a[168:171], v[120:123]
    buffer_load_dwordx4 v3, s[40:43], s72 offen lds
    v_mfma_f32_16x16x32_bf16 v[116:119], v[80:83], a[164:167], v[116:119]
    s_sub_u32 s72, s72, 5013376
    ds_read_b64_tr_b16 a[232:233], v10 offset:8192
    v_mfma_f32_16x16x32_bf16 v[116:119], v[84:87], a[180:183], v[116:119]
    ds_read_b64_tr_b16 a[236:237], v11 offset:8192
    s_waitcnt vmcnt(14)
    v_mfma_f32_16x16x32_bf16 v[116:119], v[88:91], a[196:199], v[116:119]
    ds_read_b64_tr_b16 a[226:227], v8 offset:10240
    s_add_u32 m0, s58, 86016
    v_mfma_f32_16x16x32_bf16 v[116:119], v[92:95], a[212:215], v[116:119]
    buffer_load_dwordx4 v31, s[28:31], m0 offen sc1 lds
    v_mfma_f32_16x16x32_bf16 v[112:115], v[92:95], a[208:211], v[112:115]
    ds_read_b64_tr_b16 a[230:231], v9 offset:10240
    ds_read_b64_tr_b16 a[234:235], v10 offset:10240
    v_mfma_f32_16x16x32_bf16 v[112:115], v[88:91], a[192:195], v[112:115]
    ds_read_b64_tr_b16 a[238:239], v11 offset:10240
    v_mfma_f32_16x16x32_bf16 v[112:115], v[84:87], a[176:179], v[112:115]
    v_mfma_f32_16x16x32_bf16 v[112:115], v[80:83], a[160:163], v[112:115]
    s_add_u32 m0, s58, 90112
    s_waitcnt lgkmcnt(0)
    v_mfma_f32_16x16x32_bf16 v[140:143], v[64:67], a[172:175], v[140:143]
    buffer_load_dwordx4 v31, s[28:31], m0 offen sc1 lds
    v_mfma_f32_16x16x32_bf16 v[140:143], v[68:71], a[188:191], v[140:143]
    ds_read_b64_tr_b16 v[80:81], v17 offset:28672
    ds_read_b64_tr_b16 v[82:83], v17 offset:30720
    v_mfma_f32_16x16x32_bf16 v[140:143], v[72:75], a[204:207], v[140:143]
    ds_read_b64_tr_b16 v[84:85], v17 offset:36864
    ds_read_b64_tr_b16 v[86:87], v17 offset:38912
    v_mfma_f32_16x16x32_bf16 v[140:143], v[76:79], a[220:223], v[140:143]
    ds_read_b64_tr_b16 v[88:89], v17 offset:45056
    s_add_u32 m0, s59, 8192
    v_mfma_f32_16x16x32_bf16 v[136:139], v[76:79], a[216:219], v[136:139]
    buffer_load_dwordx4 v2, s[28:31], s60 offen offset:0 sc1 lds
    v_mfma_f32_16x16x32_bf16 v[136:139], v[72:75], a[200:203], v[136:139]
    ds_read_b64_tr_b16 v[90:91], v17 offset:47104
    ds_read_b64_tr_b16 v[92:93], v13 offset:0
    v_mfma_f32_16x16x32_bf16 v[136:139], v[68:71], a[184:187], v[136:139]
    ds_read_b64_tr_b16 v[94:95], v13 offset:2048
    s_waitcnt vmcnt(12)
    v_mfma_f32_16x16x32_bf16 v[136:139], v[64:67], a[168:171], v[136:139]
    ds_read_b64_tr_b16 a[240:241], v8 offset:0
    ds_read_b64_tr_b16 a[244:245], v9 offset:0
    v_mfma_f32_16x16x32_bf16 v[132:135], v[64:67], a[164:167], v[132:135]
    buffer_load_dwordx4 v2, s[28:31], s60 offen offset:1024 sc1 lds
    v_mfma_f32_16x16x32_bf16 v[132:135], v[68:71], a[180:183], v[132:135]
    ds_read_b64_tr_b16 a[248:249], v10 offset:0
    ds_read_b64_tr_b16 a[252:253], v11 offset:0
    v_mfma_f32_16x16x32_bf16 v[132:135], v[72:75], a[196:199], v[132:135]
    v_mfma_f32_16x16x32_bf16 v[132:135], v[76:79], a[212:215], v[132:135]
    v_mfma_f32_16x16x32_bf16 v[128:131], v[76:79], a[208:211], v[128:131]
    buffer_load_dwordx4 v2, s[28:31], s60 offen offset:2048 sc1 lds
    v_mfma_f32_16x16x32_bf16 v[128:131], v[72:75], a[192:195], v[128:131]
    v_mfma_f32_16x16x32_bf16 v[128:131], v[68:71], a[176:179], v[128:131]
    v_mfma_f32_16x16x32_bf16 v[128:131], v[64:67], a[160:163], v[128:131]
    s_waitcnt lgkmcnt(0)
    v_mfma_f32_16x16x32_bf16 v[156:159], v[80:83], a[172:175], v[156:159]
    ds_read_b64_tr_b16 v[64:65], v18 offset:24576
    ds_read_b64_tr_b16 v[66:67], v18 offset:26624
    v_mfma_f32_16x16x32_bf16 v[156:159], v[84:87], a[188:191], v[156:159]
    buffer_load_dwordx4 v2, s[28:31], s60 offen offset:3072 sc1 lds
    v_mfma_f32_16x16x32_bf16 v[156:159], v[88:91], a[204:207], v[156:159]
    s_add_u32 s60, s60, 4096
    ds_read_b64_tr_b16 v[68:69], v18 offset:32768
    v_mfma_f32_16x16x32_bf16 v[156:159], v[92:95], a[220:223], v[156:159]
    ds_read_b64_tr_b16 v[70:71], v18 offset:34816
    ds_read_b64_tr_b16 v[72:73], v18 offset:40960
    v_mfma_f32_16x16x32_bf16 v[152:155], v[92:95], a[216:219], v[152:155]
    ds_read_b64_tr_b16 v[74:75], v18 offset:43008
    s_add_u32 m0, s58, 94208
    v_mfma_f32_16x16x32_bf16 v[152:155], v[88:91], a[200:203], v[152:155]
    buffer_load_dwordx4 v31, s[28:31], m0 offen sc1 lds
    v_mfma_f32_16x16x32_bf16 v[152:155], v[84:87], a[184:187], v[152:155]
    ds_read_b64_tr_b16 v[76:77], v18 offset:49152
    ds_read_b64_tr_b16 v[78:79], v18 offset:51200
    v_mfma_f32_16x16x32_bf16 v[152:155], v[80:83], a[168:171], v[152:155]
    s_waitcnt vmcnt(14)
    ds_read_b64_tr_b16 a[242:243], v8 offset:2048
    v_mfma_f32_16x16x32_bf16 v[148:151], v[80:83], a[164:167], v[148:151]
    ds_read_b64_tr_b16 a[246:247], v9 offset:2048
    s_add_u32 m0, s58, 98304
    v_mfma_f32_16x16x32_bf16 v[148:151], v[84:87], a[180:183], v[148:151]
    buffer_load_dwordx4 v31, s[28:31], m0 offen sc1 lds
    v_mfma_f32_16x16x32_bf16 v[148:151], v[88:91], a[196:199], v[148:151]
    ds_read_b64_tr_b16 a[250:251], v10 offset:2048
    ds_read_b64_tr_b16 a[254:255], v11 offset:2048
    v_mfma_f32_16x16x32_bf16 v[148:151], v[92:95], a[212:215], v[148:151]
    s_waitcnt vmcnt(13)
    ds_read_b64_tr_b16 v[224:225], v8 offset:4096
    v_mfma_f32_16x16x32_bf16 v[144:147], v[92:95], a[208:211], v[144:147]
    ds_read_b64_tr_b16 v[228:229], v9 offset:4096
    ds_read_b64_tr_b16 v[232:233], v10 offset:4096
    v_mfma_f32_16x16x32_bf16 v[144:147], v[88:91], a[192:195], v[144:147]
    ds_read_b64_tr_b16 v[236:237], v11 offset:4096
    s_add_u32 m0, s58, 102400
    v_mfma_f32_16x16x32_bf16 v[144:147], v[84:87], a[176:179], v[144:147]
    buffer_load_dwordx4 v31, s[28:31], m0 offen sc1 lds
    v_mfma_f32_16x16x32_bf16 v[144:147], v[80:83], a[160:163], v[144:147]
    s_waitcnt lgkmcnt(0)
    v_mfma_f32_16x16x32_bf16 v[172:175], v[64:67], a[172:175], v[172:175]
    ds_read_b64_tr_b16 v[80:81], v18 offset:28672
    ds_read_b64_tr_b16 v[82:83], v18 offset:30720
    v_mfma_f32_16x16x32_bf16 v[172:175], v[68:71], a[188:191], v[172:175]
    ds_read_b64_tr_b16 v[84:85], v18 offset:36864
    s_add_u32 m0, s58, 106496
    v_mfma_f32_16x16x32_bf16 v[172:175], v[72:75], a[204:207], v[172:175]
    buffer_load_dwordx4 v31, s[28:31], m0 offen sc1 lds
    v_mfma_f32_16x16x32_bf16 v[172:175], v[76:79], a[220:223], v[172:175]
    ds_read_b64_tr_b16 v[86:87], v18 offset:38912
    ds_read_b64_tr_b16 v[88:89], v18 offset:45056
    v_mfma_f32_16x16x32_bf16 v[168:171], v[76:79], a[216:219], v[168:171]
    ds_read_b64_tr_b16 v[90:91], v18 offset:47104
    ds_read_b64_tr_b16 v[92:93], v14 offset:0
    v_mfma_f32_16x16x32_bf16 v[168:171], v[72:75], a[200:203], v[168:171]
    ds_read_b64_tr_b16 v[94:95], v14 offset:2048
    s_add_u32 m0, s58, 110592
    v_mfma_f32_16x16x32_bf16 v[168:171], v[68:71], a[184:187], v[168:171]
    buffer_load_dwordx4 v31, s[28:31], m0 offen sc1 lds
    v_mfma_f32_16x16x32_bf16 v[168:171], v[64:67], a[168:171], v[168:171]
    s_waitcnt vmcnt(13)
    ds_read_b64_tr_b16 v[226:227], v8 offset:6144
    v_mfma_f32_16x16x32_bf16 v[164:167], v[64:67], a[164:167], v[164:167]
    ds_read_b64_tr_b16 v[230:231], v9 offset:6144
    ds_read_b64_tr_b16 v[234:235], v10 offset:6144
    v_mfma_f32_16x16x32_bf16 v[164:167], v[68:71], a[180:183], v[164:167]
    ds_read_b64_tr_b16 v[238:239], v11 offset:6144
    v_add_f32 v40, v40, v41
    v_mfma_f32_16x16x32_bf16 v[164:167], v[72:75], a[196:199], v[164:167]
    v_add_f32 v42, v42, v43
    s_add_u32 m0, s58, 114688
    v_mfma_f32_16x16x32_bf16 v[164:167], v[76:79], a[212:215], v[164:167]
    buffer_load_dwordx4 v31, s[28:31], m0 offen sc1 lds
    v_mfma_f32_16x16x32_bf16 v[160:163], v[76:79], a[208:211], v[160:163]
    v_add_f32 v4, v4, v5
    v_add_f32 v40, v40, v42
    v_mfma_f32_16x16x32_bf16 v[160:163], v[72:75], a[192:195], v[160:163]
    v_add_f32 v40, v40, v4
    ds_write_b32 v28, v40
    v_mfma_f32_16x16x32_bf16 v[160:163], v[68:71], a[176:179], v[160:163]
    v_mfma_f32_16x16x32_bf16 v[160:163], v[64:67], a[160:163], v[160:163]
    s_add_u32 m0, s58, 118784
    s_waitcnt lgkmcnt(0)
    v_mfma_f32_16x16x32_bf16 v[188:191], v[80:83], a[172:175], v[188:191]
    buffer_load_dwordx4 v31, s[28:31], m0 offen sc1 lds
    v_mfma_f32_16x16x32_bf16 v[188:191], v[84:87], a[188:191], v[188:191]
    ds_read_b64_tr_b16 v[64:65], v19 offset:24576
    v_mfma_f32_16x16x32_bf16 v[188:191], v[88:91], a[204:207], v[188:191]
    ds_read_b64_tr_b16 v[66:67], v19 offset:26624
    v_mfma_f32_16x16x32_bf16 v[188:191], v[92:95], a[220:223], v[188:191]
    ds_read_b64_tr_b16 v[68:69], v19 offset:32768
    s_add_u32 m0, s58, 122880
    v_mfma_f32_16x16x32_bf16 v[184:187], v[92:95], a[216:219], v[184:187]
    buffer_load_dwordx4 v3, s[20:23], s72 offen lds
    v_mfma_f32_16x16x32_bf16 v[184:187], v[88:91], a[200:203], v[184:187]
    ds_read_b64_tr_b16 v[70:71], v19 offset:34816
    v_mfma_f32_16x16x32_bf16 v[184:187], v[84:87], a[184:187], v[184:187]
    ds_read_b64_tr_b16 v[72:73], v19 offset:40960
    v_mfma_f32_16x16x32_bf16 v[184:187], v[80:83], a[168:171], v[184:187]
    ds_read_b64_tr_b16 v[74:75], v19 offset:43008
    v_mfma_f32_16x16x32_bf16 v[180:183], v[80:83], a[164:167], v[180:183]
    buffer_load_dwordx2 v[52:53], v38, s[28:31], s25 offen sc1
    v_mfma_f32_16x16x32_bf16 v[180:183], v[84:87], a[180:183], v[180:183]
    ds_read_b64_tr_b16 v[76:77], v19 offset:49152
    v_mfma_f32_16x16x32_bf16 v[180:183], v[88:91], a[196:199], v[180:183]
    ds_read_b64_tr_b16 v[78:79], v19 offset:51200
    v_mfma_f32_16x16x32_bf16 v[180:183], v[92:95], a[212:215], v[180:183]
    v_mfma_f32_16x16x32_bf16 v[176:179], v[92:95], a[208:211], v[176:179]
    buffer_load_dwordx2 v[56:57], v38, s[28:31], s26 offen sc1
    v_mfma_f32_16x16x32_bf16 v[176:179], v[88:91], a[192:195], v[176:179]
    v_mfma_f32_16x16x32_bf16 v[176:179], v[84:87], a[176:179], v[176:179]
    v_mfma_f32_16x16x32_bf16 v[176:179], v[80:83], a[160:163], v[176:179]
    s_waitcnt lgkmcnt(0)
    v_mfma_f32_16x16x32_bf16 v[204:207], v[64:67], a[172:175], v[204:207]
    ds_read_b64_tr_b16 v[80:81], v19 offset:28672
    ds_read_b64_tr_b16 v[82:83], v19 offset:30720
    v_mfma_f32_16x16x32_bf16 v[204:207], v[68:71], a[188:191], v[204:207]
    buffer_load_dwordx2 v[60:61], v38, s[28:31], s27 offen sc1
    v_mfma_f32_16x16x32_bf16 v[204:207], v[72:75], a[204:207], v[204:207]
    ds_read_b64_tr_b16 v[84:85], v19 offset:36864
    ds_read_b64_tr_b16 v[86:87], v19 offset:38912
    v_mfma_f32_16x16x32_bf16 v[204:207], v[76:79], a[220:223], v[204:207]
    ds_read_b64_tr_b16 v[88:89], v19 offset:45056
    ds_read_b64_tr_b16 v[90:91], v19 offset:47104
    v_mfma_f32_16x16x32_bf16 v[200:203], v[76:79], a[216:219], v[200:203]
    ds_read_b64_tr_b16 v[92:93], v15 offset:0
    s_add_u32 m0, s58, 126976
    v_mfma_f32_16x16x32_bf16 v[200:203], v[72:75], a[200:203], v[200:203]
    buffer_load_dwordx4 v3, s[40:43], s72 offen lds
    v_mfma_f32_16x16x32_bf16 v[200:203], v[68:71], a[184:187], v[200:203]
    s_add_u32 s72, s72, 294912
    ds_read_b64_tr_b16 v[94:95], v15 offset:2048
    v_mfma_f32_16x16x32_bf16 v[200:203], v[64:67], a[168:171], v[200:203]
    s_waitcnt vmcnt(14)
    ds_read_b64_tr_b16 v[240:241], v8 offset:8192
    v_mfma_f32_16x16x32_bf16 v[196:199], v[64:67], a[164:167], v[196:199]
    ds_read_b64_tr_b16 v[244:245], v9 offset:8192
    ds_read_b64_tr_b16 v[248:249], v10 offset:8192
    v_mfma_f32_16x16x32_bf16 v[196:199], v[68:71], a[180:183], v[196:199]
    ds_read_b64_tr_b16 v[252:253], v11 offset:8192
    s_waitcnt vmcnt(12)
    v_mfma_f32_16x16x32_bf16 v[196:199], v[72:75], a[196:199], v[196:199]
    ds_read_b64_tr_b16 v[242:243], v8 offset:10240
    ds_read_b64_tr_b16 v[246:247], v9 offset:10240
    v_mfma_f32_16x16x32_bf16 v[196:199], v[76:79], a[212:215], v[196:199]
    ds_read_b64_tr_b16 v[250:251], v10 offset:10240
    ds_read_b64_tr_b16 v[254:255], v11 offset:10240
    v_mfma_f32_16x16x32_bf16 v[192:195], v[76:79], a[208:211], v[192:195]
    v_mfma_f32_16x16x32_bf16 v[192:195], v[72:75], a[192:195], v[192:195]
    v_mfma_f32_16x16x32_bf16 v[192:195], v[68:71], a[176:179], v[192:195]
    v_mfma_f32_16x16x32_bf16 v[192:195], v[64:67], a[160:163], v[192:195]
    s_waitcnt lgkmcnt(0)
    v_mfma_f32_16x16x32_bf16 v[220:223], v[80:83], a[172:175], v[220:223]
    s_barrier
    s_add_u32 m0, s58, 131072
    v_mfma_f32_16x16x32_bf16 v[220:223], v[84:87], a[188:191], v[220:223]
    buffer_load_dwordx4 v3, s[20:23], s72 offen lds
    v_mfma_f32_16x16x32_bf16 v[220:223], v[88:91], a[204:207], v[220:223]
    ds_read_b64_tr_b16 v[64:65], v12 offset:4096
    ds_read_b64_tr_b16 v[66:67], v12 offset:6144
    v_mfma_f32_16x16x32_bf16 v[220:223], v[92:95], a[220:223], v[220:223]
    ds_read_b64_tr_b16 v[68:69], v12 offset:12288
    ds_read_b64_tr_b16 v[70:71], v12 offset:14336
    v_mfma_f32_16x16x32_bf16 v[216:219], v[92:95], a[216:219], v[216:219]
    ds_read_b64_tr_b16 v[72:73], v12 offset:20480
    s_add_u32 m0, s58, 135168
    v_mfma_f32_16x16x32_bf16 v[216:219], v[88:91], a[200:203], v[216:219]
    buffer_load_dwordx4 v3, s[40:43], s72 offen lds
    v_mfma_f32_16x16x32_bf16 v[216:219], v[84:87], a[184:187], v[216:219]
    s_add_u32 s72, s72, 294912
    ds_read_b64_tr_b16 v[74:75], v12 offset:22528
    v_mfma_f32_16x16x32_bf16 v[216:219], v[80:83], a[168:171], v[216:219]
    ds_read_b64_tr_b16 v[76:77], v12 offset:28672
    ds_read_b64_tr_b16 v[78:79], v12 offset:30720
    v_mfma_f32_16x16x32_bf16 v[212:215], v[80:83], a[164:167], v[212:215]
    s_add_u32 m0, s58, 139264
    v_mfma_f32_16x16x32_bf16 v[212:215], v[84:87], a[180:183], v[212:215]
    buffer_load_dwordx4 v3, s[20:23], s72 offen lds
    v_mfma_f32_16x16x32_bf16 v[212:215], v[88:91], a[196:199], v[212:215]
    v_mfma_f32_16x16x32_bf16 v[212:215], v[92:95], a[212:215], v[212:215]
    v_mfma_f32_16x16x32_bf16 v[208:211], v[92:95], a[208:211], v[208:211]
    s_add_u32 m0, s58, 143360
    v_mfma_f32_16x16x32_bf16 v[208:211], v[88:91], a[192:195], v[208:211]
    buffer_load_dwordx4 v3, s[40:43], s72 offen lds
    v_mfma_f32_16x16x32_bf16 v[208:211], v[84:87], a[176:179], v[208:211]
    s_add_u32 s72, s72, 294912
    v_mfma_f32_16x16x32_bf16 v[208:211], v[80:83], a[160:163], v[208:211]
    s_waitcnt lgkmcnt(0)
    v_mfma_f32_16x16x32_bf16 v[108:111], v[64:67], a[236:239], v[108:111]
    ds_read_b64_tr_b16 v[80:81], v12 offset:8192
    v_mfma_f32_16x16x32_bf16 v[108:111], v[68:71], a[252:255], v[108:111]
    ds_read_b64_tr_b16 v[82:83], v12 offset:10240
    v_mfma_f32_16x16x32_bf16 v[108:111], v[72:75], v[236:239], v[108:111]
    ds_read_b64_tr_b16 v[84:85], v12 offset:16384
    s_add_u32 m0, s58, 147456
    v_mfma_f32_16x16x32_bf16 v[108:111], v[76:79], v[252:255], v[108:111]
    buffer_load_dwordx4 v3, s[20:23], s72 offen lds
    v_mfma_f32_16x16x32_bf16 v[104:107], v[76:79], v[248:251], v[104:107]
    ds_read_b64_tr_b16 v[86:87], v12 offset:18432
    v_mfma_f32_16x16x32_bf16 v[104:107], v[72:75], v[232:235], v[104:107]
    ds_read_b64_tr_b16 v[88:89], v12 offset:24576
    v_mfma_f32_16x16x32_bf16 v[104:107], v[68:71], a[248:251], v[104:107]
    ds_read_b64_tr_b16 v[90:91], v12 offset:26624
    v_mfma_f32_16x16x32_bf16 v[104:107], v[64:67], a[232:235], v[104:107]
    ds_read_b64_tr_b16 v[92:93], v12 offset:32768
    v_mfma_f32_16x16x32_bf16 v[100:103], v[64:67], a[228:231], v[100:103]
    ds_read_b64_tr_b16 v[94:95], v12 offset:34816
    s_add_u32 m0, s58, 151552
    v_mfma_f32_16x16x32_bf16 v[100:103], v[68:71], a[244:247], v[100:103]
    buffer_load_dwordx4 v3, s[40:43], s72 offen lds
    v_mfma_f32_16x16x32_bf16 v[100:103], v[72:75], v[228:231], v[100:103]
    s_add_u32 s72, s72, 294912
    v_mfma_f32_16x16x32_bf16 v[100:103], v[76:79], v[244:247], v[100:103]
    v_mfma_f32_16x16x32_bf16 v[96:99], v[76:79], v[240:243], v[96:99]
    v_mfma_f32_16x16x32_bf16 v[96:99], v[72:75], v[224:227], v[96:99]
    v_mfma_f32_16x16x32_bf16 v[96:99], v[68:71], a[240:243], v[96:99]
    v_mfma_f32_16x16x32_bf16 v[96:99], v[64:67], a[224:227], v[96:99]
    s_add_u32 m0, s58, 155648
    s_waitcnt lgkmcnt(0)
    v_mfma_f32_16x16x32_bf16 v[124:127], v[80:83], a[236:239], v[124:127]
    buffer_load_dwordx4 v3, s[20:23], s72 offen lds
    v_mfma_f32_16x16x32_bf16 v[124:127], v[84:87], a[252:255], v[124:127]
    ds_read_b64_tr_b16 v[64:65], v13 offset:4096
    v_mfma_f32_16x16x32_bf16 v[124:127], v[88:91], v[236:239], v[124:127]
    ds_read_b64_tr_b16 v[66:67], v13 offset:6144
    v_mfma_f32_16x16x32_bf16 v[124:127], v[92:95], v[252:255], v[124:127]
    ds_read_b64_tr_b16 v[68:69], v13 offset:12288
    v_mfma_f32_16x16x32_bf16 v[120:123], v[92:95], v[248:251], v[120:123]
    ds_read_b64_tr_b16 v[70:71], v13 offset:14336
    v_mfma_f32_16x16x32_bf16 v[120:123], v[88:91], v[232:235], v[120:123]
    s_waitcnt vmcnt(8)
    ds_read_b64_tr_b16 v[72:73], v13 offset:20480
    v_mfma_f32_16x16x32_bf16 v[120:123], v[84:87], a[248:251], v[120:123]
    v_xor_b32 v53, s96, v53
    ds_read_b64_tr_b16 v[74:75], v13 offset:22528
    v_mfma_f32_16x16x32_bf16 v[120:123], v[80:83], a[232:235], v[120:123]
    v_bitop3_b32 v53, v57, s96, v53 bitop3:0xbe
    ds_read_b64_tr_b16 v[76:77], v13 offset:28672
    v_mfma_f32_16x16x32_bf16 v[116:119], v[80:83], a[228:231], v[116:119]
    v_bitop3_b32 v53, v61, s96, v53 bitop3:0xbe
    ds_read_b64_tr_b16 v[78:79], v13 offset:30720
    v_mfma_f32_16x16x32_bf16 v[116:119], v[84:87], a[244:247], v[116:119]
    v_cmp_ne_u32 vcc, 0, v53
    v_mfma_f32_16x16x32_bf16 v[116:119], v[88:91], v[228:231], v[116:119]
    s_cbranch_vccnz ffn_m1
ffn_m2:
    v_mfma_f32_16x16x32_bf16 v[116:119], v[92:95], v[244:247], v[116:119]
    s_add_u32 m0, s58, 49152
    v_mfma_f32_16x16x32_bf16 v[112:115], v[92:95], v[240:243], v[112:115]
    buffer_load_dwordx4 v3, s[40:43], s72 offen lds
    v_mfma_f32_16x16x32_bf16 v[112:115], v[88:91], v[224:227], v[112:115]
    s_add_u32 s72, s72, 294912
    v_mfma_f32_16x16x32_bf16 v[112:115], v[84:87], a[240:243], v[112:115]
    v_mfma_f32_16x16x32_bf16 v[112:115], v[80:83], a[224:227], v[112:115]
    s_waitcnt lgkmcnt(0)
    v_mfma_f32_16x16x32_bf16 v[60:63], v[20:23], a[236:239], v[60:63]
    ds_read_b64_tr_b16 v[80:81], v13 offset:8192
    v_mfma_f32_16x16x32_bf16 v[60:63], v[20:23], a[252:255], v[60:63]
    ds_read_b64_tr_b16 v[82:83], v13 offset:10240
    v_mfma_f32_16x16x32_bf16 v[60:63], v[20:23], v[236:239], v[60:63]
    ds_read_b64_tr_b16 v[84:85], v13 offset:16384
    v_mfma_f32_16x16x32_bf16 v[60:63], v[20:23], v[252:255], v[60:63]
    ds_read_b64_tr_b16 v[86:87], v13 offset:18432
    v_mfma_f32_16x16x32_bf16 v[56:59], v[20:23], a[232:235], v[56:59]
    ds_read_b64_tr_b16 v[88:89], v13 offset:24576
    v_mfma_f32_16x16x32_bf16 v[56:59], v[20:23], a[248:251], v[56:59]
    ds_read_b64_tr_b16 v[90:91], v13 offset:26624
    v_mfma_f32_16x16x32_bf16 v[56:59], v[20:23], v[232:235], v[56:59]
    ds_read_b64_tr_b16 v[92:93], v13 offset:32768
    v_mfma_f32_16x16x32_bf16 v[56:59], v[20:23], v[248:251], v[56:59]
    ds_read_b64_tr_b16 v[94:95], v13 offset:34816
    v_mfma_f32_16x16x32_bf16 v[52:55], v[20:23], a[228:231], v[52:55]
    v_mfma_f32_16x16x32_bf16 v[52:55], v[20:23], a[244:247], v[52:55]
    v_mfma_f32_16x16x32_bf16 v[52:55], v[20:23], v[228:231], v[52:55]
    v_mfma_f32_16x16x32_bf16 v[52:55], v[20:23], v[244:247], v[52:55]
    v_mfma_f32_16x16x32_bf16 v[48:51], v[20:23], a[224:227], v[48:51]
    v_mfma_f32_16x16x32_bf16 v[48:51], v[20:23], a[240:243], v[48:51]
    v_mfma_f32_16x16x32_bf16 v[48:51], v[20:23], v[224:227], v[48:51]
    v_mfma_f32_16x16x32_bf16 v[48:51], v[20:23], v[240:243], v[48:51]
    v_mfma_f32_16x16x32_bf16 v[140:143], v[64:67], a[236:239], v[140:143]
    v_mfma_f32_16x16x32_bf16 v[140:143], v[68:71], a[252:255], v[140:143]
    v_mfma_f32_16x16x32_bf16 v[140:143], v[72:75], v[236:239], v[140:143]
    v_mfma_f32_16x16x32_bf16 v[140:143], v[76:79], v[252:255], v[140:143]
    v_mfma_f32_16x16x32_bf16 v[136:139], v[76:79], v[248:251], v[136:139]
    v_mov_b32 v7, v60
    v_mov_b32 v6, v56
    v_mfma_f32_16x16x32_bf16 v[136:139], v[72:75], v[232:235], v[136:139]
    v_mov_b32 v5, v52
    v_mov_b32 v4, v48
    v_mfma_f32_16x16x32_bf16 v[136:139], v[68:71], a[248:251], v[136:139]
    v_mov_b32 v20, -1
    v_mov_b32 v21, -1
    v_mfma_f32_16x16x32_bf16 v[136:139], v[64:67], a[232:235], v[136:139]
    v_mov_b32 v22, -1
    v_mov_b32 v23, -1
    v_mfma_f32_16x16x32_bf16 v[132:135], v[64:67], a[228:231], v[132:135]
    ds_read_b128 v[40:43], v35 offset:0
    ds_read_b128 v[8:11], v35 offset:256
    v_mfma_f32_16x16x32_bf16 v[132:135], v[68:71], a[244:247], v[132:135]
    v_mfma_f32_16x16x32_bf16 v[132:135], v[72:75], v[228:231], v[132:135]
    buffer_store_dwordx4 v[20:23], v24, s[28:31], s50 offen offset:0 sc1
    v_mfma_f32_16x16x32_bf16 v[132:135], v[76:79], v[244:247], v[132:135]
ffn_c_h2:
    s_cbranch_execz ffn_c_h2_1
    v_mfma_f32_16x16x32_bf16 v[128:131], v[76:79], v[240:243], v[128:131]
    v_mfma_f32_16x16x32_bf16 v[128:131], v[72:75], v[224:227], v[128:131]
    s_waitcnt lgkmcnt(0)
    v_fmac_f32 v108, v7, v40
    v_mfma_f32_16x16x32_bf16 v[128:131], v[68:71], a[240:243], v[128:131]
    v_fmac_f32 v109, v7, v41
    v_fmac_f32 v110, v7, v42
    v_mfma_f32_16x16x32_bf16 v[128:131], v[64:67], a[224:227], v[128:131]
    v_fmac_f32 v111, v7, v43
    v_mfma_f32_16x16x32_bf16 v[44:47], a[224:227], a[224:227], v[44:47]
    buffer_store_dwordx4 v[20:23], v24, s[28:31], s50 offen offset:1024 sc1
    v_mfma_f32_16x16x32_bf16 v[44:47], a[240:243], a[240:243], v[44:47]
    ds_read_b64_tr_b16 v[64:65], v14 offset:4096
    v_fmac_f32 v124, v7, v8
    v_mfma_f32_16x16x32_bf16 v[44:47], v[224:227], v[224:227], v[44:47]
    ds_read_b64_tr_b16 v[66:67], v14 offset:6144
    v_fmac_f32 v125, v7, v9
    v_mfma_f32_16x16x32_bf16 v[44:47], v[240:243], v[240:243], v[44:47]
    ds_read_b64_tr_b16 v[68:69], v14 offset:12288
    v_fmac_f32 v126, v7, v10
    v_mfma_f32_16x16x32_bf16 v[156:159], v[80:83], a[236:239], v[156:159]
    ds_read_b64_tr_b16 v[70:71], v14 offset:14336
    v_fmac_f32 v127, v7, v11
    v_mfma_f32_16x16x32_bf16 v[156:159], v[84:87], a[252:255], v[156:159]
    ds_read_b64_tr_b16 v[72:73], v14 offset:20480
    v_mul_f32 v108, v124, v108
    v_mfma_f32_16x16x32_bf16 v[156:159], v[88:91], v[236:239], v[156:159]
    ds_read_b64_tr_b16 v[74:75], v14 offset:22528
    v_mul_f32 v109, v125, v109
    v_mfma_f32_16x16x32_bf16 v[156:159], v[92:95], v[252:255], v[156:159]
    ds_read_b64_tr_b16 v[76:77], v14 offset:28672
    v_mul_f32 v110, v126, v110
    v_mfma_f32_16x16x32_bf16 v[152:155], v[92:95], v[248:251], v[152:155]
    ds_read_b64_tr_b16 v[78:79], v14 offset:30720
    v_mul_f32 v111, v127, v111
    v_mfma_f32_16x16x32_bf16 v[152:155], v[88:91], v[232:235], v[152:155]
    v_cvt_pk_bf16_f32 v60, v108, v109
    v_cvt_pk_bf16_f32 v61, v110, v111
    v_mfma_f32_16x16x32_bf16 v[152:155], v[84:87], a[248:251], v[152:155]
    buffer_store_dwordx4 v[20:23], v34, s[28:31], s50 offen offset:2048 sc1
    v_mfma_f32_16x16x32_bf16 v[152:155], v[80:83], a[232:235], v[152:155]
    v_fmac_f32 v104, v6, v40
    v_fmac_f32 v105, v6, v41
    v_mfma_f32_16x16x32_bf16 v[148:151], v[80:83], a[228:231], v[148:151]
    v_fmac_f32 v106, v6, v42
    v_fmac_f32 v107, v6, v43
    v_mfma_f32_16x16x32_bf16 v[148:151], v[84:87], a[244:247], v[148:151]
    v_fmac_f32 v120, v6, v8
    v_fmac_f32 v121, v6, v9
ffn_c_h2_1:
    s_cbranch_execz ffn_c_h2_2
    v_mfma_f32_16x16x32_bf16 v[148:151], v[88:91], v[228:231], v[148:151]
    v_fmac_f32 v122, v6, v10
    v_fmac_f32 v123, v6, v11
    v_mfma_f32_16x16x32_bf16 v[148:151], v[92:95], v[244:247], v[148:151]
    v_mul_f32 v104, v120, v104
    v_mul_f32 v105, v121, v105
    v_mfma_f32_16x16x32_bf16 v[144:147], v[92:95], v[240:243], v[144:147]
    v_mul_f32 v106, v122, v106
    v_mul_f32 v107, v123, v107
    v_mfma_f32_16x16x32_bf16 v[144:147], v[88:91], v[224:227], v[144:147]
    v_cvt_pk_bf16_f32 v56, v104, v105
    v_cvt_pk_bf16_f32 v57, v106, v107
    v_mfma_f32_16x16x32_bf16 v[144:147], v[84:87], a[240:243], v[144:147]
    v_fmac_f32 v100, v5, v40
    v_fmac_f32 v101, v5, v41
    v_mfma_f32_16x16x32_bf16 v[144:147], v[80:83], a[224:227], v[144:147]
    v_fmac_f32 v102, v5, v42
    s_waitcnt lgkmcnt(0)
    v_mfma_f32_16x16x32_bf16 v[172:175], v[64:67], a[236:239], v[172:175]
    ds_read_b64_tr_b16 v[80:81], v14 offset:8192
    v_fmac_f32 v103, v5, v43
    v_mfma_f32_16x16x32_bf16 v[172:175], v[68:71], a[252:255], v[172:175]
    buffer_store_dwordx4 v[20:23], v24, s[28:31], s55 offen offset:0 sc1
    v_mfma_f32_16x16x32_bf16 v[172:175], v[72:75], v[236:239], v[172:175]
    ds_read_b64_tr_b16 v[82:83], v14 offset:10240
    v_fmac_f32 v116, v5, v8
    v_mfma_f32_16x16x32_bf16 v[172:175], v[76:79], v[252:255], v[172:175]
    ds_read_b64_tr_b16 v[84:85], v14 offset:16384
    v_fmac_f32 v117, v5, v9
    v_mfma_f32_16x16x32_bf16 v[168:171], v[76:79], v[248:251], v[168:171]
    ds_read_b64_tr_b16 v[86:87], v14 offset:18432
    v_fmac_f32 v118, v5, v10
    v_mfma_f32_16x16x32_bf16 v[168:171], v[72:75], v[232:235], v[168:171]
    ds_read_b64_tr_b16 v[88:89], v14 offset:24576
    v_fmac_f32 v119, v5, v11
    v_mfma_f32_16x16x32_bf16 v[168:171], v[68:71], a[248:251], v[168:171]
    ds_read_b64_tr_b16 v[90:91], v14 offset:26624
    v_mul_f32 v100, v116, v100
    v_mfma_f32_16x16x32_bf16 v[168:171], v[64:67], a[232:235], v[168:171]
    buffer_store_dwordx4 v[20:23], v24, s[28:31], s55 offen offset:1024 sc1
    v_mfma_f32_16x16x32_bf16 v[164:167], v[64:67], a[228:231], v[164:167]
    ds_read_b64_tr_b16 v[92:93], v14 offset:32768
    v_mul_f32 v101, v117, v101
    v_mfma_f32_16x16x32_bf16 v[164:167], v[68:71], a[244:247], v[164:167]
    ds_read_b64_tr_b16 v[94:95], v14 offset:34816
    v_mul_f32 v102, v118, v102
    v_mfma_f32_16x16x32_bf16 v[164:167], v[72:75], v[228:231], v[164:167]
    v_mul_f32 v103, v119, v103
    v_cvt_pk_bf16_f32 v52, v100, v101
ffn_c_h2_2:
    s_cbranch_execz ffn_c_h6
    v_mfma_f32_16x16x32_bf16 v[164:167], v[76:79], v[244:247], v[164:167]
    v_cvt_pk_bf16_f32 v53, v102, v103
    v_fmac_f32 v96, v4, v40
    v_mfma_f32_16x16x32_bf16 v[160:163], v[76:79], v[240:243], v[160:163]
    v_fmac_f32 v97, v4, v41
    v_fmac_f32 v98, v4, v42
    v_mfma_f32_16x16x32_bf16 v[160:163], v[72:75], v[224:227], v[160:163]
    v_fmac_f32 v99, v4, v43
    v_fmac_f32 v112, v4, v8
    v_mfma_f32_16x16x32_bf16 v[160:163], v[68:71], a[240:243], v[160:163]
    v_fmac_f32 v113, v4, v9
    v_fmac_f32 v114, v4, v10
    v_mfma_f32_16x16x32_bf16 v[160:163], v[64:67], a[224:227], v[160:163]
    v_fmac_f32 v115, v4, v11
    s_waitcnt lgkmcnt(0)
    v_mfma_f32_16x16x32_bf16 v[188:191], v[80:83], a[236:239], v[188:191]
    ds_read_b64_tr_b16 v[64:65], v15 offset:4096
    v_mul_f32 v96, v112, v96
    v_mfma_f32_16x16x32_bf16 v[188:191], v[84:87], a[252:255], v[188:191]
    ds_read_b64_tr_b16 v[66:67], v15 offset:6144
    v_mul_f32 v97, v113, v97
    v_mfma_f32_16x16x32_bf16 v[188:191], v[88:91], v[236:239], v[188:191]
    ds_read_b64_tr_b16 v[68:69], v15 offset:12288
    v_mul_f32 v98, v114, v98
    v_mfma_f32_16x16x32_bf16 v[188:191], v[92:95], v[252:255], v[188:191]
    ds_read_b64_tr_b16 v[70:71], v15 offset:14336
    v_mul_f32 v99, v115, v99
    v_mfma_f32_16x16x32_bf16 v[184:187], v[92:95], v[248:251], v[184:187]
    buffer_store_dwordx4 v[20:23], v34, s[28:31], s55 offen offset:2048 sc1
    v_mfma_f32_16x16x32_bf16 v[184:187], v[88:91], v[232:235], v[184:187]
    ds_read_b64_tr_b16 v[72:73], v15 offset:20480
    v_cvt_pk_bf16_f32 v48, v96, v97
    v_mfma_f32_16x16x32_bf16 v[184:187], v[84:87], a[248:251], v[184:187]
    ds_read_b64_tr_b16 v[74:75], v15 offset:22528
    v_cvt_pk_bf16_f32 v49, v98, v99
    v_mfma_f32_16x16x32_bf16 v[184:187], v[80:83], a[232:235], v[184:187]
    ds_read_b64_tr_b16 v[76:77], v15 offset:28672
    ds_read_b128 v[40:43], v35 offset:64
    v_mfma_f32_16x16x32_bf16 v[180:183], v[80:83], a[228:231], v[180:183]
    ds_read_b64_tr_b16 v[78:79], v15 offset:30720
    ds_read_b128 v[8:11], v35 offset:320
    v_mfma_f32_16x16x32_bf16 v[180:183], v[84:87], a[244:247], v[180:183]
    v_mfma_f32_16x16x32_bf16 v[180:183], v[88:91], v[228:231], v[180:183]
    v_mfma_f32_16x16x32_bf16 v[180:183], v[92:95], v[244:247], v[180:183]
    v_mfma_f32_16x16x32_bf16 v[176:179], v[92:95], v[240:243], v[176:179]
    v_mfma_f32_16x16x32_bf16 v[176:179], v[88:91], v[224:227], v[176:179]
    s_waitcnt lgkmcnt(0)
    v_fmac_f32 v140, v7, v40
    v_mfma_f32_16x16x32_bf16 v[176:179], v[84:87], a[240:243], v[176:179]
    v_fmac_f32 v141, v7, v41
    v_fmac_f32 v142, v7, v42
    v_mfma_f32_16x16x32_bf16 v[176:179], v[80:83], a[224:227], v[176:179]
    v_fmac_f32 v143, v7, v43
    v_mfma_f32_16x16x32_bf16 v[204:207], v[64:67], a[236:239], v[204:207]
    ds_read_b64_tr_b16 v[80:81], v15 offset:8192
    v_fmac_f32 v156, v7, v8
    v_mfma_f32_16x16x32_bf16 v[204:207], v[68:71], a[252:255], v[204:207]
    buffer_store_dwordx4 v[20:23], v24, s[28:31], s56 offen offset:0 sc1
    v_mfma_f32_16x16x32_bf16 v[204:207], v[72:75], v[236:239], v[204:207]
    ds_read_b64_tr_b16 v[82:83], v15 offset:10240
    v_fmac_f32 v157, v7, v9
    v_mfma_f32_16x16x32_bf16 v[204:207], v[76:79], v[252:255], v[204:207]
    ds_read_b64_tr_b16 v[84:85], v15 offset:16384
    v_fmac_f32 v158, v7, v10
    v_mfma_f32_16x16x32_bf16 v[200:203], v[76:79], v[248:251], v[200:203]
    ds_read_b64_tr_b16 v[86:87], v15 offset:18432
    v_fmac_f32 v159, v7, v11
    v_mfma_f32_16x16x32_bf16 v[200:203], v[72:75], v[232:235], v[200:203]
    ds_read_b64_tr_b16 v[88:89], v15 offset:24576
    v_mul_f32 v140, v156, v140
    v_mfma_f32_16x16x32_bf16 v[200:203], v[68:71], a[248:251], v[200:203]
    ds_read_b64_tr_b16 v[90:91], v15 offset:26624
    v_mul_f32 v141, v157, v141
    v_mfma_f32_16x16x32_bf16 v[200:203], v[64:67], a[232:235], v[200:203]
    buffer_store_dwordx4 v[20:23], v24, s[28:31], s56 offen offset:1024 sc1
    v_mfma_f32_16x16x32_bf16 v[196:199], v[64:67], a[228:231], v[196:199]
    ds_read_b64_tr_b16 v[92:93], v15 offset:32768
    v_mul_f32 v142, v158, v142
    v_mfma_f32_16x16x32_bf16 v[196:199], v[68:71], a[244:247], v[196:199]
    ds_read_b64_tr_b16 v[94:95], v15 offset:34816
    v_mul_f32 v143, v159, v143
    v_mfma_f32_16x16x32_bf16 v[196:199], v[72:75], v[228:231], v[196:199]
    v_cvt_pk_bf16_f32 v62, v140, v141
    v_cvt_pk_bf16_f32 v63, v142, v143
    v_mfma_f32_16x16x32_bf16 v[196:199], v[76:79], v[244:247], v[196:199]
    v_fmac_f32 v136, v6, v40
    v_fmac_f32 v137, v6, v41
    v_mfma_f32_16x16x32_bf16 v[192:195], v[76:79], v[240:243], v[192:195]
    v_fmac_f32 v138, v6, v42
    v_fmac_f32 v139, v6, v43
    v_mfma_f32_16x16x32_bf16 v[192:195], v[72:75], v[224:227], v[192:195]
    v_fmac_f32 v152, v6, v8
    v_fmac_f32 v153, v6, v9
    v_mfma_f32_16x16x32_bf16 v[192:195], v[68:71], a[240:243], v[192:195]
    v_fmac_f32 v154, v6, v10
    v_fmac_f32 v155, v6, v11
    v_mfma_f32_16x16x32_bf16 v[192:195], v[64:67], a[224:227], v[192:195]
    v_mul_f32 v136, v152, v136
    s_waitcnt lgkmcnt(0)
    v_mfma_f32_16x16x32_bf16 v[220:223], v[80:83], a[236:239], v[220:223]
    s_barrier
    v_mul_f32 v137, v153, v137
    v_mfma_f32_16x16x32_bf16 v[220:223], v[84:87], a[252:255], v[220:223]
    ds_read_b128 v[64:67], v25 offset:28672
    v_mul_f32 v138, v154, v138
    v_mfma_f32_16x16x32_bf16 v[220:223], v[88:91], v[236:239], v[220:223]
    buffer_store_dwordx4 v[60:63], v24, s[28:31], s74 offen sc1
    v_mfma_f32_16x16x32_bf16 v[220:223], v[92:95], v[252:255], v[220:223]
    s_add_u32 s74, s74, 16384
    ds_read_b128 v[68:71], v25 offset:30720
    v_mfma_f32_16x16x32_bf16 v[216:219], v[92:95], v[248:251], v[216:219]
    ds_read_b128 v[72:75], v25 offset:32768
    v_mul_f32 v139, v155, v139
    v_mfma_f32_16x16x32_bf16 v[216:219], v[88:91], v[232:235], v[216:219]
    ds_read_b128 v[76:79], v25 offset:34816
    v_cvt_pk_bf16_f32 v58, v136, v137
    v_mfma_f32_16x16x32_bf16 v[216:219], v[84:87], a[248:251], v[216:219]
    v_cvt_pk_bf16_f32 v59, v138, v139
    v_fmac_f32 v132, v5, v40
    v_mfma_f32_16x16x32_bf16 v[216:219], v[80:83], a[232:235], v[216:219]
    v_fmac_f32 v133, v5, v41
    v_fmac_f32 v134, v5, v42
    v_mfma_f32_16x16x32_bf16 v[212:215], v[80:83], a[228:231], v[212:215]
    v_fmac_f32 v135, v5, v43
    v_fmac_f32 v148, v5, v8
    v_mfma_f32_16x16x32_bf16 v[212:215], v[84:87], a[244:247], v[212:215]
    v_fmac_f32 v149, v5, v9
    v_fmac_f32 v150, v5, v10
    v_mfma_f32_16x16x32_bf16 v[212:215], v[88:91], v[228:231], v[212:215]
    v_fmac_f32 v151, v5, v11
    v_mul_f32 v132, v148, v132
    v_mfma_f32_16x16x32_bf16 v[212:215], v[92:95], v[244:247], v[212:215]
    v_mul_f32 v133, v149, v133
    v_mul_f32 v134, v150, v134
    v_mfma_f32_16x16x32_bf16 v[208:211], v[92:95], v[240:243], v[208:211]
    v_mul_f32 v135, v151, v135
    v_cvt_pk_bf16_f32 v54, v132, v133
    v_mfma_f32_16x16x32_bf16 v[208:211], v[88:91], v[224:227], v[208:211]
    v_cvt_pk_bf16_f32 v55, v134, v135
    v_fmac_f32 v128, v4, v40
    v_mfma_f32_16x16x32_bf16 v[208:211], v[84:87], a[240:243], v[208:211]
    v_fmac_f32 v129, v4, v41
    v_fmac_f32 v130, v4, v42
    v_mfma_f32_16x16x32_bf16 v[208:211], v[80:83], a[224:227], v[208:211]
    v_fmac_f32 v131, v4, v43
    s_waitcnt lgkmcnt(0)
    v_mfma_f32_16x16x32_bf16 v[108:111], v[64:67], a[12:15], 0
    buffer_store_dwordx4 v[56:59], v24, s[28:31], s73 offen sc1
    v_mfma_f32_16x16x32_bf16 v[108:111], v[68:71], a[28:31], v[108:111]
    s_add_u32 s73, s73, 16384
    v_and_b32 v2, 0x3c0, v24
    v_mfma_f32_16x16x32_bf16 v[108:111], v[72:75], a[44:47], v[108:111]
    v_add_u32 v2, v2, v24
    ds_read_b128 v[80:83], v25 offset:29696
    v_mfma_f32_16x16x32_bf16 v[108:111], v[76:79], a[60:63], v[108:111]
    ds_read_b128 v[84:87], v25 offset:31744
    v_fmac_f32 v144, v4, v8
    v_mfma_f32_16x16x32_bf16 v[104:107], v[76:79], a[56:59], 0
    ds_read_b128 v[88:91], v25 offset:33792
    v_fmac_f32 v145, v4, v9
    v_mfma_f32_16x16x32_bf16 v[104:107], v[72:75], a[40:43], v[104:107]
    ds_read_b128 v[92:95], v25 offset:35840
    v_fmac_f32 v146, v4, v10
    v_mfma_f32_16x16x32_bf16 v[104:107], v[68:71], a[24:27], v[104:107]
    v_fmac_f32 v147, v4, v11
    v_mul_f32 v128, v144, v128
    v_mfma_f32_16x16x32_bf16 v[104:107], v[64:67], a[8:11], v[104:107]
    v_mul_f32 v129, v145, v129
    v_mul_f32 v130, v146, v130
    v_mfma_f32_16x16x32_bf16 v[100:103], v[64:67], a[4:7], 0
    v_mul_f32 v131, v147, v131
    v_cvt_pk_bf16_f32 v50, v128, v129
    v_mfma_f32_16x16x32_bf16 v[100:103], v[68:71], a[20:23], v[100:103]
    v_cvt_pk_bf16_f32 v51, v130, v131
    ds_read_b128 v[40:43], v35 offset:128
    v_mfma_f32_16x16x32_bf16 v[100:103], v[72:75], a[36:39], v[100:103]
    ds_read_b128 v[8:11], v35 offset:384
    v_mfma_f32_16x16x32_bf16 v[100:103], v[76:79], a[52:55], v[100:103]
    v_mfma_f32_16x16x32_bf16 v[96:99], v[76:79], a[48:51], 0
    v_mfma_f32_16x16x32_bf16 v[96:99], v[72:75], a[32:35], v[96:99]
    buffer_store_dwordx4 v[52:55], v24, s[28:31], s71 offen sc1
    v_mfma_f32_16x16x32_bf16 v[96:99], v[68:71], a[16:19], v[96:99]
    s_add_u32 s71, s71, 16384
    s_waitcnt lgkmcnt(0)
    v_mfma_f32_16x16x32_bf16 v[96:99], v[64:67], a[0:3], v[96:99]
    v_fmac_f32 v172, v7, v40
    v_mfma_f32_16x16x32_bf16 v[124:127], v[80:83], a[12:15], 0
    ds_read_b128 v[64:67], v25 offset:36864
    v_fmac_f32 v173, v7, v41
    v_mfma_f32_16x16x32_bf16 v[124:127], v[84:87], a[28:31], v[124:127]
    ds_read_b128 v[68:71], v25 offset:38912
    v_fmac_f32 v174, v7, v42
    v_mfma_f32_16x16x32_bf16 v[124:127], v[88:91], a[44:47], v[124:127]
    ds_read_b128 v[72:75], v25 offset:40960
    v_fmac_f32 v175, v7, v43
    v_mfma_f32_16x16x32_bf16 v[124:127], v[92:95], a[60:63], v[124:127]
    ds_read_b128 v[76:79], v25 offset:43008
    v_fmac_f32 v188, v7, v8
    v_mfma_f32_16x16x32_bf16 v[120:123], v[92:95], a[56:59], 0
    v_fmac_f32 v189, v7, v9
    v_fmac_f32 v190, v7, v10
    v_mfma_f32_16x16x32_bf16 v[120:123], v[88:91], a[40:43], v[120:123]
    v_fmac_f32 v191, v7, v11
    v_mul_f32 v172, v188, v172
    v_mfma_f32_16x16x32_bf16 v[120:123], v[84:87], a[24:27], v[120:123]
    v_mul_f32 v173, v189, v173
    v_mul_f32 v174, v190, v174
    v_mfma_f32_16x16x32_bf16 v[120:123], v[80:83], a[8:11], v[120:123]
    v_mul_f32 v175, v191, v175
    v_cvt_pk_bf16_f32 v60, v172, v173
    v_mfma_f32_16x16x32_bf16 v[116:119], v[80:83], a[4:7], 0
    v_cvt_pk_bf16_f32 v61, v174, v175
    v_fmac_f32 v168, v6, v40
    v_mfma_f32_16x16x32_bf16 v[116:119], v[84:87], a[20:23], v[116:119]
    v_fmac_f32 v169, v6, v41
    v_fmac_f32 v170, v6, v42
    v_mfma_f32_16x16x32_bf16 v[116:119], v[88:91], a[36:39], v[116:119]
    buffer_store_dwordx4 v[48:51], v24, s[28:31], s70 offen sc1
    v_mfma_f32_16x16x32_bf16 v[116:119], v[92:95], a[52:55], v[116:119]
    s_add_u32 s70, s70, 16384
    v_fmac_f32 v171, v6, v43
    v_mfma_f32_16x16x32_bf16 v[112:115], v[92:95], a[48:51], 0
    v_fmac_f32 v184, v6, v8
    v_fmac_f32 v185, v6, v9
    v_mfma_f32_16x16x32_bf16 v[112:115], v[88:91], a[32:35], v[112:115]
    v_fmac_f32 v186, v6, v10
    v_fmac_f32 v187, v6, v11
    v_mfma_f32_16x16x32_bf16 v[112:115], v[84:87], a[16:19], v[112:115]
    v_mul_f32 v168, v184, v168
    v_mul_f32 v169, v185, v169
    v_mfma_f32_16x16x32_bf16 v[112:115], v[80:83], a[0:3], v[112:115]
    v_mul_f32 v170, v186, v170
    s_waitcnt lgkmcnt(0)
    v_mfma_f32_16x16x32_bf16 v[108:111], v[64:67], a[76:79], v[108:111]
    ds_read_b128 v[80:83], v25 offset:37888
    v_mul_f32 v171, v187, v171
    v_mfma_f32_16x16x32_bf16 v[108:111], v[68:71], a[92:95], v[108:111]
    ds_read_b128 v[84:87], v25 offset:39936
    v_cvt_pk_bf16_f32 v56, v168, v169
    v_mfma_f32_16x16x32_bf16 v[108:111], v[72:75], a[108:111], v[108:111]
    ds_read_b128 v[88:91], v25 offset:41984
    v_cvt_pk_bf16_f32 v57, v170, v171
    v_mfma_f32_16x16x32_bf16 v[108:111], v[76:79], a[124:127], v[108:111]
    ds_read_b128 v[92:95], v25 offset:44032
    v_fmac_f32 v164, v5, v40
    v_mfma_f32_16x16x32_bf16 v[104:107], v[76:79], a[120:123], v[104:107]
    v_fmac_f32 v165, v5, v41
    v_fmac_f32 v166, v5, v42
    v_mfma_f32_16x16x32_bf16 v[104:107], v[72:75], a[104:107], v[104:107]
    v_fmac_f32 v167, v5, v43
    v_fmac_f32 v180, v5, v8
    v_mfma_f32_16x16x32_bf16 v[104:107], v[68:71], a[88:91], v[104:107]
    v_fmac_f32 v181, v5, v9
    v_fmac_f32 v182, v5, v10
    v_mfma_f32_16x16x32_bf16 v[104:107], v[64:67], a[72:75], v[104:107]
    buffer_store_dwordx4 v[20:23], v34, s[28:31], s56 offen offset:2048 sc1
    v_mfma_f32_16x16x32_bf16 v[100:103], v[64:67], a[68:71], v[100:103]
    v_fmac_f32 v183, v5, v11
    v_mul_f32 v164, v180, v164
    v_mfma_f32_16x16x32_bf16 v[100:103], v[68:71], a[84:87], v[100:103]
    v_mul_f32 v165, v181, v165
    v_mul_f32 v166, v182, v166
    v_mfma_f32_16x16x32_bf16 v[100:103], v[72:75], a[100:103], v[100:103]
    v_mul_f32 v167, v183, v167
    v_cvt_pk_bf16_f32 v52, v164, v165
    v_mfma_f32_16x16x32_bf16 v[100:103], v[76:79], a[116:119], v[100:103]
    v_cvt_pk_bf16_f32 v53, v166, v167
    v_fmac_f32 v160, v4, v40
    v_mfma_f32_16x16x32_bf16 v[96:99], v[76:79], a[112:115], v[96:99]
    v_fmac_f32 v161, v4, v41
    s_add_u32 m0, s75, 0
    v_mfma_f32_16x16x32_bf16 v[96:99], v[72:75], a[96:99], v[96:99]
    buffer_load_dwordx4 v2, s[28:31], s8 offen sc1 lds
    v_mfma_f32_16x16x32_bf16 v[96:99], v[68:71], a[80:83], v[96:99]
    v_fmac_f32 v162, v4, v42
    v_fmac_f32 v163, v4, v43
    v_mfma_f32_16x16x32_bf16 v[96:99], v[64:67], a[64:67], v[96:99]
    v_fmac_f32 v176, v4, v8
    s_waitcnt lgkmcnt(0)
    v_mfma_f32_16x16x32_bf16 v[124:127], v[80:83], a[76:79], v[124:127]
    ds_read_b128 v[64:67], v25 offset:45056
    v_fmac_f32 v177, v4, v9
    v_mfma_f32_16x16x32_bf16 v[124:127], v[84:87], a[92:95], v[124:127]
    ds_read_b128 v[68:71], v25 offset:47104
    v_fmac_f32 v178, v4, v10
    v_mfma_f32_16x16x32_bf16 v[124:127], v[88:91], a[108:111], v[124:127]
    ds_read_b128 v[72:75], v25 offset:49152
    s_add_u32 m0, s75, 1024
    v_mfma_f32_16x16x32_bf16 v[124:127], v[92:95], a[124:127], v[124:127]
    buffer_load_dwordx4 v2, s[28:31], s9 offen sc1 lds
    v_mfma_f32_16x16x32_bf16 v[120:123], v[92:95], a[120:123], v[120:123]
    ds_read_b128 v[76:79], v25 offset:51200
    v_fmac_f32 v179, v4, v11
    v_mfma_f32_16x16x32_bf16 v[120:123], v[88:91], a[104:107], v[120:123]
    v_mul_f32 v160, v176, v160
    v_mul_f32 v161, v177, v161
    v_mfma_f32_16x16x32_bf16 v[120:123], v[84:87], a[88:91], v[120:123]
    v_mul_f32 v162, v178, v162
    v_mul_f32 v163, v179, v163
    v_mfma_f32_16x16x32_bf16 v[120:123], v[80:83], a[72:75], v[120:123]
    v_cvt_pk_bf16_f32 v48, v160, v161
    v_cvt_pk_bf16_f32 v49, v162, v163
    v_mfma_f32_16x16x32_bf16 v[116:119], v[80:83], a[68:71], v[116:119]
    ds_read_b128 v[40:43], v35 offset:192
    s_add_u32 m0, s75, 2048
    v_mfma_f32_16x16x32_bf16 v[116:119], v[84:87], a[84:87], v[116:119]
    buffer_load_dwordx4 v2, s[28:31], s10 offen sc1 lds
    v_mfma_f32_16x16x32_bf16 v[116:119], v[88:91], a[100:103], v[116:119]
    ds_read_b128 v[8:11], v35 offset:448
    v_mfma_f32_16x16x32_bf16 v[116:119], v[92:95], a[116:119], v[116:119]
    v_mfma_f32_16x16x32_bf16 v[112:115], v[92:95], a[112:115], v[112:115]
    v_mfma_f32_16x16x32_bf16 v[112:115], v[88:91], a[96:99], v[112:115]
    v_mfma_f32_16x16x32_bf16 v[112:115], v[84:87], a[80:83], v[112:115]
    s_waitcnt lgkmcnt(0)
    v_fmac_f32 v204, v7, v40
    v_mfma_f32_16x16x32_bf16 v[112:115], v[80:83], a[64:67], v[112:115]
    s_add_u32 m0, s58, 53248
    v_mfma_f32_16x16x32_bf16 v[108:111], v[64:67], a[140:143], v[108:111]
    buffer_load_dwordx4 v3, s[20:23], s72 offen lds
    v_mfma_f32_16x16x32_bf16 v[108:111], v[68:71], a[156:159], v[108:111]
    ds_read_b128 v[80:83], v25 offset:46080
    v_fmac_f32 v205, v7, v41
    v_mfma_f32_16x16x32_bf16 v[108:111], v[72:75], a[172:175], v[108:111]
    ds_read_b128 v[84:87], v25 offset:48128
    v_fmac_f32 v206, v7, v42
    v_mfma_f32_16x16x32_bf16 v[108:111], v[76:79], a[188:191], v[108:111]
    ds_read_b128 v[88:91], v25 offset:50176
    v_fmac_f32 v207, v7, v43
    v_mfma_f32_16x16x32_bf16 v[104:107], v[76:79], a[184:187], v[104:107]
    ds_read_b128 v[92:95], v25 offset:52224
    v_fmac_f32 v220, v7, v8
    v_mfma_f32_16x16x32_bf16 v[104:107], v[72:75], a[168:171], v[104:107]
    v_fmac_f32 v221, v7, v9
    s_add_u32 m0, s58, 57344
    v_mfma_f32_16x16x32_bf16 v[104:107], v[68:71], a[152:155], v[104:107]
    buffer_load_dwordx4 v3, s[40:43], s72 offen lds
    v_mfma_f32_16x16x32_bf16 v[104:107], v[64:67], a[136:139], v[104:107]
    s_add_u32 s72, s72, 294912
    v_fmac_f32 v222, v7, v10
    v_mfma_f32_16x16x32_bf16 v[100:103], v[64:67], a[132:135], v[100:103]
    v_fmac_f32 v223, v7, v11
    v_mul_f32 v204, v220, v204
    v_mfma_f32_16x16x32_bf16 v[100:103], v[68:71], a[148:151], v[100:103]
    v_mul_f32 v205, v221, v205
    v_mul_f32 v206, v222, v206
    v_mfma_f32_16x16x32_bf16 v[100:103], v[72:75], a[164:167], v[100:103]
    v_mul_f32 v207, v223, v207
    v_cvt_pk_bf16_f32 v62, v204, v205
    v_mfma_f32_16x16x32_bf16 v[100:103], v[76:79], a[180:183], v[100:103]
    v_cvt_pk_bf16_f32 v63, v206, v207
    s_add_u32 m0, s58, 61440
    v_mfma_f32_16x16x32_bf16 v[96:99], v[76:79], a[176:179], v[96:99]
    buffer_load_dwordx4 v3, s[20:23], s72 offen lds
    v_mfma_f32_16x16x32_bf16 v[96:99], v[72:75], a[160:163], v[96:99]
    v_fmac_f32 v200, v6, v40
    v_fmac_f32 v201, v6, v41
    v_mfma_f32_16x16x32_bf16 v[96:99], v[68:71], a[144:147], v[96:99]
    v_fmac_f32 v202, v6, v42
    v_fmac_f32 v203, v6, v43
    v_mfma_f32_16x16x32_bf16 v[96:99], v[64:67], a[128:131], v[96:99]
    v_fmac_f32 v216, v6, v8
    s_waitcnt lgkmcnt(0)
    v_mfma_f32_16x16x32_bf16 v[124:127], v[80:83], a[140:143], v[124:127]
    ds_read_b128 v[64:67], v25 offset:53248
    v_fmac_f32 v217, v6, v9
    v_mfma_f32_16x16x32_bf16 v[124:127], v[84:87], a[156:159], v[124:127]
    ds_read_b128 v[68:71], v25 offset:55296
    v_fmac_f32 v218, v6, v10
    v_mfma_f32_16x16x32_bf16 v[124:127], v[88:91], a[172:175], v[124:127]
    buffer_store_dwordx4 v[60:63], v24, s[28:31], s74 offen sc1
    v_mfma_f32_16x16x32_bf16 v[124:127], v[92:95], a[188:191], v[124:127]
    s_add_u32 s74, s74, s16
    ds_read_b128 v[72:75], v26 offset:0
    v_mfma_f32_16x16x32_bf16 v[120:123], v[92:95], a[184:187], v[120:123]
    ds_read_b128 v[76:79], v26 offset:2048
    v_fmac_f32 v219, v6, v11
    v_mfma_f32_16x16x32_bf16 v[120:123], v[88:91], a[168:171], v[120:123]
    v_mul_f32 v200, v216, v200
    v_mul_f32 v201, v217, v201
    v_mfma_f32_16x16x32_bf16 v[120:123], v[84:87], a[152:155], v[120:123]
    v_mul_f32 v202, v218, v202
    v_mul_f32 v203, v219, v203
    v_mfma_f32_16x16x32_bf16 v[120:123], v[80:83], a[136:139], v[120:123]
    v_cvt_pk_bf16_f32 v58, v200, v201
    s_add_u32 m0, s58, 65536
    v_mfma_f32_16x16x32_bf16 v[116:119], v[80:83], a[132:135], v[116:119]
    buffer_load_dwordx4 v3, s[40:43], s72 offen lds
    v_mfma_f32_16x16x32_bf16 v[116:119], v[84:87], a[148:151], v[116:119]
    s_add_u32 s72, s72, 294912
    v_cvt_pk_bf16_f32 v59, v202, v203
    v_mfma_f32_16x16x32_bf16 v[116:119], v[88:91], a[164:167], v[116:119]
    v_fmac_f32 v196, v5, v40
    v_fmac_f32 v197, v5, v41
    v_mfma_f32_16x16x32_bf16 v[116:119], v[92:95], a[180:183], v[116:119]
    v_fmac_f32 v198, v5, v42
    v_fmac_f32 v199, v5, v43
    v_mfma_f32_16x16x32_bf16 v[112:115], v[92:95], a[176:179], v[112:115]
    v_fmac_f32 v212, v5, v8
    v_fmac_f32 v213, v5, v9
    v_mfma_f32_16x16x32_bf16 v[112:115], v[88:91], a[160:163], v[112:115]
    v_fmac_f32 v214, v5, v10
    v_fmac_f32 v215, v5, v11
    v_mfma_f32_16x16x32_bf16 v[112:115], v[84:87], a[144:147], v[112:115]
    buffer_store_dwordx4 v[56:59], v24, s[28:31], s73 offen sc1
    v_mfma_f32_16x16x32_bf16 v[112:115], v[80:83], a[128:131], v[112:115]
    s_add_u32 s73, s73, s16
    s_waitcnt lgkmcnt(0)
    v_mfma_f32_16x16x32_bf16 v[108:111], v[64:67], a[204:207], v[108:111]
    ds_read_b128 v[80:83], v25 offset:54272
    v_mul_f32 v196, v212, v196
    v_mfma_f32_16x16x32_bf16 v[108:111], v[68:71], a[220:223], v[108:111]
    ds_read_b128 v[84:87], v25 offset:56320
    v_mul_f32 v197, v213, v197
    v_mfma_f32_16x16x32_bf16 v[108:111], v[72:75], a[236:239], v[108:111]
    ds_read_b128 v[88:91], v26 offset:1024
    v_mul_f32 v198, v214, v198
    v_mfma_f32_16x16x32_bf16 v[108:111], v[76:79], a[252:255], v[108:111]
    ds_read_b128 v[92:95], v26 offset:3072
    v_mul_f32 v199, v215, v199
    v_mfma_f32_16x16x32_bf16 v[104:107], v[76:79], a[248:251], v[104:107]
    v_cvt_pk_bf16_f32 v54, v196, v197
    s_add_u32 m0, s58, 69632
    v_mfma_f32_16x16x32_bf16 v[104:107], v[72:75], a[232:235], v[104:107]
    buffer_load_dwordx4 v3, s[20:23], s72 offen lds
    v_mfma_f32_16x16x32_bf16 v[104:107], v[68:71], a[216:219], v[104:107]
    v_cvt_pk_bf16_f32 v55, v198, v199
    v_fmac_f32 v192, v4, v40
    v_mfma_f32_16x16x32_bf16 v[104:107], v[64:67], a[200:203], v[104:107]
    v_fmac_f32 v193, v4, v41
    v_fmac_f32 v194, v4, v42
    v_mfma_f32_16x16x32_bf16 v[100:103], v[64:67], a[196:199], v[100:103]
    v_fmac_f32 v195, v4, v43
    v_fmac_f32 v208, v4, v8
    v_mfma_f32_16x16x32_bf16 v[100:103], v[68:71], a[212:215], v[100:103]
    v_fmac_f32 v209, v4, v9
    v_fmac_f32 v210, v4, v10
    v_mfma_f32_16x16x32_bf16 v[100:103], v[72:75], a[228:231], v[100:103]
    v_fmac_f32 v211, v4, v11
    v_mul_f32 v192, v208, v192
    v_mfma_f32_16x16x32_bf16 v[100:103], v[76:79], a[244:247], v[100:103]
    buffer_store_dwordx4 v[52:55], v24, s[28:31], s71 offen sc1
    v_mfma_f32_16x16x32_bf16 v[96:99], v[76:79], a[240:243], v[96:99]
    s_add_u32 s71, s71, s16
    v_mul_f32 v193, v209, v193
    v_mfma_f32_16x16x32_bf16 v[96:99], v[72:75], a[224:227], v[96:99]
    v_mul_f32 v194, v210, v194
    v_mul_f32 v195, v211, v195
    v_mfma_f32_16x16x32_bf16 v[96:99], v[68:71], a[208:211], v[96:99]
    v_cvt_pk_bf16_f32 v50, v192, v193
    v_cvt_pk_bf16_f32 v51, v194, v195
    v_mfma_f32_16x16x32_bf16 v[96:99], v[64:67], a[192:195], v[96:99]
    s_waitcnt lgkmcnt(0)
    v_mfma_f32_16x16x32_bf16 v[124:127], v[80:83], a[204:207], v[124:127]
    ds_read_b128 v[64:67], v26 offset:4096
    v_mfma_f32_16x16x32_bf16 v[124:127], v[84:87], a[220:223], v[124:127]
    ds_read_b128 v[68:71], v26 offset:6144
    v_mfma_f32_16x16x32_bf16 v[124:127], v[88:91], a[236:239], v[124:127]
    ds_read_b128 v[72:75], v26 offset:5120
    v_mfma_f32_16x16x32_bf16 v[124:127], v[92:95], a[252:255], v[124:127]
    ds_read_b128 v[76:79], v26 offset:7168
    v_mfma_f32_16x16x32_bf16 v[120:123], v[92:95], a[248:251], v[120:123]
    v_mfma_f32_16x16x32_bf16 v[120:123], v[88:91], a[232:235], v[120:123]
    buffer_store_dwordx4 v[48:51], v24, s[28:31], s70 offen sc1
    v_mfma_f32_16x16x32_bf16 v[120:123], v[84:87], a[216:219], v[120:123]
    s_add_u32 s70, s70, s16
    v_mfma_f32_16x16x32_bf16 v[120:123], v[80:83], a[200:203], v[120:123]
    v_mfma_f32_16x16x32_bf16 v[116:119], v[80:83], a[196:199], v[116:119]
    v_mfma_f32_16x16x32_bf16 v[116:119], v[84:87], a[212:215], v[116:119]
    v_mfma_f32_16x16x32_bf16 v[116:119], v[88:91], a[228:231], v[116:119]
    v_mfma_f32_16x16x32_bf16 v[116:119], v[92:95], a[244:247], v[116:119]
    v_mfma_f32_16x16x32_bf16 v[112:115], v[92:95], a[240:243], v[112:115]
    v_mfma_f32_16x16x32_bf16 v[112:115], v[88:91], a[224:227], v[112:115]
    v_mfma_f32_16x16x32_bf16 v[112:115], v[84:87], a[208:211], v[112:115]
    v_mfma_f32_16x16x32_bf16 v[112:115], v[80:83], a[192:195], v[112:115]
    s_waitcnt lgkmcnt(0)
    v_mfma_f32_16x16x32_bf16 v[108:111], v[64:67], v[236:239], v[108:111]
    s_waitcnt vmcnt(27)
    s_barrier
    v_mfma_f32_16x16x32_bf16 v[108:111], v[68:71], v[252:255], v[108:111]
    ds_read_b64_tr_b16 v[80:81], v16 offset:16384
    s_add_u32 m0, s58, 73728
    v_mfma_f32_16x16x32_bf16 v[104:107], v[68:71], v[248:251], v[104:107]
    buffer_load_dwordx4 v3, s[40:43], s72 offen lds
    v_mfma_f32_16x16x32_bf16 v[104:107], v[64:67], v[232:235], v[104:107]
    s_add_u32 s72, s72, 294912
    ds_read_b64_tr_b16 v[82:83], v16 offset:18432
    v_mfma_f32_16x16x32_bf16 v[100:103], v[64:67], v[228:231], v[100:103]
    ds_read_b64_tr_b16 v[84:85], v16 offset:24576
    ds_read_b64_tr_b16 v[86:87], v16 offset:26624
    v_mfma_f32_16x16x32_bf16 v[100:103], v[68:71], v[244:247], v[100:103]
    ds_read_b64_tr_b16 v[88:89], v16 offset:32768
    ds_read_b64_tr_b16 v[90:91], v16 offset:34816
    v_mfma_f32_16x16x32_bf16 v[96:99], v[68:71], v[240:243], v[96:99]
    ds_read_b64_tr_b16 v[92:93], v16 offset:40960
    ds_read_b64_tr_b16 v[94:95], v16 offset:43008
    v_mfma_f32_16x16x32_bf16 v[96:99], v[64:67], v[224:227], v[96:99]
    s_add_u32 m0, s58, 77824
    v_mfma_f32_16x16x32_bf16 v[112:115], v[72:75], v[224:227], v[112:115]
    buffer_load_dwordx4 v3, s[20:23], s72 offen lds
    v_mfma_f32_16x16x32_bf16 v[112:115], v[76:79], v[240:243], v[112:115]
    v_mfma_f32_16x16x32_bf16 v[116:119], v[76:79], v[244:247], v[116:119]
    v_mfma_f32_16x16x32_bf16 v[116:119], v[72:75], v[228:231], v[116:119]
    v_mfma_f32_16x16x32_bf16 v[120:123], v[72:75], v[232:235], v[120:123]
    v_mfma_f32_16x16x32_bf16 v[120:123], v[76:79], v[248:251], v[120:123]
    s_add_u32 m0, s58, 81920
    v_mfma_f32_16x16x32_bf16 v[124:127], v[76:79], v[252:255], v[124:127]
    buffer_load_dwordx4 v3, s[40:43], s72 offen lds
    v_mfma_f32_16x16x32_bf16 v[124:127], v[72:75], v[236:239], v[124:127]
    s_add_u32 s72, s72, 294912
    s_waitcnt lgkmcnt(0)
    v_mfma_f32_16x16x32_bf16 v[172:175], v[80:83], a[12:15], 0
    ds_read_b64_tr_b16 v[64:65], v16 offset:20480
    v_mul_f32 v96, v112, v96
    v_mfma_f32_16x16x32_bf16 v[172:175], v[84:87], a[28:31], v[172:175]
    ds_read_b64_tr_b16 v[66:67], v16 offset:22528
    s_add_u32 m0, s58, 86016
    v_mfma_f32_16x16x32_bf16 v[172:175], v[88:91], a[44:47], v[172:175]
    buffer_load_dwordx4 v3, s[20:23], s72 offen lds
    v_mfma_f32_16x16x32_bf16 v[172:175], v[92:95], a[60:63], v[172:175]
    ds_read_b64_tr_b16 v[68:69], v16 offset:28672
    v_mul_f32 v97, v113, v97
    v_mfma_f32_16x16x32_bf16 v[168:171], v[92:95], a[56:59], 0
ffn_c_h3:
    s_cbranch_execz ffn_c_h3_1
    ds_read_b64_tr_b16 v[70:71], v16 offset:30720
    v_mul_f32 v98, v114, v98
    v_mfma_f32_16x16x32_bf16 v[168:171], v[88:91], a[40:43], v[168:171]
    ds_read_b64_tr_b16 v[72:73], v16 offset:36864
    s_add_u32 m0, s58, 90112
    v_mfma_f32_16x16x32_bf16 v[168:171], v[84:87], a[24:27], v[168:171]
    buffer_load_dwordx4 v3, s[40:43], s72 offen lds
    v_mfma_f32_16x16x32_bf16 v[168:171], v[80:83], a[8:11], v[168:171]
    s_add_u32 s72, s72, 294912
    ds_read_b64_tr_b16 v[74:75], v16 offset:38912
    v_mfma_f32_16x16x32_bf16 v[164:167], v[80:83], a[4:7], 0
    ds_read_b64_tr_b16 v[76:77], v16 offset:45056
    v_mul_f32 v99, v115, v99
    v_mfma_f32_16x16x32_bf16 v[164:167], v[84:87], a[20:23], v[164:167]
    ds_read_b64_tr_b16 v[78:79], v16 offset:47104
    v_cvt_pk_bf16_f32 v48, v96, v97
    v_mfma_f32_16x16x32_bf16 v[164:167], v[88:91], a[36:39], v[164:167]
    v_cvt_pk_bf16_f32 v49, v98, v99
    s_add_u32 m0, s58, 94208
    v_mfma_f32_16x16x32_bf16 v[164:167], v[92:95], a[52:55], v[164:167]
    buffer_load_dwordx4 v3, s[20:23], s72 offen lds
    v_mfma_f32_16x16x32_bf16 v[160:163], v[92:95], a[48:51], 0
    v_mul_f32 v100, v116, v100
    v_mul_f32 v101, v117, v101
    v_mfma_f32_16x16x32_bf16 v[160:163], v[88:91], a[32:35], v[160:163]
    v_mul_f32 v102, v118, v102
    v_mul_f32 v103, v119, v103
    v_mfma_f32_16x16x32_bf16 v[160:163], v[84:87], a[16:19], v[160:163]
    v_cvt_pk_bf16_f32 v52, v100, v101
    v_cvt_pk_bf16_f32 v53, v102, v103
    v_mfma_f32_16x16x32_bf16 v[160:163], v[80:83], a[0:3], v[160:163]
    v_mul_f32 v104, v120, v104
    s_waitcnt lgkmcnt(0)
    v_mfma_f32_16x16x32_bf16 v[188:191], v[64:67], a[12:15], 0
    buffer_store_dwordx2 v[48:49], v27, s[28:31], s70 offen sc1
    v_mfma_f32_16x16x32_bf16 v[188:191], v[68:71], a[28:31], v[188:191]
    s_add_u32 s70, s70, s18
    ds_read_b64_tr_b16 v[80:81], v17 offset:16384
    v_mfma_f32_16x16x32_bf16 v[188:191], v[72:75], a[44:47], v[188:191]
    ds_read_b64_tr_b16 v[82:83], v17 offset:18432
    v_mul_f32 v105, v121, v105
    v_mfma_f32_16x16x32_bf16 v[188:191], v[76:79], a[60:63], v[188:191]
    ds_read_b64_tr_b16 v[84:85], v17 offset:24576
    v_mul_f32 v106, v122, v106
    v_mfma_f32_16x16x32_bf16 v[184:187], v[76:79], a[56:59], 0
ffn_c_h3_1:
    s_cbranch_execz ffn_c_h3_2
    buffer_store_dwordx2 v[52:53], v27, s[28:31], s71 offen sc1
    v_mfma_f32_16x16x32_bf16 v[184:187], v[72:75], a[40:43], v[184:187]
    s_add_u32 s71, s71, s18
    ds_read_b64_tr_b16 v[86:87], v17 offset:26624
    v_mfma_f32_16x16x32_bf16 v[184:187], v[68:71], a[24:27], v[184:187]
    ds_read_b64_tr_b16 v[88:89], v17 offset:32768
    v_mul_f32 v107, v123, v107
    v_mfma_f32_16x16x32_bf16 v[184:187], v[64:67], a[8:11], v[184:187]
    ds_read_b64_tr_b16 v[90:91], v17 offset:34816
    s_add_u32 m0, s58, 98304
    v_mfma_f32_16x16x32_bf16 v[180:183], v[64:67], a[4:7], 0
    buffer_load_dwordx4 v3, s[40:43], s72 offen lds
    v_mfma_f32_16x16x32_bf16 v[180:183], v[68:71], a[20:23], v[180:183]
    s_add_u32 s72, s72, 294912
    ds_read_b64_tr_b16 v[92:93], v17 offset:40960
    v_mfma_f32_16x16x32_bf16 v[180:183], v[72:75], a[36:39], v[180:183]
    ds_read_b64_tr_b16 v[94:95], v17 offset:43008
    v_cvt_pk_bf16_f32 v56, v104, v105
    v_mfma_f32_16x16x32_bf16 v[180:183], v[76:79], a[52:55], v[180:183]
    v_cvt_pk_bf16_f32 v57, v106, v107
    v_mul_f32 v108, v124, v108
    v_mfma_f32_16x16x32_bf16 v[176:179], v[76:79], a[48:51], 0
    v_mul_f32 v109, v125, v109
    v_mul_f32 v110, v126, v110
    v_mfma_f32_16x16x32_bf16 v[176:179], v[72:75], a[32:35], v[176:179]
    buffer_store_dwordx2 v[56:57], v27, s[28:31], s73 offen sc1
    v_mfma_f32_16x16x32_bf16 v[176:179], v[68:71], a[16:19], v[176:179]
    s_add_u32 s73, s73, s18
    v_mul_f32 v111, v127, v111
    v_mfma_f32_16x16x32_bf16 v[176:179], v[64:67], a[0:3], v[176:179]
    v_cvt_pk_bf16_f32 v60, v108, v109
    s_waitcnt lgkmcnt(0)
    v_mfma_f32_16x16x32_bf16 v[204:207], v[80:83], a[12:15], 0
    ds_read_b64_tr_b16 v[64:65], v17 offset:20480
    s_add_u32 m0, s58, 102400
    v_mfma_f32_16x16x32_bf16 v[204:207], v[84:87], a[28:31], v[204:207]
    buffer_load_dwordx4 v3, s[20:23], s72 offen lds
    v_mfma_f32_16x16x32_bf16 v[204:207], v[88:91], a[44:47], v[204:207]
    ds_read_b64_tr_b16 v[66:67], v17 offset:22528
    v_cvt_pk_bf16_f32 v61, v110, v111
    v_mfma_f32_16x16x32_bf16 v[204:207], v[92:95], a[60:63], v[204:207]
    ds_read_b64_tr_b16 v[68:69], v17 offset:28672
    v_cndmask_b32 v44, v44, v45, s[64:65]
ffn_c_h3_2:
    s_cbranch_execz ffn_c_h7
    v_mfma_f32_16x16x32_bf16 v[200:203], v[92:95], a[56:59], 0
    ds_read_b64_tr_b16 v[70:71], v17 offset:30720
    v_cndmask_b32 v44, v44, v46, s[66:67]
    v_mfma_f32_16x16x32_bf16 v[200:203], v[88:91], a[40:43], v[200:203]
    ds_read_b64_tr_b16 v[72:73], v17 offset:36864
    v_mul_f32 v45, 0x3ae38e39, v4
    v_mfma_f32_16x16x32_bf16 v[200:203], v[84:87], a[24:27], v[200:203]
    buffer_store_dwordx2 v[60:61], v27, s[28:31], s74 offen sc1
    v_mfma_f32_16x16x32_bf16 v[200:203], v[80:83], a[8:11], v[200:203]
    s_add_u32 s74, s74, s18
    ds_read_b64_tr_b16 v[74:75], v17 offset:38912
    v_mfma_f32_16x16x32_bf16 v[196:199], v[80:83], a[4:7], 0
    ds_read_b64_tr_b16 v[76:77], v17 offset:45056
    v_cndmask_b32 v44, v44, v47, s[68:69]
    v_mfma_f32_16x16x32_bf16 v[196:199], v[84:87], a[20:23], v[196:199]
    ds_read_b64_tr_b16 v[78:79], v17 offset:47104
    s_add_u32 m0, s58, 106496
    v_mfma_f32_16x16x32_bf16 v[196:199], v[88:91], a[36:39], v[196:199]
    buffer_load_dwordx4 v3, s[40:43], s72 offen lds
    v_mfma_f32_16x16x32_bf16 v[196:199], v[92:95], a[52:55], v[196:199]
    s_add_u32 s72, s72, 294912
    v_mul_f32 v44, 0x3ae38e39, v44
    v_mfma_f32_16x16x32_bf16 v[192:195], v[92:95], a[48:51], 0
    v_fma_f32 v44, -v45, v45, v44
    v_max_f32 v44, 0, v44
    v_mfma_f32_16x16x32_bf16 v[192:195], v[88:91], a[32:35], v[192:195]
    v_cvt_pk_bf16_f32 v44, v44, v44
    s_add_u32 m0, s58, 110592
    v_mfma_f32_16x16x32_bf16 v[192:195], v[84:87], a[16:19], v[192:195]
    buffer_load_dwordx4 v3, s[20:23], s72 offen lds
    v_mfma_f32_16x16x32_bf16 v[192:195], v[80:83], a[0:3], v[192:195]
    v_lshlrev_b32 v44, 16, v44
    s_waitcnt lgkmcnt(0)
    v_mfma_f32_16x16x32_bf16 v[220:223], v[64:67], a[12:15], 0
    ds_read_b64_tr_b16 v[80:81], v18 offset:16384
    v_add_f32 v44, 0x3727c5ac, v44
    v_mfma_f32_16x16x32_bf16 v[220:223], v[68:71], a[28:31], v[220:223]
    ds_read_b64_tr_b16 v[82:83], v18 offset:18432
    v_cvt_pk_bf16_f32 v44, v44, v44
    v_mfma_f32_16x16x32_bf16 v[220:223], v[72:75], a[44:47], v[220:223]
    ds_read_b64_tr_b16 v[84:85], v18 offset:24576
    s_add_u32 m0, s58, 114688
    v_mfma_f32_16x16x32_bf16 v[220:223], v[76:79], a[60:63], v[220:223]
    buffer_load_dwordx4 v3, s[40:43], s72 offen lds
    v_mfma_f32_16x16x32_bf16 v[216:219], v[76:79], a[56:59], 0
    s_add_u32 s72, s72, 294912
    ds_read_b64_tr_b16 v[86:87], v18 offset:26624
    v_mfma_f32_16x16x32_bf16 v[216:219], v[72:75], a[40:43], v[216:219]
    ds_read_b64_tr_b16 v[88:89], v18 offset:32768
    v_lshlrev_b32 v44, 16, v44
    v_mfma_f32_16x16x32_bf16 v[216:219], v[68:71], a[24:27], v[216:219]
    ds_read_b64_tr_b16 v[90:91], v18 offset:34816
    s_add_u32 m0, s58, 118784
    v_mfma_f32_16x16x32_bf16 v[216:219], v[64:67], a[8:11], v[216:219]
    buffer_load_dwordx4 v3, s[20:23], s72 offen lds
    v_mfma_f32_16x16x32_bf16 v[212:215], v[64:67], a[4:7], 0
    ds_read_b64_tr_b16 v[92:93], v18 offset:40960
    v_sqrt_f32 v44, v44
    v_mfma_f32_16x16x32_bf16 v[212:215], v[68:71], a[20:23], v[212:215]
    ds_read_b64_tr_b16 v[94:95], v18 offset:43008
    s_nop 0
    v_mfma_f32_16x16x32_bf16 v[212:215], v[72:75], a[36:39], v[212:215]
    v_cvt_pk_bf16_f32 v44, v44, v44
    v_lshlrev_b32 v44, 16, v44
    v_mfma_f32_16x16x32_bf16 v[212:215], v[76:79], a[52:55], v[212:215]
    v_rcp_f32 v44, v44
    s_add_u32 m0, s58, 12288
    v_mfma_f32_16x16x32_bf16 v[208:211], v[76:79], a[48:51], 0
    buffer_load_dwordx4 v30, s[28:31], m0 offen sc1 lds
    v_mfma_f32_16x16x32_bf16 v[208:211], v[72:75], a[32:35], v[208:211]
    s_nop 0
    v_mul_f32 v44, v44, v44
    v_mfma_f32_16x16x32_bf16 v[208:211], v[68:71], a[16:19], v[208:211]
    ds_read_b128 v[40:43], v35 offset:512
    v_mfma_f32_16x16x32_bf16 v[208:211], v[64:67], a[0:3], v[208:211]
    s_waitcnt lgkmcnt(1)
    v_mfma_f32_16x16x32_bf16 v[108:111], v[80:83], a[12:15], 0
    s_waitcnt vmcnt(17)
    ds_read_b64_tr_b16 v[64:65], v18 offset:20480
    v_mfma_f32_16x16x32_bf16 v[108:111], v[84:87], a[28:31], v[108:111]
    ds_read_b64_tr_b16 v[66:67], v18 offset:22528
    v_mfma_f32_16x16x32_bf16 v[108:111], v[88:91], a[44:47], v[108:111]
    buffer_store_dword v44, v36, s[28:31], s19 offen sc1
    v_mfma_f32_16x16x32_bf16 v[108:111], v[92:95], a[60:63], v[108:111]
    ds_read_b64_tr_b16 v[68:69], v18 offset:28672
    s_waitcnt lgkmcnt(3)
    v_mfma_f32_16x16x32_bf16 v[104:107], v[92:95], a[56:59], 0
    ds_read_b64_tr_b16 v[70:71], v18 offset:30720
    v_fmac_f32 v160, v4, v40
    v_mfma_f32_16x16x32_bf16 v[104:107], v[88:91], a[40:43], v[104:107]
    ds_read_b64_tr_b16 v[72:73], v18 offset:36864
    v_mov_b32 v28, s96
    v_mfma_f32_16x16x32_bf16 v[104:107], v[84:87], a[24:27], v[104:107]
    buffer_store_dword v28, v33, s[28:31], s49 offen sc1
    v_mfma_f32_16x16x32_bf16 v[104:107], v[80:83], a[8:11], v[104:107]
    s_add_u32 s49, s49, 0x4000
    ds_read_b64_tr_b16 v[74:75], v18 offset:38912
    v_mfma_f32_16x16x32_bf16 v[100:103], v[80:83], a[4:7], 0
    ds_read_b64_tr_b16 v[76:77], v18 offset:45056
    v_fmac_f32 v161, v4, v41
    v_mfma_f32_16x16x32_bf16 v[100:103], v[84:87], a[20:23], v[100:103]
    ds_read_b64_tr_b16 v[78:79], v18 offset:47104
    s_add_u32 m0, s58, 16384
    v_mfma_f32_16x16x32_bf16 v[100:103], v[88:91], a[36:39], v[100:103]
    buffer_load_dwordx4 v30, s[28:31], m0 offen sc1 lds
    v_mfma_f32_16x16x32_bf16 v[100:103], v[92:95], a[52:55], v[100:103]
    v_fmac_f32 v162, v4, v42
    v_fmac_f32 v163, v4, v43
    v_mfma_f32_16x16x32_bf16 v[96:99], v[92:95], a[48:51], 0
    v_fmac_f32 v164, v5, v40
    v_fmac_f32 v165, v5, v41
    v_mfma_f32_16x16x32_bf16 v[96:99], v[88:91], a[32:35], v[96:99]
    v_fmac_f32 v166, v5, v42
    v_fmac_f32 v167, v5, v43
    v_mfma_f32_16x16x32_bf16 v[96:99], v[84:87], a[16:19], v[96:99]
    v_fmac_f32 v168, v6, v40
    v_fmac_f32 v169, v6, v41
    v_mfma_f32_16x16x32_bf16 v[96:99], v[80:83], a[0:3], v[96:99]
    s_add_u32 m0, s58, 20480
    s_waitcnt lgkmcnt(0)
    v_mfma_f32_16x16x32_bf16 v[124:127], v[64:67], a[12:15], 0
    buffer_load_dwordx4 v30, s[28:31], m0 offen sc1 lds
    v_mfma_f32_16x16x32_bf16 v[124:127], v[68:71], a[28:31], v[124:127]
    ds_read_b64_tr_b16 v[80:81], v19 offset:16384
    v_fmac_f32 v170, v6, v42
    v_mfma_f32_16x16x32_bf16 v[124:127], v[72:75], a[44:47], v[124:127]
    ds_read_b64_tr_b16 v[82:83], v19 offset:18432
    v_fmac_f32 v171, v6, v43
    v_mfma_f32_16x16x32_bf16 v[124:127], v[76:79], a[60:63], v[124:127]
    ds_read_b64_tr_b16 v[84:85], v19 offset:24576
    s_add_u32 m0, s58, 24576
    v_mfma_f32_16x16x32_bf16 v[120:123], v[76:79], a[56:59], 0
    buffer_load_dwordx4 v30, s[28:31], m0 offen sc1 lds
    v_mfma_f32_16x16x32_bf16 v[120:123], v[72:75], a[40:43], v[120:123]
    ds_read_b64_tr_b16 v[86:87], v19 offset:26624
    v_fmac_f32 v172, v7, v40
    v_mfma_f32_16x16x32_bf16 v[120:123], v[68:71], a[24:27], v[120:123]
    ds_read_b64_tr_b16 v[88:89], v19 offset:32768
    v_fmac_f32 v173, v7, v41
    v_mfma_f32_16x16x32_bf16 v[120:123], v[64:67], a[8:11], v[120:123]
    ds_read_b64_tr_b16 v[90:91], v19 offset:34816
    s_add_u32 m0, s58, 28672
    v_mfma_f32_16x16x32_bf16 v[116:119], v[64:67], a[4:7], 0
    buffer_load_dwordx4 v30, s[28:31], m0 offen sc1 lds
    v_mfma_f32_16x16x32_bf16 v[116:119], v[68:71], a[20:23], v[116:119]
    ds_read_b64_tr_b16 v[92:93], v19 offset:40960
    v_fmac_f32 v174, v7, v42
    v_mfma_f32_16x16x32_bf16 v[116:119], v[72:75], a[36:39], v[116:119]
    ds_read_b64_tr_b16 v[94:95], v19 offset:43008
    v_fmac_f32 v175, v7, v43
    v_mfma_f32_16x16x32_bf16 v[116:119], v[76:79], a[52:55], v[116:119]
    ds_read_b128 v[8:11], v35 offset:768
    v_mfma_f32_16x16x32_bf16 v[112:115], v[76:79], a[48:51], 0
    s_add_u32 m0, s58, 32768
    v_mfma_f32_16x16x32_bf16 v[112:115], v[72:75], a[32:35], v[112:115]
    buffer_load_dwordx4 v30, s[28:31], m0 offen sc1 lds
    v_mfma_f32_16x16x32_bf16 v[112:115], v[68:71], a[16:19], v[112:115]
    v_mfma_f32_16x16x32_bf16 v[112:115], v[64:67], a[0:3], v[112:115]
    s_waitcnt lgkmcnt(0)
    v_mfma_f32_16x16x32_bf16 v[140:143], v[80:83], a[12:15], 0
    ds_read_b64_tr_b16 v[64:65], v19 offset:20480
    s_add_u32 m0, s58, 36864
    v_mfma_f32_16x16x32_bf16 v[140:143], v[84:87], a[28:31], v[140:143]
    buffer_load_dwordx4 v30, s[28:31], m0 offen sc1 lds
    v_mfma_f32_16x16x32_bf16 v[140:143], v[88:91], a[44:47], v[140:143]
    ds_read_b64_tr_b16 v[66:67], v19 offset:22528
    v_fmac_f32 v176, v4, v8
    v_mfma_f32_16x16x32_bf16 v[140:143], v[92:95], a[60:63], v[140:143]
    ds_read_b64_tr_b16 v[68:69], v19 offset:28672
    v_fmac_f32 v177, v4, v9
    v_mfma_f32_16x16x32_bf16 v[136:139], v[92:95], a[56:59], 0
    ds_read_b64_tr_b16 v[70:71], v19 offset:30720
    v_fmac_f32 v178, v4, v10
    v_mfma_f32_16x16x32_bf16 v[136:139], v[88:91], a[40:43], v[136:139]
    ds_read_b64_tr_b16 v[72:73], v19 offset:36864
    s_add_u32 m0, s58, 40960
    v_mfma_f32_16x16x32_bf16 v[136:139], v[84:87], a[24:27], v[136:139]
    buffer_load_dwordx4 v30, s[28:31], m0 offen sc1 lds
    v_mfma_f32_16x16x32_bf16 v[136:139], v[80:83], a[8:11], v[136:139]
    ds_read_b64_tr_b16 v[74:75], v19 offset:38912
    v_fmac_f32 v179, v4, v11
    v_mfma_f32_16x16x32_bf16 v[132:135], v[80:83], a[4:7], 0
    ds_read_b64_tr_b16 v[76:77], v19 offset:45056
    v_fmac_f32 v180, v5, v8
    v_mfma_f32_16x16x32_bf16 v[132:135], v[84:87], a[20:23], v[132:135]
    ds_read_b64_tr_b16 v[78:79], v19 offset:47104
    s_add_u32 m0, s58, 45056
    v_mfma_f32_16x16x32_bf16 v[132:135], v[88:91], a[36:39], v[132:135]
    buffer_load_dwordx4 v30, s[28:31], m0 offen sc1 lds
    v_mfma_f32_16x16x32_bf16 v[132:135], v[92:95], a[52:55], v[132:135]
    v_fmac_f32 v181, v5, v9
    v_fmac_f32 v182, v5, v10
    v_mfma_f32_16x16x32_bf16 v[128:131], v[92:95], a[48:51], 0
    v_fmac_f32 v183, v5, v11
    v_fmac_f32 v184, v6, v8
    v_mfma_f32_16x16x32_bf16 v[128:131], v[88:91], a[32:35], v[128:131]
    v_fmac_f32 v185, v6, v9
    v_fmac_f32 v186, v6, v10
    v_mfma_f32_16x16x32_bf16 v[128:131], v[84:87], a[16:19], v[128:131]
    v_fmac_f32 v187, v6, v11
    v_fmac_f32 v188, v7, v8
    v_mfma_f32_16x16x32_bf16 v[128:131], v[80:83], a[0:3], v[128:131]
    v_fmac_f32 v189, v7, v9
    s_waitcnt lgkmcnt(0)
    v_mfma_f32_16x16x32_bf16 v[156:159], v[64:67], a[12:15], 0
    s_waitcnt vmcnt(26)
    s_barrier
    v_mfma_f32_16x16x32_bf16 v[156:159], v[68:71], a[28:31], v[156:159]
    ds_read_b64_tr_b16 v[80:81], v16 offset:49152
    s_add_u32 m0, s58, 122880
    v_mfma_f32_16x16x32_bf16 v[156:159], v[72:75], a[44:47], v[156:159]
    buffer_load_dwordx4 v3, s[40:43], s72 offen lds
    v_mfma_f32_16x16x32_bf16 v[156:159], v[76:79], a[60:63], v[156:159]
    s_add_u32 s72, s72, 294912
    ds_read_b64_tr_b16 v[82:83], v16 offset:51200
    v_mfma_f32_16x16x32_bf16 v[152:155], v[76:79], a[56:59], 0
    ds_read_b64_tr_b16 v[84:85], v12 offset:4096
    ds_read_b64_tr_b16 v[86:87], v12 offset:6144
    v_mfma_f32_16x16x32_bf16 v[152:155], v[72:75], a[40:43], v[152:155]
    ds_read_b64_tr_b16 v[88:89], v12 offset:12288
    s_add_u32 m0, s58, 126976
    v_mfma_f32_16x16x32_bf16 v[152:155], v[68:71], a[24:27], v[152:155]
    buffer_load_dwordx4 v3, s[20:23], s72 offen lds
    v_mfma_f32_16x16x32_bf16 v[152:155], v[64:67], a[8:11], v[152:155]
    ds_read_b64_tr_b16 v[90:91], v12 offset:14336
    ds_read_b64_tr_b16 v[92:93], v12 offset:20480
    v_mfma_f32_16x16x32_bf16 v[148:151], v[64:67], a[4:7], 0
    ds_read_b64_tr_b16 v[94:95], v12 offset:22528
    v_fmac_f32 v190, v7, v10
    v_mfma_f32_16x16x32_bf16 v[148:151], v[68:71], a[20:23], v[148:151]
    v_fmac_f32 v191, v7, v11
    s_add_u32 m0, s58, 131072
    v_mfma_f32_16x16x32_bf16 v[148:151], v[72:75], a[36:39], v[148:151]
    buffer_load_dwordx4 v3, s[40:43], s72 offen lds
    v_mfma_f32_16x16x32_bf16 v[148:151], v[76:79], a[52:55], v[148:151]
    s_add_u32 s72, s72, 294912
    ds_read_b128 v[40:43], v35 offset:576
    v_mfma_f32_16x16x32_bf16 v[144:147], v[76:79], a[48:51], 0
    v_mfma_f32_16x16x32_bf16 v[144:147], v[72:75], a[32:35], v[144:147]
    v_mfma_f32_16x16x32_bf16 v[144:147], v[68:71], a[16:19], v[144:147]
    v_mfma_f32_16x16x32_bf16 v[144:147], v[64:67], a[0:3], v[144:147]
    s_add_u32 m0, s58, 135168
    s_waitcnt lgkmcnt(1)
    v_mfma_f32_16x16x32_bf16 v[172:175], v[80:83], a[76:79], v[172:175]
    buffer_load_dwordx4 v3, s[20:23], s72 offen lds
    v_mfma_f32_16x16x32_bf16 v[172:175], v[84:87], a[92:95], v[172:175]
    ds_read_b64_tr_b16 v[64:65], v12 offset:0
    s_waitcnt lgkmcnt(1)
    v_mfma_f32_16x16x32_bf16 v[172:175], v[88:91], a[108:111], v[172:175]
    ds_read_b64_tr_b16 v[66:67], v12 offset:2048
    v_fmac_f32 v192, v4, v40
    v_mfma_f32_16x16x32_bf16 v[172:175], v[92:95], a[124:127], v[172:175]
    ds_read_b64_tr_b16 v[68:69], v12 offset:8192
    s_add_u32 m0, s58, 139264
    v_mfma_f32_16x16x32_bf16 v[168:171], v[92:95], a[120:123], v[168:171]
    buffer_load_dwordx4 v3, s[40:43], s72 offen lds
    v_mfma_f32_16x16x32_bf16 v[168:171], v[88:91], a[104:107], v[168:171]
    s_add_u32 s72, s72, 294912
    ds_read_b64_tr_b16 v[70:71], v12 offset:10240
    v_mfma_f32_16x16x32_bf16 v[168:171], v[84:87], a[88:91], v[168:171]
    ds_read_b64_tr_b16 v[72:73], v12 offset:16384
    v_fmac_f32 v193, v4, v41
    v_mfma_f32_16x16x32_bf16 v[168:171], v[80:83], a[72:75], v[168:171]
    ds_read_b64_tr_b16 v[74:75], v12 offset:18432
    s_add_u32 m0, s58, 143360
    v_mfma_f32_16x16x32_bf16 v[164:167], v[80:83], a[68:71], v[164:167]
    buffer_load_dwordx4 v3, s[20:23], s72 offen lds
    v_mfma_f32_16x16x32_bf16 v[164:167], v[84:87], a[84:87], v[164:167]
    ds_read_b64_tr_b16 v[76:77], v12 offset:24576
    v_fmac_f32 v194, v4, v42
    v_mfma_f32_16x16x32_bf16 v[164:167], v[88:91], a[100:103], v[164:167]
    ds_read_b64_tr_b16 v[78:79], v12 offset:26624
    v_fmac_f32 v195, v4, v43
    v_mfma_f32_16x16x32_bf16 v[164:167], v[92:95], a[116:119], v[164:167]
    v_fmac_f32 v196, v5, v40
    v_fmac_f32 v197, v5, v41
    v_mfma_f32_16x16x32_bf16 v[160:163], v[92:95], a[112:115], v[160:163]
    v_fmac_f32 v198, v5, v42
    s_add_u32 m0, s58, 147456
    v_mfma_f32_16x16x32_bf16 v[160:163], v[88:91], a[96:99], v[160:163]
    buffer_load_dwordx4 v3, s[40:43], s72 offen lds
    v_mfma_f32_16x16x32_bf16 v[160:163], v[84:87], a[80:83], v[160:163]
    s_add_u32 s72, s72, 294912
    v_fmac_f32 v199, v5, v43
    v_mfma_f32_16x16x32_bf16 v[160:163], v[80:83], a[64:67], v[160:163]
    v_fmac_f32 v200, v6, v40
    s_waitcnt lgkmcnt(0)
    v_mfma_f32_16x16x32_bf16 v[188:191], v[64:67], a[76:79], v[188:191]
    ds_read_b64_tr_b16 v[80:81], v17 offset:49152
    s_add_u32 s12, s12, 0x4000
    v_mfma_f32_16x16x32_bf16 v[188:191], v[68:71], a[92:95], v[188:191]
    buffer_load_dword v29, v32, s[28:31], s12 offen sc1
    v_mfma_f32_16x16x32_bf16 v[188:191], v[72:75], a[108:111], v[188:191]
    ds_read_b64_tr_b16 v[82:83], v17 offset:51200
    v_fmac_f32 v201, v6, v41
    v_mfma_f32_16x16x32_bf16 v[188:191], v[76:79], a[124:127], v[188:191]
    ds_read_b64_tr_b16 v[84:85], v13 offset:4096
    v_fmac_f32 v202, v6, v42
    v_mfma_f32_16x16x32_bf16 v[184:187], v[76:79], a[120:123], v[184:187]
    ds_read_b64_tr_b16 v[86:87], v13 offset:6144
    v_fmac_f32 v203, v6, v43
    v_mfma_f32_16x16x32_bf16 v[184:187], v[72:75], a[104:107], v[184:187]
    ds_read_b64_tr_b16 v[88:89], v13 offset:12288
    s_add_u32 m0, s58, 151552
    v_mfma_f32_16x16x32_bf16 v[184:187], v[68:71], a[88:91], v[184:187]
    buffer_load_dwordx4 v3, s[20:23], s72 offen lds
    v_mfma_f32_16x16x32_bf16 v[184:187], v[64:67], a[72:75], v[184:187]
    ds_read_b64_tr_b16 v[90:91], v13 offset:14336
    v_fmac_f32 v204, v7, v40
    v_mfma_f32_16x16x32_bf16 v[180:183], v[64:67], a[68:71], v[180:183]
    ds_read_b64_tr_b16 v[92:93], v13 offset:20480
    v_fmac_f32 v205, v7, v41
    v_mfma_f32_16x16x32_bf16 v[180:183], v[68:71], a[84:87], v[180:183]
    ds_read_b64_tr_b16 v[94:95], v13 offset:22528
    v_fmac_f32 v206, v7, v42
    v_mfma_f32_16x16x32_bf16 v[180:183], v[72:75], a[100:103], v[180:183]
    v_fmac_f32 v207, v7, v43
    ds_read_b128 v[8:11], v35 offset:832
    v_mfma_f32_16x16x32_bf16 v[180:183], v[76:79], a[116:119], v[180:183]
    v_mfma_f32_16x16x32_bf16 v[176:179], v[76:79], a[112:115], v[176:179]
    v_mfma_f32_16x16x32_bf16 v[176:179], v[72:75], a[96:99], v[176:179]
    v_mfma_f32_16x16x32_bf16 v[176:179], v[68:71], a[80:83], v[176:179]
    v_mfma_f32_16x16x32_bf16 v[176:179], v[64:67], a[64:67], v[176:179]
    s_waitcnt lgkmcnt(0)
    v_mfma_f32_16x16x32_bf16 v[204:207], v[80:83], a[76:79], v[204:207]
    ds_read_b64_tr_b16 v[64:65], v13 offset:0
    v_fmac_f32 v208, v4, v8
    v_mfma_f32_16x16x32_bf16 v[204:207], v[84:87], a[92:95], v[204:207]
    ds_read_b64_tr_b16 v[66:67], v13 offset:2048
    v_fmac_f32 v209, v4, v9
    v_mfma_f32_16x16x32_bf16 v[204:207], v[88:91], a[108:111], v[204:207]
    ds_read_b64_tr_b16 v[68:69], v13 offset:8192
    v_fmac_f32 v210, v4, v10
    v_mfma_f32_16x16x32_bf16 v[204:207], v[92:95], a[124:127], v[204:207]
    ds_read_b64_tr_b16 v[70:71], v13 offset:10240
    v_fmac_f32 v211, v4, v11
    v_mfma_f32_16x16x32_bf16 v[200:203], v[92:95], a[120:123], v[200:203]
    ds_read_b64_tr_b16 v[72:73], v13 offset:16384
    v_fmac_f32 v212, v5, v8
    v_mfma_f32_16x16x32_bf16 v[200:203], v[88:91], a[104:107], v[200:203]
    ds_read_b64_tr_b16 v[74:75], v13 offset:18432
    v_fmac_f32 v213, v5, v9
    v_mfma_f32_16x16x32_bf16 v[200:203], v[84:87], a[88:91], v[200:203]
    ds_read_b64_tr_b16 v[76:77], v13 offset:24576
    v_fmac_f32 v214, v5, v10
    v_mfma_f32_16x16x32_bf16 v[200:203], v[80:83], a[72:75], v[200:203]
    ds_read_b64_tr_b16 v[78:79], v13 offset:26624
    v_fmac_f32 v215, v5, v11
    v_mfma_f32_16x16x32_bf16 v[196:199], v[80:83], a[68:71], v[196:199]
    s_waitcnt vmcnt(18)
    v_mfma_f32_16x16x32_bf16 v[196:199], v[84:87], a[84:87], v[196:199]
    v_fmac_f32 v216, v6, v8
    v_fmac_f32 v217, v6, v9
    v_mfma_f32_16x16x32_bf16 v[196:199], v[88:91], a[100:103], v[196:199]
    buffer_store_dword v28, v33, s[28:31], s49 offen sc1
    v_mfma_f32_16x16x32_bf16 v[196:199], v[92:95], a[116:119], v[196:199]
    s_add_u32 s49, s49, 0x4000
    v_fmac_f32 v218, v6, v10
    v_mfma_f32_16x16x32_bf16 v[192:195], v[92:95], a[112:115], v[192:195]
    v_fmac_f32 v219, v6, v11
    v_fmac_f32 v220, v7, v8
    v_mfma_f32_16x16x32_bf16 v[192:195], v[88:91], a[96:99], v[192:195]
    v_fmac_f32 v221, v7, v9
    v_fmac_f32 v222, v7, v10
    v_mfma_f32_16x16x32_bf16 v[192:195], v[84:87], a[80:83], v[192:195]
    v_mfma_f32_16x16x32_bf16 v[192:195], v[80:83], a[64:67], v[192:195]
    s_waitcnt lgkmcnt(0)
    v_mfma_f32_16x16x32_bf16 v[220:223], v[64:67], a[76:79], v[220:223]
    ds_read_b64_tr_b16 v[80:81], v18 offset:49152
    v_mfma_f32_16x16x32_bf16 v[220:223], v[68:71], a[92:95], v[220:223]
    ds_read_b64_tr_b16 v[82:83], v18 offset:51200
    v_mfma_f32_16x16x32_bf16 v[220:223], v[72:75], a[108:111], v[220:223]
    ds_read_b64_tr_b16 v[84:85], v14 offset:4096
    v_mfma_f32_16x16x32_bf16 v[220:223], v[76:79], a[124:127], v[220:223]
    ds_read_b64_tr_b16 v[86:87], v14 offset:6144
    v_mfma_f32_16x16x32_bf16 v[216:219], v[76:79], a[120:123], v[216:219]
    ds_read_b64_tr_b16 v[88:89], v14 offset:12288
    v_mfma_f32_16x16x32_bf16 v[216:219], v[72:75], a[104:107], v[216:219]
    ds_read_b64_tr_b16 v[90:91], v14 offset:14336
    v_mfma_f32_16x16x32_bf16 v[216:219], v[68:71], a[88:91], v[216:219]
    ds_read_b64_tr_b16 v[92:93], v14 offset:20480
    v_mfma_f32_16x16x32_bf16 v[216:219], v[64:67], a[72:75], v[216:219]
    ds_read_b64_tr_b16 v[94:95], v14 offset:22528
    v_mfma_f32_16x16x32_bf16 v[212:215], v[64:67], a[68:71], v[212:215]
    v_mfma_f32_16x16x32_bf16 v[212:215], v[68:71], a[84:87], v[212:215]
    v_mfma_f32_16x16x32_bf16 v[212:215], v[72:75], a[100:103], v[212:215]
    v_mfma_f32_16x16x32_bf16 v[212:215], v[76:79], a[116:119], v[212:215]
    v_mfma_f32_16x16x32_bf16 v[208:211], v[76:79], a[112:115], v[208:211]
    v_mfma_f32_16x16x32_bf16 v[208:211], v[72:75], a[96:99], v[208:211]
    v_mfma_f32_16x16x32_bf16 v[208:211], v[68:71], a[80:83], v[208:211]
    v_mfma_f32_16x16x32_bf16 v[208:211], v[64:67], a[64:67], v[208:211]
    s_waitcnt lgkmcnt(0)
    v_mfma_f32_16x16x32_bf16 v[108:111], v[80:83], a[76:79], v[108:111]
    ds_read_b64_tr_b16 v[64:65], v14 offset:0
    v_mfma_f32_16x16x32_bf16 v[108:111], v[84:87], a[92:95], v[108:111]
    ds_read_b64_tr_b16 v[66:67], v14 offset:2048
    v_mfma_f32_16x16x32_bf16 v[108:111], v[88:91], a[108:111], v[108:111]
    ds_read_b64_tr_b16 v[68:69], v14 offset:8192
    v_mfma_f32_16x16x32_bf16 v[108:111], v[92:95], a[124:127], v[108:111]
    ds_read_b64_tr_b16 v[70:71], v14 offset:10240
    v_mfma_f32_16x16x32_bf16 v[104:107], v[92:95], a[120:123], v[104:107]
    ds_read_b64_tr_b16 v[72:73], v14 offset:16384
    v_mfma_f32_16x16x32_bf16 v[104:107], v[88:91], a[104:107], v[104:107]
    ds_read_b64_tr_b16 v[74:75], v14 offset:18432
    v_fmac_f32 v223, v7, v11
    v_mfma_f32_16x16x32_bf16 v[104:107], v[84:87], a[88:91], v[104:107]
    ds_read_b64_tr_b16 v[76:77], v14 offset:24576
    ds_read_b128 v[40:43], v35 offset:640
    v_mfma_f32_16x16x32_bf16 v[104:107], v[80:83], a[72:75], v[104:107]
    ds_read_b64_tr_b16 v[78:79], v14 offset:26624
    v_mfma_f32_16x16x32_bf16 v[100:103], v[80:83], a[68:71], v[100:103]
    v_mfma_f32_16x16x32_bf16 v[100:103], v[84:87], a[84:87], v[100:103]
    s_waitcnt vmcnt(2)
    v_mfma_f32_16x16x32_bf16 v[100:103], v[88:91], a[100:103], v[100:103]
    v_cmp_ne_u32 vcc, s96, v29
    v_mfma_f32_16x16x32_bf16 v[100:103], v[92:95], a[116:119], v[100:103]
    s_cbranch_vccnz ffn_slow2
ffn_back2:
    v_mfma_f32_16x16x32_bf16 v[96:99], v[92:95], a[112:115], v[96:99]
    v_and_b32 v32, 7, v1
    v_mfma_f32_16x16x32_bf16 v[96:99], v[88:91], a[96:99], v[96:99]
    v_lshl_add_u32 v32, v32, 2, s14
    s_waitcnt lgkmcnt(1)
    v_mfma_f32_16x16x32_bf16 v[96:99], v[84:87], a[80:83], v[96:99]
    buffer_load_dwordx4 a[0:3], v24, s[28:31], s57 offen offset:0 sc1
    v_mfma_f32_16x16x32_bf16 v[96:99], v[80:83], a[64:67], v[96:99]
    s_waitcnt lgkmcnt(0)
    v_mfma_f32_16x16x32_bf16 v[124:127], v[64:67], a[76:79], v[124:127]
    ds_read_b64_tr_b16 v[80:81], v19 offset:49152
    v_mfma_f32_16x16x32_bf16 v[124:127], v[68:71], a[92:95], v[124:127]
    ds_read_b64_tr_b16 v[82:83], v19 offset:51200
    v_mfma_f32_16x16x32_bf16 v[124:127], v[72:75], a[108:111], v[124:127]
    buffer_load_dwordx4 a[4:7], v24, s[28:31], s57 offen offset:1024 sc1
    v_mfma_f32_16x16x32_bf16 v[124:127], v[76:79], a[124:127], v[124:127]
    ds_read_b64_tr_b16 v[84:85], v15 offset:4096
    v_mfma_f32_16x16x32_bf16 v[120:123], v[76:79], a[120:123], v[120:123]
    ds_read_b64_tr_b16 v[86:87], v15 offset:6144
    v_mfma_f32_16x16x32_bf16 v[120:123], v[72:75], a[104:107], v[120:123]
    ds_read_b64_tr_b16 v[88:89], v15 offset:12288
    v_fmac_f32 v96, v4, v40
    v_mfma_f32_16x16x32_bf16 v[120:123], v[68:71], a[88:91], v[120:123]
    buffer_load_dwordx4 a[8:11], v24, s[28:31], s57 offen offset:2048 sc1
    v_mfma_f32_16x16x32_bf16 v[120:123], v[64:67], a[72:75], v[120:123]
    ds_read_b64_tr_b16 v[90:91], v15 offset:14336
    v_fmac_f32 v97, v4, v41
    v_mfma_f32_16x16x32_bf16 v[116:119], v[64:67], a[68:71], v[116:119]
    ds_read_b64_tr_b16 v[92:93], v15 offset:20480
    v_fmac_f32 v98, v4, v42
    v_mfma_f32_16x16x32_bf16 v[116:119], v[68:71], a[84:87], v[116:119]
    ds_read_b64_tr_b16 v[94:95], v15 offset:22528
    v_fmac_f32 v99, v4, v43
    v_mfma_f32_16x16x32_bf16 v[116:119], v[72:75], a[100:103], v[116:119]
    v_fmac_f32 v100, v5, v40
    v_fmac_f32 v101, v5, v41
    v_mfma_f32_16x16x32_bf16 v[116:119], v[76:79], a[116:119], v[116:119]
    buffer_load_dwordx4 a[12:15], v24, s[28:31], s57 offen offset:3072 sc1
    v_mfma_f32_16x16x32_bf16 v[112:115], v[76:79], a[112:115], v[112:115]
    s_add_u32 s57, s57, 4096
    v_fmac_f32 v102, v5, v42
    v_mfma_f32_16x16x32_bf16 v[112:115], v[72:75], a[96:99], v[112:115]
    v_fmac_f32 v103, v5, v43
    v_fmac_f32 v104, v6, v40
    v_mfma_f32_16x16x32_bf16 v[112:115], v[68:71], a[80:83], v[112:115]
    v_fmac_f32 v105, v6, v41
    v_fmac_f32 v106, v6, v42
    v_mfma_f32_16x16x32_bf16 v[112:115], v[64:67], a[64:67], v[112:115]
    v_fmac_f32 v107, v6, v43
    s_waitcnt lgkmcnt(0)
    v_mfma_f32_16x16x32_bf16 v[140:143], v[80:83], a[76:79], v[140:143]
    buffer_load_dwordx4 a[16:19], v24, s[28:31], s57 offen offset:0 sc1
    v_mfma_f32_16x16x32_bf16 v[140:143], v[84:87], a[92:95], v[140:143]
    ds_read_b64_tr_b16 v[64:65], v15 offset:0
    v_fmac_f32 v108, v7, v40
    v_mfma_f32_16x16x32_bf16 v[140:143], v[88:91], a[108:111], v[140:143]
    ds_read_b64_tr_b16 v[66:67], v15 offset:2048
    v_fmac_f32 v109, v7, v41
    v_mfma_f32_16x16x32_bf16 v[140:143], v[92:95], a[124:127], v[140:143]
    ds_read_b64_tr_b16 v[68:69], v15 offset:8192
    v_fmac_f32 v110, v7, v42
    v_mfma_f32_16x16x32_bf16 v[136:139], v[92:95], a[120:123], v[136:139]
    buffer_load_dwordx4 a[20:23], v24, s[28:31], s57 offen offset:1024 sc1
    v_mfma_f32_16x16x32_bf16 v[136:139], v[88:91], a[104:107], v[136:139]
    ds_read_b64_tr_b16 v[70:71], v15 offset:10240
    v_fmac_f32 v111, v7, v43
    v_mfma_f32_16x16x32_bf16 v[136:139], v[84:87], a[88:91], v[136:139]
    ds_read_b64_tr_b16 v[72:73], v15 offset:16384
    ds_read_b128 v[8:11], v35 offset:896
    v_mfma_f32_16x16x32_bf16 v[136:139], v[80:83], a[72:75], v[136:139]
    ds_read_b64_tr_b16 v[74:75], v15 offset:18432
    v_mfma_f32_16x16x32_bf16 v[132:135], v[80:83], a[68:71], v[132:135]
ffn_c_h4:
    s_cbranch_execz ffn_c_h4_1
    buffer_load_dwordx4 a[24:27], v24, s[28:31], s57 offen offset:2048 sc1
    v_mfma_f32_16x16x32_bf16 v[132:135], v[84:87], a[84:87], v[132:135]
    ds_read_b64_tr_b16 v[76:77], v15 offset:24576
    v_mfma_f32_16x16x32_bf16 v[132:135], v[88:91], a[100:103], v[132:135]
    ds_read_b64_tr_b16 v[78:79], v15 offset:26624
    v_mfma_f32_16x16x32_bf16 v[132:135], v[92:95], a[116:119], v[132:135]
    s_waitcnt lgkmcnt(3)
    v_fmac_f32 v112, v4, v8
    v_mfma_f32_16x16x32_bf16 v[128:131], v[92:95], a[112:115], v[128:131]
    v_fmac_f32 v113, v4, v9
    v_fmac_f32 v114, v4, v10
    v_mfma_f32_16x16x32_bf16 v[128:131], v[88:91], a[96:99], v[128:131]
    buffer_load_dwordx4 a[28:31], v24, s[28:31], s57 offen offset:3072 sc1
    v_mfma_f32_16x16x32_bf16 v[128:131], v[84:87], a[80:83], v[128:131]
    s_add_u32 s57, s57, 4096
    v_fmac_f32 v115, v4, v11
    v_mfma_f32_16x16x32_bf16 v[128:131], v[80:83], a[64:67], v[128:131]
    v_fmac_f32 v116, v5, v8
    s_waitcnt lgkmcnt(0)
    v_mfma_f32_16x16x32_bf16 v[156:159], v[64:67], a[76:79], v[156:159]
    s_barrier
    s_add_u32 m0, s58, 155648
    v_mfma_f32_16x16x32_bf16 v[156:159], v[68:71], a[92:95], v[156:159]
    buffer_load_dwordx4 v3, s[40:43], s72 offen lds
    v_mfma_f32_16x16x32_bf16 v[156:159], v[72:75], a[108:111], v[156:159]
    ds_read_b64_tr_b16 v[80:81], v12 offset:28672
    ds_read_b64_tr_b16 v[82:83], v12 offset:30720
    v_mfma_f32_16x16x32_bf16 v[156:159], v[76:79], a[124:127], v[156:159]
    ds_read_b64_tr_b16 v[84:85], v12 offset:36864
    ds_read_b64_tr_b16 v[86:87], v12 offset:38912
    v_mfma_f32_16x16x32_bf16 v[152:155], v[76:79], a[120:123], v[152:155]
    ds_read_b64_tr_b16 v[88:89], v12 offset:45056
    ds_read_b64_tr_b16 v[90:91], v12 offset:47104
    v_mfma_f32_16x16x32_bf16 v[152:155], v[72:75], a[104:107], v[152:155]
    ds_read_b64_tr_b16 v[92:93], v12 offset:53248
    ds_read_b64_tr_b16 v[94:95], v12 offset:55296
    v_mfma_f32_16x16x32_bf16 v[152:155], v[68:71], a[88:91], v[152:155]
    buffer_load_dwordx4 a[32:35], v24, s[28:31], s57 offen offset:0 sc1
    v_mfma_f32_16x16x32_bf16 v[152:155], v[64:67], a[72:75], v[152:155]
    v_fmac_f32 v117, v5, v9
    v_fmac_f32 v118, v5, v10
    v_mfma_f32_16x16x32_bf16 v[148:151], v[64:67], a[68:71], v[148:151]
    v_fmac_f32 v119, v5, v11
    v_fmac_f32 v120, v6, v8
    v_mfma_f32_16x16x32_bf16 v[148:151], v[68:71], a[84:87], v[148:151]
ffn_c_h4_1:
    s_cbranch_execz ffn_c_h4_2
    v_fmac_f32 v121, v6, v9
    s_add_u32 m0, s58, 49152
    v_mfma_f32_16x16x32_bf16 v[148:151], v[72:75], a[100:103], v[148:151]
    buffer_load_dwordx4 v30, s[28:31], m0 offen sc1 lds
    v_mfma_f32_16x16x32_bf16 v[148:151], v[76:79], a[116:119], v[148:151]
    v_fmac_f32 v122, v6, v10
    v_fmac_f32 v123, v6, v11
    v_mfma_f32_16x16x32_bf16 v[144:147], v[76:79], a[112:115], v[144:147]
    v_fmac_f32 v124, v7, v8
    v_fmac_f32 v125, v7, v9
    v_mfma_f32_16x16x32_bf16 v[144:147], v[72:75], a[96:99], v[144:147]
    v_fmac_f32 v126, v7, v10
    v_fmac_f32 v127, v7, v11
    v_mfma_f32_16x16x32_bf16 v[144:147], v[68:71], a[80:83], v[144:147]
    buffer_load_dwordx4 a[36:39], v24, s[28:31], s57 offen offset:1024 sc1
    v_mfma_f32_16x16x32_bf16 v[144:147], v[64:67], a[64:67], v[144:147]
    ds_read_b128 v[40:43], v35 offset:704
    s_waitcnt lgkmcnt(1)
    v_mfma_f32_16x16x32_bf16 v[172:175], v[80:83], a[140:143], v[172:175]
    ds_read_b64_tr_b16 v[64:65], v12 offset:32768
    v_mfma_f32_16x16x32_bf16 v[172:175], v[84:87], a[156:159], v[172:175]
    ds_read_b64_tr_b16 v[66:67], v12 offset:34816
    v_mfma_f32_16x16x32_bf16 v[172:175], v[88:91], a[172:175], v[172:175]
    ds_read_b64_tr_b16 v[68:69], v12 offset:40960
    s_add_u32 s12, s12, 0x4000
    v_mfma_f32_16x16x32_bf16 v[172:175], v[92:95], a[188:191], v[172:175]
    buffer_load_dword v29, v32, s[28:31], s12 offen sc1
    v_mfma_f32_16x16x32_bf16 v[168:171], v[92:95], a[184:187], v[168:171]
    ds_read_b64_tr_b16 v[70:71], v12 offset:43008
    s_waitcnt lgkmcnt(4)
    v_mfma_f32_16x16x32_bf16 v[168:171], v[88:91], a[168:171], v[168:171]
    ds_read_b64_tr_b16 v[72:73], v12 offset:49152
    v_fmac_f32 v128, v4, v40
    v_mfma_f32_16x16x32_bf16 v[168:171], v[84:87], a[152:155], v[168:171]
    ds_read_b64_tr_b16 v[74:75], v12 offset:51200
    s_add_u32 m0, s58, 53248
    v_mfma_f32_16x16x32_bf16 v[168:171], v[80:83], a[136:139], v[168:171]
    buffer_load_dwordx4 v30, s[28:31], m0 offen sc1 lds
    v_mfma_f32_16x16x32_bf16 v[164:167], v[80:83], a[132:135], v[164:167]
    ds_read_b64_tr_b16 v[76:77], v16 offset:0
    v_fmac_f32 v129, v4, v41
    v_mfma_f32_16x16x32_bf16 v[164:167], v[84:87], a[148:151], v[164:167]
    ds_read_b64_tr_b16 v[78:79], v16 offset:2048
    v_fmac_f32 v130, v4, v42
    v_mfma_f32_16x16x32_bf16 v[164:167], v[88:91], a[164:167], v[164:167]
    v_fmac_f32 v131, v4, v43
ffn_c_h4_2:
    s_cbranch_execz ffn_c_ret
    v_fmac_f32 v132, v5, v40
    v_mfma_f32_16x16x32_bf16 v[164:167], v[92:95], a[180:183], v[164:167]
    v_fmac_f32 v133, v5, v41
    v_fmac_f32 v134, v5, v42
    v_mfma_f32_16x16x32_bf16 v[160:163], v[92:95], a[176:179], v[160:163]
    buffer_load_dwordx4 a[40:43], v24, s[28:31], s57 offen offset:2048 sc1
    v_mfma_f32_16x16x32_bf16 v[160:163], v[88:91], a[160:163], v[160:163]
    v_fmac_f32 v135, v5, v43
    v_fmac_f32 v136, v6, v40
    v_mfma_f32_16x16x32_bf16 v[160:163], v[84:87], a[144:147], v[160:163]
    v_fmac_f32 v137, v6, v41
    v_fmac_f32 v138, v6, v42
    v_mfma_f32_16x16x32_bf16 v[160:163], v[80:83], a[128:131], v[160:163]
    v_fmac_f32 v139, v6, v43
    s_waitcnt lgkmcnt(0)
    v_mfma_f32_16x16x32_bf16 v[188:191], v[64:67], a[140:143], v[188:191]
    buffer_load_dwordx4 a[44:47], v24, s[28:31], s57 offen offset:3072 sc1
    v_mfma_f32_16x16x32_bf16 v[188:191], v[68:71], a[156:159], v[188:191]
    s_add_u32 s57, s57, 4096
    ds_read_b64_tr_b16 v[80:81], v13 offset:28672
    v_mfma_f32_16x16x32_bf16 v[188:191], v[72:75], a[172:175], v[188:191]
    ds_read_b64_tr_b16 v[82:83], v13 offset:30720
    v_fmac_f32 v140, v7, v40
    v_mfma_f32_16x16x32_bf16 v[188:191], v[76:79], a[188:191], v[188:191]
    ds_read_b64_tr_b16 v[84:85], v13 offset:36864
    v_fmac_f32 v141, v7, v41
    v_mfma_f32_16x16x32_bf16 v[184:187], v[76:79], a[184:187], v[184:187]
    buffer_load_dwordx4 a[48:51], v24, s[28:31], s57 offen offset:0 sc1
    v_mfma_f32_16x16x32_bf16 v[184:187], v[72:75], a[168:171], v[184:187]
    ds_read_b64_tr_b16 v[86:87], v13 offset:38912
    v_fmac_f32 v142, v7, v42
    v_mfma_f32_16x16x32_bf16 v[184:187], v[68:71], a[152:155], v[184:187]
    ds_read_b64_tr_b16 v[88:89], v13 offset:45056
    v_fmac_f32 v143, v7, v43
    v_mfma_f32_16x16x32_bf16 v[184:187], v[64:67], a[136:139], v[184:187]
    ds_read_b64_tr_b16 v[90:91], v13 offset:47104
    ds_read_b128 v[8:11], v35 offset:960
    v_mfma_f32_16x16x32_bf16 v[180:183], v[64:67], a[132:135], v[180:183]
    ds_read_b64_tr_b16 v[92:93], v13 offset:53248
    v_mfma_f32_16x16x32_bf16 v[180:183], v[68:71], a[148:151], v[180:183]
    buffer_load_dwordx4 a[52:55], v24, s[28:31], s57 offen offset:1024 sc1
    v_mfma_f32_16x16x32_bf16 v[180:183], v[72:75], a[164:167], v[180:183]
    ds_read_b64_tr_b16 v[94:95], v13 offset:55296
    v_mfma_f32_16x16x32_bf16 v[180:183], v[76:79], a[180:183], v[180:183]
    v_mfma_f32_16x16x32_bf16 v[176:179], v[76:79], a[176:179], v[176:179]
    s_waitcnt lgkmcnt(2)
    s_add_u32 m0, s58, 57344
    v_mfma_f32_16x16x32_bf16 v[176:179], v[72:75], a[160:163], v[176:179]
    buffer_load_dwordx4 v30, s[28:31], m0 offen sc1 lds
    v_mfma_f32_16x16x32_bf16 v[176:179], v[68:71], a[144:147], v[176:179]
    v_fmac_f32 v144, v4, v8
    v_fmac_f32 v145, v4, v9
    v_mfma_f32_16x16x32_bf16 v[176:179], v[64:67], a[128:131], v[176:179]
    v_fmac_f32 v146, v4, v10
    s_waitcnt lgkmcnt(0)
    v_mfma_f32_16x16x32_bf16 v[204:207], v[80:83], a[140:143], v[204:207]
    ds_read_b64_tr_b16 v[64:65], v13 offset:32768
    v_fmac_f32 v147, v4, v11
    v_mfma_f32_16x16x32_bf16 v[204:207], v[84:87], a[156:159], v[204:207]
    ds_read_b64_tr_b16 v[66:67], v13 offset:34816
    s_add_u32 m0, s58, 61440
    v_mfma_f32_16x16x32_bf16 v[204:207], v[88:91], a[172:175], v[204:207]
    buffer_load_dwordx4 v30, s[28:31], m0 offen sc1 lds
    v_mfma_f32_16x16x32_bf16 v[204:207], v[92:95], a[188:191], v[204:207]
    ds_read_b64_tr_b16 v[68:69], v13 offset:40960
    v_fmac_f32 v148, v5, v8
    v_mfma_f32_16x16x32_bf16 v[200:203], v[92:95], a[184:187], v[200:203]
    ds_read_b64_tr_b16 v[70:71], v13 offset:43008
    v_fmac_f32 v149, v5, v9
    v_mfma_f32_16x16x32_bf16 v[200:203], v[88:91], a[168:171], v[200:203]
    ds_read_b64_tr_b16 v[72:73], v13 offset:49152
    s_add_u32 m0, s58, 65536
    v_mfma_f32_16x16x32_bf16 v[200:203], v[84:87], a[152:155], v[200:203]
    buffer_load_dwordx4 v30, s[28:31], m0 offen sc1 lds
    v_mfma_f32_16x16x32_bf16 v[200:203], v[80:83], a[136:139], v[200:203]
    ds_read_b64_tr_b16 v[74:75], v13 offset:51200
    v_fmac_f32 v150, v5, v10
    v_mfma_f32_16x16x32_bf16 v[196:199], v[80:83], a[132:135], v[196:199]
    ds_read_b64_tr_b16 v[76:77], v17 offset:0
    v_fmac_f32 v151, v5, v11
    v_mfma_f32_16x16x32_bf16 v[196:199], v[84:87], a[148:151], v[196:199]
    ds_read_b64_tr_b16 v[78:79], v17 offset:2048
    s_add_u32 m0, s58, 69632
    v_mfma_f32_16x16x32_bf16 v[196:199], v[88:91], a[164:167], v[196:199]
    buffer_load_dwordx4 v30, s[28:31], m0 offen sc1 lds
    v_mfma_f32_16x16x32_bf16 v[196:199], v[92:95], a[180:183], v[196:199]
    v_fmac_f32 v152, v6, v8
    v_fmac_f32 v153, v6, v9
    v_mfma_f32_16x16x32_bf16 v[192:195], v[92:95], a[176:179], v[192:195]
    v_fmac_f32 v154, v6, v10
    v_fmac_f32 v155, v6, v11
    v_mfma_f32_16x16x32_bf16 v[192:195], v[88:91], a[160:163], v[192:195]
    v_fmac_f32 v156, v7, v8
    v_fmac_f32 v157, v7, v9
    v_mfma_f32_16x16x32_bf16 v[192:195], v[84:87], a[144:147], v[192:195]
    v_fmac_f32 v158, v7, v10
    v_fmac_f32 v159, v7, v11
    v_mfma_f32_16x16x32_bf16 v[192:195], v[80:83], a[128:131], v[192:195]
    s_add_u32 m0, s58, 73728
    s_waitcnt lgkmcnt(0)
    v_mfma_f32_16x16x32_bf16 v[220:223], v[64:67], a[140:143], v[220:223]
    buffer_load_dwordx4 v30, s[28:31], m0 offen sc1 lds
    v_mfma_f32_16x16x32_bf16 v[220:223], v[68:71], a[156:159], v[220:223]
    ds_read_b64_tr_b16 v[80:81], v16 offset:4096
    v_mfma_f32_16x16x32_bf16 v[220:223], v[72:75], a[172:175], v[220:223]
    ds_read_b64_tr_b16 v[82:83], v16 offset:6144
    v_mfma_f32_16x16x32_bf16 v[220:223], v[76:79], a[188:191], v[220:223]
    ds_read_b64_tr_b16 v[84:85], v16 offset:12288
    v_mfma_f32_16x16x32_bf16 v[216:219], v[76:79], a[184:187], v[216:219]
    buffer_load_dwordx4 a[56:59], v24, s[28:31], s57 offen offset:2048 sc1
    v_mfma_f32_16x16x32_bf16 v[216:219], v[72:75], a[168:171], v[216:219]
    ds_read_b64_tr_b16 v[86:87], v16 offset:14336
    v_mfma_f32_16x16x32_bf16 v[216:219], v[68:71], a[152:155], v[216:219]
    ds_read_b64_tr_b16 v[88:89], v16 offset:20480
    v_mfma_f32_16x16x32_bf16 v[216:219], v[64:67], a[136:139], v[216:219]
    ds_read_b64_tr_b16 v[90:91], v16 offset:22528
    v_mfma_f32_16x16x32_bf16 v[212:215], v[64:67], a[132:135], v[212:215]
    buffer_load_dwordx4 a[60:63], v24, s[28:31], s57 offen offset:3072 sc1
    v_mfma_f32_16x16x32_bf16 v[212:215], v[68:71], a[148:151], v[212:215]
    s_add_u32 s57, s57, 4096
    ds_read_b64_tr_b16 v[92:93], v16 offset:28672
    v_mfma_f32_16x16x32_bf16 v[212:215], v[72:75], a[164:167], v[212:215]
    ds_read_b64_tr_b16 v[94:95], v16 offset:30720
    v_mfma_f32_16x16x32_bf16 v[212:215], v[76:79], a[180:183], v[212:215]
    s_waitcnt vmcnt(12)
    v_cmp_ne_u32 vcc, s96, v29
    v_mfma_f32_16x16x32_bf16 v[208:211], v[76:79], a[176:179], v[208:211]
    s_cbranch_vccnz ffn_slow3
ffn_back3:
    v_mfma_f32_16x16x32_bf16 v[208:211], v[72:75], a[160:163], v[208:211]
    buffer_load_dwordx4 a[64:67], v24, s[28:31], s57 offen offset:0 sc1
    v_mfma_f32_16x16x32_bf16 v[208:211], v[68:71], a[144:147], v[208:211]
    v_mfma_f32_16x16x32_bf16 v[208:211], v[64:67], a[128:131], v[208:211]
    s_waitcnt lgkmcnt(0)
    v_mfma_f32_16x16x32_bf16 v[172:175], v[80:83], a[204:207], v[172:175]
    s_barrier
    ds_read_b64_tr_b16 v[64:65], v16 offset:8192
    v_mfma_f32_16x16x32_bf16 v[172:175], v[84:87], a[220:223], v[172:175]
    buffer_load_dwordx4 a[68:71], v24, s[28:31], s57 offen offset:1024 sc1
    v_mfma_f32_16x16x32_bf16 v[172:175], v[88:91], a[236:239], v[172:175]
    ds_read_b64_tr_b16 v[66:67], v16 offset:10240
    ds_read_b64_tr_b16 v[68:69], v16 offset:16384
    v_mfma_f32_16x16x32_bf16 v[172:175], v[92:95], a[252:255], v[172:175]
    ds_read_b64_tr_b16 v[70:71], v16 offset:18432
    ds_read_b64_tr_b16 v[72:73], v16 offset:24576
    v_mfma_f32_16x16x32_bf16 v[168:171], v[92:95], a[248:251], v[168:171]
    ds_read_b64_tr_b16 v[74:75], v16 offset:26624
    ds_read_b64_tr_b16 v[76:77], v16 offset:32768
    v_mfma_f32_16x16x32_bf16 v[168:171], v[88:91], a[232:235], v[168:171]
    ds_read_b64_tr_b16 v[78:79], v16 offset:34816
    v_mfma_f32_16x16x32_bf16 v[168:171], v[84:87], a[216:219], v[168:171]
    buffer_load_dwordx4 a[72:75], v24, s[28:31], s57 offen offset:2048 sc1
    v_mfma_f32_16x16x32_bf16 v[168:171], v[80:83], a[200:203], v[168:171]
    v_mfma_f32_16x16x32_bf16 v[164:167], v[80:83], a[196:199], v[164:167]
    v_mfma_f32_16x16x32_bf16 v[164:167], v[84:87], a[212:215], v[164:167]
    v_mfma_f32_16x16x32_bf16 v[164:167], v[88:91], a[228:231], v[164:167]
    buffer_load_dwordx4 a[76:79], v24, s[28:31], s57 offen offset:3072 sc1
    v_mfma_f32_16x16x32_bf16 v[164:167], v[92:95], a[244:247], v[164:167]
    s_add_u32 s57, s57, 4096
    v_mfma_f32_16x16x32_bf16 v[160:163], v[92:95], a[240:243], v[160:163]
    v_mfma_f32_16x16x32_bf16 v[160:163], v[88:91], a[224:227], v[160:163]
    v_mfma_f32_16x16x32_bf16 v[160:163], v[84:87], a[208:211], v[160:163]
    buffer_load_dwordx4 a[80:83], v24, s[28:31], s57 offen offset:0 sc1
    v_mfma_f32_16x16x32_bf16 v[160:163], v[80:83], a[192:195], v[160:163]
    s_waitcnt lgkmcnt(0)
    v_mfma_f32_16x16x32_bf16 v[188:191], v[64:67], a[204:207], v[188:191]
    ds_read_b64_tr_b16 v[80:81], v17 offset:4096
    v_mfma_f32_16x16x32_bf16 v[188:191], v[68:71], a[220:223], v[188:191]
    ds_read_b64_tr_b16 v[82:83], v17 offset:6144
    v_mfma_f32_16x16x32_bf16 v[188:191], v[72:75], a[236:239], v[188:191]
    ds_read_b64_tr_b16 v[84:85], v17 offset:12288
    v_mfma_f32_16x16x32_bf16 v[188:191], v[76:79], a[252:255], v[188:191]
    buffer_load_dwordx4 a[84:87], v24, s[28:31], s57 offen offset:1024 sc1
    v_mfma_f32_16x16x32_bf16 v[184:187], v[76:79], a[248:251], v[184:187]
    ds_read_b64_tr_b16 v[86:87], v17 offset:14336
    v_mfma_f32_16x16x32_bf16 v[184:187], v[72:75], a[232:235], v[184:187]
    ds_read_b64_tr_b16 v[88:89], v17 offset:20480
    v_mfma_f32_16x16x32_bf16 v[184:187], v[68:71], a[216:219], v[184:187]
    ds_read_b64_tr_b16 v[90:91], v17 offset:22528
    v_mfma_f32_16x16x32_bf16 v[184:187], v[64:67], a[200:203], v[184:187]
    buffer_load_dwordx4 a[88:91], v24, s[28:31], s57 offen offset:2048 sc1
    v_mfma_f32_16x16x32_bf16 v[180:183], v[64:67], a[196:199], v[180:183]
    ds_read_b64_tr_b16 v[92:93], v17 offset:28672
    v_mfma_f32_16x16x32_bf16 v[180:183], v[68:71], a[212:215], v[180:183]
    ds_read_b64_tr_b16 v[94:95], v17 offset:30720
    v_mfma_f32_16x16x32_bf16 v[180:183], v[72:75], a[228:231], v[180:183]
    v_mfma_f32_16x16x32_bf16 v[180:183], v[76:79], a[244:247], v[180:183]
    v_mfma_f32_16x16x32_bf16 v[176:179], v[76:79], a[240:243], v[176:179]
    buffer_load_dwordx4 a[92:95], v24, s[28:31], s57 offen offset:3072 sc1
    v_mfma_f32_16x16x32_bf16 v[176:179], v[72:75], a[224:227], v[176:179]
    s_add_u32 s57, s57, 4096
    v_mfma_f32_16x16x32_bf16 v[176:179], v[68:71], a[208:211], v[176:179]
    v_mfma_f32_16x16x32_bf16 v[176:179], v[64:67], a[192:195], v[176:179]
    s_waitcnt lgkmcnt(0)
    v_mfma_f32_16x16x32_bf16 v[204:207], v[80:83], a[204:207], v[204:207]
    buffer_load_dwordx4 a[96:99], v24, s[28:31], s57 offen offset:0 sc1
    v_mfma_f32_16x16x32_bf16 v[204:207], v[84:87], a[220:223], v[204:207]
    ds_read_b64_tr_b16 v[64:65], v17 offset:8192
    v_mfma_f32_16x16x32_bf16 v[204:207], v[88:91], a[236:239], v[204:207]
    ds_read_b64_tr_b16 v[66:67], v17 offset:10240
    v_mfma_f32_16x16x32_bf16 v[204:207], v[92:95], a[252:255], v[204:207]
    ds_read_b64_tr_b16 v[68:69], v17 offset:16384
    v_mfma_f32_16x16x32_bf16 v[200:203], v[92:95], a[248:251], v[200:203]
    buffer_load_dwordx4 a[100:103], v24, s[28:31], s57 offen offset:1024 sc1
    v_mfma_f32_16x16x32_bf16 v[200:203], v[88:91], a[232:235], v[200:203]
    ds_read_b64_tr_b16 v[70:71], v17 offset:18432
    v_mfma_f32_16x16x32_bf16 v[200:203], v[84:87], a[216:219], v[200:203]
    ds_read_b64_tr_b16 v[72:73], v17 offset:24576
    v_mfma_f32_16x16x32_bf16 v[200:203], v[80:83], a[200:203], v[200:203]
    ds_read_b64_tr_b16 v[74:75], v17 offset:26624
    v_mfma_f32_16x16x32_bf16 v[196:199], v[80:83], a[196:199], v[196:199]
    ds_read_b64_tr_b16 v[76:77], v17 offset:32768
    v_mfma_f32_16x16x32_bf16 v[196:199], v[84:87], a[212:215], v[196:199]
    buffer_load_dwordx4 a[104:107], v24, s[28:31], s57 offen offset:2048 sc1
    v_mfma_f32_16x16x32_bf16 v[196:199], v[88:91], a[228:231], v[196:199]
    ds_read_b64_tr_b16 v[78:79], v17 offset:34816
    v_mfma_f32_16x16x32_bf16 v[196:199], v[92:95], a[244:247], v[196:199]
    v_mfma_f32_16x16x32_bf16 v[192:195], v[92:95], a[240:243], v[192:195]
    v_mfma_f32_16x16x32_bf16 v[192:195], v[88:91], a[224:227], v[192:195]
    buffer_load_dwordx4 a[108:111], v24, s[28:31], s57 offen offset:3072 sc1
    v_mfma_f32_16x16x32_bf16 v[192:195], v[84:87], a[208:211], v[192:195]
    s_add_u32 s57, s57, 4096
    v_mfma_f32_16x16x32_bf16 v[192:195], v[80:83], a[192:195], v[192:195]
    s_waitcnt lgkmcnt(0)
    v_mfma_f32_16x16x32_bf16 v[220:223], v[64:67], a[204:207], v[220:223]
    ds_read_b64_tr_b16 v[80:81], v16 offset:36864
    v_mfma_f32_16x16x32_bf16 v[220:223], v[68:71], a[220:223], v[220:223]
    ds_read_b64_tr_b16 v[82:83], v16 offset:38912
    v_mfma_f32_16x16x32_bf16 v[220:223], v[72:75], a[236:239], v[220:223]
    buffer_load_dword v38, v37, s[28:31], s19 offen offset:0 sc1
    v_mfma_f32_16x16x32_bf16 v[220:223], v[76:79], a[252:255], v[220:223]
    ds_read_b64_tr_b16 v[84:85], v16 offset:45056
    v_mfma_f32_16x16x32_bf16 v[216:219], v[76:79], a[248:251], v[216:219]
    ds_read_b64_tr_b16 v[86:87], v16 offset:47104
    v_mfma_f32_16x16x32_bf16 v[216:219], v[72:75], a[232:235], v[216:219]
    ds_read_b64_tr_b16 v[88:89], v16 offset:40960
    v_mfma_f32_16x16x32_bf16 v[216:219], v[68:71], a[216:219], v[216:219]
    buffer_load_dword v39, v37, s[28:31], s19 offen offset:64 sc1
    v_mfma_f32_16x16x32_bf16 v[216:219], v[64:67], a[200:203], v[216:219]
    ds_read_b64_tr_b16 v[90:91], v16 offset:43008
    v_mfma_f32_16x16x32_bf16 v[212:215], v[64:67], a[196:199], v[212:215]
    ds_read_b64_tr_b16 v[92:93], v16 offset:49152
    v_mfma_f32_16x16x32_bf16 v[212:215], v[68:71], a[212:215], v[212:215]
    ds_read_b64_tr_b16 v[94:95], v16 offset:51200
    v_mfma_f32_16x16x32_bf16 v[212:215], v[72:75], a[228:231], v[212:215]
    buffer_load_dwordx4 a[112:115], v24, s[28:31], s57 offen offset:0 sc1
    v_mfma_f32_16x16x32_bf16 v[212:215], v[76:79], a[244:247], v[212:215]
    v_mfma_f32_16x16x32_bf16 v[208:211], v[76:79], a[240:243], v[208:211]
    v_mfma_f32_16x16x32_bf16 v[208:211], v[72:75], a[224:227], v[208:211]
    v_mfma_f32_16x16x32_bf16 v[208:211], v[68:71], a[208:211], v[208:211]
    v_mfma_f32_16x16x32_bf16 v[208:211], v[64:67], a[192:195], v[208:211]
    s_waitcnt lgkmcnt(0)
    v_mfma_f32_16x16x32_bf16 v[172:175], v[80:83], v[236:239], v[172:175]
    buffer_load_dwordx4 a[116:119], v24, s[28:31], s57 offen offset:1024 sc1
    v_mfma_f32_16x16x32_bf16 v[172:175], v[84:87], v[252:255], v[172:175]
    ds_read_b64_tr_b16 v[64:65], v17 offset:36864
    v_mfma_f32_16x16x32_bf16 v[168:171], v[84:87], v[248:251], v[168:171]
    ds_read_b64_tr_b16 v[66:67], v17 offset:38912
    v_mfma_f32_16x16x32_bf16 v[168:171], v[80:83], v[232:235], v[168:171]
    ds_read_b64_tr_b16 v[68:69], v17 offset:45056
    v_mfma_f32_16x16x32_bf16 v[164:167], v[80:83], v[228:231], v[164:167]
    buffer_load_dwordx4 a[120:123], v24, s[28:31], s57 offen offset:2048 sc1
    v_mfma_f32_16x16x32_bf16 v[164:167], v[84:87], v[244:247], v[164:167]
    ds_read_b64_tr_b16 v[70:71], v17 offset:47104
    v_mfma_f32_16x16x32_bf16 v[160:163], v[84:87], v[240:243], v[160:163]
    ds_read_b64_tr_b16 v[72:73], v17 offset:40960
    v_mfma_f32_16x16x32_bf16 v[160:163], v[80:83], v[224:227], v[160:163]
    ds_read_b64_tr_b16 v[74:75], v17 offset:43008
    v_mfma_f32_16x16x32_bf16 v[176:179], v[88:91], v[224:227], v[176:179]
    buffer_load_dwordx4 a[124:127], v24, s[28:31], s57 offen offset:3072 sc1
    v_mfma_f32_16x16x32_bf16 v[176:179], v[92:95], v[240:243], v[176:179]
    s_add_u32 s57, s57, 4096
    ds_read_b64_tr_b16 v[76:77], v17 offset:49152
    v_mfma_f32_16x16x32_bf16 v[180:183], v[92:95], v[244:247], v[180:183]
    ds_read_b64_tr_b16 v[78:79], v17 offset:51200
    v_mfma_f32_16x16x32_bf16 v[180:183], v[88:91], v[228:231], v[180:183]
    v_mfma_f32_16x16x32_bf16 v[184:187], v[88:91], v[232:235], v[184:187]
    v_mfma_f32_16x16x32_bf16 v[184:187], v[92:95], v[248:251], v[184:187]
    v_mfma_f32_16x16x32_bf16 v[188:191], v[92:95], v[252:255], v[188:191]
    v_mfma_f32_16x16x32_bf16 v[188:191], v[88:91], v[236:239], v[188:191]
    s_waitcnt lgkmcnt(0)
    v_mfma_f32_16x16x32_bf16 v[204:207], v[64:67], v[236:239], v[204:207]
    ds_read_b64_tr_b16 v[80:81], v14 offset:28672
    v_mul_f32 v160, v176, v160
    v_mfma_f32_16x16x32_bf16 v[204:207], v[68:71], v[252:255], v[204:207]
    ds_read_b64_tr_b16 v[82:83], v14 offset:30720
    v_mul_f32 v161, v177, v161
    v_mfma_f32_16x16x32_bf16 v[200:203], v[68:71], v[248:251], v[200:203]
    ds_read_b64_tr_b16 v[84:85], v14 offset:36864
    v_mul_f32 v162, v178, v162
    v_mfma_f32_16x16x32_bf16 v[200:203], v[64:67], v[232:235], v[200:203]
    ds_read_b64_tr_b16 v[86:87], v14 offset:38912
    v_mul_f32 v163, v179, v163
    v_mfma_f32_16x16x32_bf16 v[196:199], v[64:67], v[228:231], v[196:199]
    ds_read_b64_tr_b16 v[88:89], v14 offset:45056
    v_cvt_pk_bf16_f32 v48, v160, v161
    v_mfma_f32_16x16x32_bf16 v[196:199], v[68:71], v[244:247], v[196:199]
    ds_read_b64_tr_b16 v[90:91], v14 offset:47104
    v_cvt_pk_bf16_f32 v49, v162, v163
    v_mfma_f32_16x16x32_bf16 v[192:195], v[68:71], v[240:243], v[192:195]
    ds_read_b64_tr_b16 v[92:93], v14 offset:53248
    v_mul_f32 v164, v180, v164
    v_mfma_f32_16x16x32_bf16 v[192:195], v[64:67], v[224:227], v[192:195]
    ds_read_b64_tr_b16 v[94:95], v14 offset:55296
    v_mul_f32 v165, v181, v165
    v_mfma_f32_16x16x32_bf16 v[208:211], v[72:75], v[224:227], v[208:211]
    v_mul_f32 v166, v182, v166
    v_mul_f32 v167, v183, v167
    v_mfma_f32_16x16x32_bf16 v[208:211], v[76:79], v[240:243], v[208:211]
    v_cvt_pk_bf16_f32 v52, v164, v165
    v_cvt_pk_bf16_f32 v53, v166, v167
    v_mfma_f32_16x16x32_bf16 v[212:215], v[76:79], v[244:247], v[212:215]
    v_mul_f32 v168, v184, v168
    v_mul_f32 v169, v185, v169
    v_mfma_f32_16x16x32_bf16 v[212:215], v[72:75], v[228:231], v[212:215]
    v_mul_f32 v170, v186, v170
    v_mul_f32 v171, v187, v171
    v_mfma_f32_16x16x32_bf16 v[216:219], v[72:75], v[232:235], v[216:219]
    v_cvt_pk_bf16_f32 v56, v168, v169
    v_cvt_pk_bf16_f32 v57, v170, v171
    v_mfma_f32_16x16x32_bf16 v[216:219], v[76:79], v[248:251], v[216:219]
    v_mul_f32 v172, v188, v172
    v_mul_f32 v173, v189, v173
    v_mfma_f32_16x16x32_bf16 v[220:223], v[76:79], v[252:255], v[220:223]
    v_mul_f32 v174, v190, v174
    v_mul_f32 v175, v191, v175
    v_mfma_f32_16x16x32_bf16 v[220:223], v[72:75], v[236:239], v[220:223]
    v_cvt_pk_bf16_f32 v60, v172, v173
    s_waitcnt lgkmcnt(0)
    v_mfma_f32_16x16x32_bf16 v[108:111], v[80:83], a[140:143], v[108:111]
    ds_read_b64_tr_b16 v[64:65], v14 offset:32768
    v_cvt_pk_bf16_f32 v61, v174, v175
    v_mfma_f32_16x16x32_bf16 v[108:111], v[84:87], a[156:159], v[108:111]
    ds_read_b64_tr_b16 v[66:67], v14 offset:34816
    v_mul_f32 v192, v208, v192
    v_mfma_f32_16x16x32_bf16 v[108:111], v[88:91], a[172:175], v[108:111]
    ds_read_b64_tr_b16 v[68:69], v14 offset:40960
    v_mul_f32 v193, v209, v193
    v_mfma_f32_16x16x32_bf16 v[108:111], v[92:95], a[188:191], v[108:111]
    ds_read_b64_tr_b16 v[70:71], v14 offset:43008
    v_mul_f32 v194, v210, v194
    v_mfma_f32_16x16x32_bf16 v[104:107], v[92:95], a[184:187], v[104:107]
    ds_read_b64_tr_b16 v[72:73], v14 offset:49152
    v_mul_f32 v195, v211, v195
    v_mfma_f32_16x16x32_bf16 v[104:107], v[88:91], a[168:171], v[104:107]
    ds_read_b64_tr_b16 v[74:75], v14 offset:51200
    v_cvt_pk_bf16_f32 v50, v192, v193
    v_mfma_f32_16x16x32_bf16 v[104:107], v[84:87], a[152:155], v[104:107]
    ds_read_b64_tr_b16 v[76:77], v18 offset:0
    v_cvt_pk_bf16_f32 v51, v194, v195
    v_mfma_f32_16x16x32_bf16 v[104:107], v[80:83], a[136:139], v[104:107]
    ds_read_b64_tr_b16 v[78:79], v18 offset:2048
    v_mul_f32 v196, v212, v196
    v_mfma_f32_16x16x32_bf16 v[100:103], v[80:83], a[132:135], v[100:103]
    v_mul_f32 v197, v213, v197
    v_mul_f32 v198, v214, v198
    v_mfma_f32_16x16x32_bf16 v[100:103], v[84:87], a[148:151], v[100:103]
    buffer_store_dwordx4 v[48:51], v24, s[28:31], s70 offen sc1
    v_mfma_f32_16x16x32_bf16 v[100:103], v[88:91], a[164:167], v[100:103]
    s_add_u32 s70, s70, 16384
    v_mul_f32 v199, v215, v199
    v_mfma_f32_16x16x32_bf16 v[100:103], v[92:95], a[180:183], v[100:103]
    v_cvt_pk_bf16_f32 v54, v196, v197
    v_cvt_pk_bf16_f32 v55, v198, v199
    v_mfma_f32_16x16x32_bf16 v[96:99], v[92:95], a[176:179], v[96:99]
    v_mul_f32 v200, v216, v200
    v_mul_f32 v201, v217, v201
    v_mfma_f32_16x16x32_bf16 v[96:99], v[88:91], a[160:163], v[96:99]
    v_mul_f32 v202, v218, v202
    v_mul_f32 v203, v219, v203
    v_mfma_f32_16x16x32_bf16 v[96:99], v[84:87], a[144:147], v[96:99]
    buffer_store_dwordx4 v[52:55], v24, s[28:31], s71 offen sc1
    v_mfma_f32_16x16x32_bf16 v[96:99], v[80:83], a[128:131], v[96:99]
    s_add_u32 s71, s71, 16384
    s_waitcnt lgkmcnt(0)
    v_mfma_f32_16x16x32_bf16 v[124:127], v[64:67], a[140:143], v[124:127]
    ds_read_b64_tr_b16 v[80:81], v15 offset:28672
    v_cvt_pk_bf16_f32 v58, v200, v201
    v_mfma_f32_16x16x32_bf16 v[124:127], v[68:71], a[156:159], v[124:127]
    ds_read_b64_tr_b16 v[82:83], v15 offset:30720
    v_cvt_pk_bf16_f32 v59, v202, v203
    v_mfma_f32_16x16x32_bf16 v[124:127], v[72:75], a[172:175], v[124:127]
    ds_read_b64_tr_b16 v[84:85], v15 offset:36864
    v_mul_f32 v204, v220, v204
    v_mfma_f32_16x16x32_bf16 v[124:127], v[76:79], a[188:191], v[124:127]
    ds_read_b64_tr_b16 v[86:87], v15 offset:38912
    v_mul_f32 v205, v221, v205
    v_mfma_f32_16x16x32_bf16 v[120:123], v[76:79], a[184:187], v[120:123]
    ds_read_b64_tr_b16 v[88:89], v15 offset:45056
    v_mul_f32 v206, v222, v206
    v_mfma_f32_16x16x32_bf16 v[120:123], v[72:75], a[168:171], v[120:123]
    buffer_store_dwordx4 v[56:59], v24, s[28:31], s73 offen sc1
    v_mfma_f32_16x16x32_bf16 v[120:123], v[68:71], a[152:155], v[120:123]
    s_add_u32 s73, s73, 16384
    ds_read_b64_tr_b16 v[90:91], v15 offset:47104
    v_mfma_f32_16x16x32_bf16 v[120:123], v[64:67], a[136:139], v[120:123]
    ds_read_b64_tr_b16 v[92:93], v15 offset:53248
    v_mul_f32 v207, v223, v207
    v_mfma_f32_16x16x32_bf16 v[116:119], v[64:67], a[132:135], v[116:119]
    ds_read_b64_tr_b16 v[94:95], v15 offset:55296
    v_cvt_pk_bf16_f32 v62, v204, v205
    v_mfma_f32_16x16x32_bf16 v[116:119], v[68:71], a[148:151], v[116:119]
    v_cvt_pk_bf16_f32 v63, v206, v207
    v_mfma_f32_16x16x32_bf16 v[116:119], v[72:75], a[164:167], v[116:119]
    v_mfma_f32_16x16x32_bf16 v[116:119], v[76:79], a[180:183], v[116:119]
    v_mfma_f32_16x16x32_bf16 v[112:115], v[76:79], a[176:179], v[112:115]
    v_mfma_f32_16x16x32_bf16 v[112:115], v[72:75], a[160:163], v[112:115]
    v_mfma_f32_16x16x32_bf16 v[112:115], v[68:71], a[144:147], v[112:115]
    v_mfma_f32_16x16x32_bf16 v[112:115], v[64:67], a[128:131], v[112:115]
    s_waitcnt lgkmcnt(0)
    v_mfma_f32_16x16x32_bf16 v[140:143], v[80:83], a[140:143], v[140:143]
    ds_read_b64_tr_b16 v[64:65], v15 offset:32768
    v_mfma_f32_16x16x32_bf16 v[140:143], v[84:87], a[156:159], v[140:143]
    buffer_store_dwordx4 v[60:63], v24, s[28:31], s74 offen sc1
    v_mfma_f32_16x16x32_bf16 v[140:143], v[88:91], a[172:175], v[140:143]
    s_add_u32 s74, s74, 16384
    ds_read_b64_tr_b16 v[66:67], v15 offset:34816
    v_mfma_f32_16x16x32_bf16 v[140:143], v[92:95], a[188:191], v[140:143]
    ds_read_b64_tr_b16 v[68:69], v15 offset:40960
    v_mfma_f32_16x16x32_bf16 v[136:139], v[92:95], a[184:187], v[136:139]
    ds_read_b64_tr_b16 v[70:71], v15 offset:43008
    v_mfma_f32_16x16x32_bf16 v[136:139], v[88:91], a[168:171], v[136:139]
    ds_read_b64_tr_b16 v[72:73], v15 offset:49152
    v_mfma_f32_16x16x32_bf16 v[136:139], v[84:87], a[152:155], v[136:139]
    ds_read_b64_tr_b16 v[74:75], v15 offset:51200
    v_mfma_f32_16x16x32_bf16 v[136:139], v[80:83], a[136:139], v[136:139]
    ds_read_b64_tr_b16 v[76:77], v19 offset:0
    v_mfma_f32_16x16x32_bf16 v[132:135], v[80:83], a[132:135], v[132:135]
    ds_read_b64_tr_b16 v[78:79], v19 offset:2048
    v_mfma_f32_16x16x32_bf16 v[132:135], v[84:87], a[148:151], v[132:135]
    v_mfma_f32_16x16x32_bf16 v[132:135], v[88:91], a[164:167], v[132:135]
    v_mfma_f32_16x16x32_bf16 v[132:135], v[92:95], a[180:183], v[132:135]
    v_mfma_f32_16x16x32_bf16 v[128:131], v[92:95], a[176:179], v[128:131]
    v_mfma_f32_16x16x32_bf16 v[128:131], v[88:91], a[160:163], v[128:131]
    v_mfma_f32_16x16x32_bf16 v[128:131], v[84:87], a[144:147], v[128:131]
    v_mfma_f32_16x16x32_bf16 v[128:131], v[80:83], a[128:131], v[128:131]
    s_waitcnt lgkmcnt(0)
    v_mfma_f32_16x16x32_bf16 v[156:159], v[64:67], a[140:143], v[156:159]
    s_barrier
    s_add_u32 m0, s58, 77824
    v_mfma_f32_16x16x32_bf16 v[156:159], v[68:71], a[156:159], v[156:159]
    buffer_load_dwordx4 v30, s[28:31], m0 offen sc1 lds
    v_mfma_f32_16x16x32_bf16 v[156:159], v[72:75], a[172:175], v[156:159]
    ds_read_b64_tr_b16 v[80:81], v18 offset:4096
    ds_read_b64_tr_b16 v[82:83], v18 offset:6144
    v_mfma_f32_16x16x32_bf16 v[156:159], v[76:79], a[188:191], v[156:159]
    ds_read_b64_tr_b16 v[84:85], v18 offset:12288
    ds_read_b64_tr_b16 v[86:87], v18 offset:14336
    v_mfma_f32_16x16x32_bf16 v[152:155], v[76:79], a[184:187], v[152:155]
    ds_read_b64_tr_b16 v[88:89], v18 offset:20480
    s_add_u32 m0, s58, 81920
    v_mfma_f32_16x16x32_bf16 v[152:155], v[72:75], a[168:171], v[152:155]
    buffer_load_dwordx4 v30, s[28:31], m0 offen sc1 lds
    v_mfma_f32_16x16x32_bf16 v[152:155], v[68:71], a[152:155], v[152:155]
    ds_read_b64_tr_b16 v[90:91], v18 offset:22528
    ds_read_b64_tr_b16 v[92:93], v18 offset:28672
    v_mfma_f32_16x16x32_bf16 v[152:155], v[64:67], a[136:139], v[152:155]
    ds_read_b64_tr_b16 v[94:95], v18 offset:30720
    v_mfma_f32_16x16x32_bf16 v[148:151], v[64:67], a[132:135], v[148:151]
    s_add_u32 m0, s58, 86016
    v_mfma_f32_16x16x32_bf16 v[148:151], v[68:71], a[148:151], v[148:151]
    buffer_load_dwordx4 v30, s[28:31], m0 offen sc1 lds
    v_mfma_f32_16x16x32_bf16 v[148:151], v[72:75], a[164:167], v[148:151]
    v_mfma_f32_16x16x32_bf16 v[148:151], v[76:79], a[180:183], v[148:151]
    v_mfma_f32_16x16x32_bf16 v[144:147], v[76:79], a[176:179], v[144:147]
    s_add_u32 m0, s58, 90112
    v_mfma_f32_16x16x32_bf16 v[144:147], v[72:75], a[160:163], v[144:147]
    buffer_load_dwordx4 v30, s[28:31], m0 offen sc1 lds
    v_mfma_f32_16x16x32_bf16 v[144:147], v[68:71], a[144:147], v[144:147]
    v_mfma_f32_16x16x32_bf16 v[144:147], v[64:67], a[128:131], v[144:147]
    s_waitcnt lgkmcnt(0)
    v_mfma_f32_16x16x32_bf16 v[108:111], v[80:83], a[204:207], v[108:111]
    ds_read_b64_tr_b16 v[64:65], v18 offset:8192
ffn_c_h5:
    s_cbranch_execz ffn_c_h5_1
    s_add_u32 m0, s58, 94208
    v_mfma_f32_16x16x32_bf16 v[108:111], v[84:87], a[220:223], v[108:111]
    buffer_load_dwordx4 v30, s[28:31], m0 offen sc1 lds
    v_mfma_f32_16x16x32_bf16 v[108:111], v[88:91], a[236:239], v[108:111]
    ds_read_b64_tr_b16 v[66:67], v18 offset:10240
    v_mfma_f32_16x16x32_bf16 v[108:111], v[92:95], a[252:255], v[108:111]
    ds_read_b64_tr_b16 v[68:69], v18 offset:16384
    v_mfma_f32_16x16x32_bf16 v[104:107], v[92:95], a[248:251], v[104:107]
    ds_read_b64_tr_b16 v[70:71], v18 offset:18432
    s_add_u32 m0, s58, 98304
    v_mfma_f32_16x16x32_bf16 v[104:107], v[88:91], a[232:235], v[104:107]
    buffer_load_dwordx4 v30, s[28:31], m0 offen sc1 lds
    v_mfma_f32_16x16x32_bf16 v[104:107], v[84:87], a[216:219], v[104:107]
    ds_read_b64_tr_b16 v[72:73], v18 offset:24576
    v_mfma_f32_16x16x32_bf16 v[104:107], v[80:83], a[200:203], v[104:107]
    ds_read_b64_tr_b16 v[74:75], v18 offset:26624
    v_mfma_f32_16x16x32_bf16 v[100:103], v[80:83], a[196:199], v[100:103]
    ds_read_b64_tr_b16 v[76:77], v18 offset:32768
    s_add_u32 m0, s58, 102400
    v_mfma_f32_16x16x32_bf16 v[100:103], v[84:87], a[212:215], v[100:103]
    buffer_load_dwordx4 v30, s[28:31], m0 offen sc1 lds
    v_mfma_f32_16x16x32_bf16 v[100:103], v[88:91], a[228:231], v[100:103]
    ds_read_b64_tr_b16 v[78:79], v18 offset:34816
    v_mfma_f32_16x16x32_bf16 v[100:103], v[92:95], a[244:247], v[100:103]
    v_mfma_f32_16x16x32_bf16 v[96:99], v[92:95], a[240:243], v[96:99]
    s_add_u32 m0, s58, 106496
    v_mfma_f32_16x16x32_bf16 v[96:99], v[88:91], a[224:227], v[96:99]
    buffer_load_dwordx4 v30, s[28:31], m0 offen sc1 lds
    v_mfma_f32_16x16x32_bf16 v[96:99], v[84:87], a[208:211], v[96:99]
    v_mfma_f32_16x16x32_bf16 v[96:99], v[80:83], a[192:195], v[96:99]
    s_waitcnt lgkmcnt(0)
    v_mfma_f32_16x16x32_bf16 v[124:127], v[64:67], a[204:207], v[124:127]
    ds_read_b64_tr_b16 v[80:81], v19 offset:4096
    v_mfma_f32_16x16x32_bf16 v[124:127], v[68:71], a[220:223], v[124:127]
    buffer_load_dwordx2 a[128:129], v27, s[28:31], s57 offen offset:0 sc1
    v_mfma_f32_16x16x32_bf16 v[124:127], v[72:75], a[236:239], v[124:127]
    ds_read_b64_tr_b16 v[82:83], v19 offset:6144
    v_mfma_f32_16x16x32_bf16 v[124:127], v[76:79], a[252:255], v[124:127]
    ds_read_b64_tr_b16 v[84:85], v19 offset:12288
    v_mfma_f32_16x16x32_bf16 v[120:123], v[76:79], a[248:251], v[120:123]
ffn_c_h5_1:
    s_cbranch_execz ffn_c_h5_2
    ds_read_b64_tr_b16 v[86:87], v19 offset:14336
    v_mfma_f32_16x16x32_bf16 v[120:123], v[72:75], a[232:235], v[120:123]
    buffer_load_dwordx2 a[130:131], v27, s[28:31], s57 offen offset:512 sc1
    v_mfma_f32_16x16x32_bf16 v[120:123], v[68:71], a[216:219], v[120:123]
    ds_read_b64_tr_b16 v[88:89], v19 offset:20480
    v_mfma_f32_16x16x32_bf16 v[120:123], v[64:67], a[200:203], v[120:123]
    ds_read_b64_tr_b16 v[90:91], v19 offset:22528
    v_mfma_f32_16x16x32_bf16 v[116:119], v[64:67], a[196:199], v[116:119]
    ds_read_b64_tr_b16 v[92:93], v19 offset:28672
    v_mfma_f32_16x16x32_bf16 v[116:119], v[68:71], a[212:215], v[116:119]
    buffer_load_dwordx2 a[132:133], v27, s[28:31], s57 offen offset:1024 sc1
    v_mfma_f32_16x16x32_bf16 v[116:119], v[72:75], a[228:231], v[116:119]
    ds_read_b64_tr_b16 v[94:95], v19 offset:30720
    v_mfma_f32_16x16x32_bf16 v[116:119], v[76:79], a[244:247], v[116:119]
    v_mfma_f32_16x16x32_bf16 v[112:115], v[76:79], a[240:243], v[112:115]
    v_mfma_f32_16x16x32_bf16 v[112:115], v[72:75], a[224:227], v[112:115]
    buffer_load_dwordx2 a[134:135], v27, s[28:31], s57 offen offset:1536 sc1
    v_mfma_f32_16x16x32_bf16 v[112:115], v[68:71], a[208:211], v[112:115]
    v_mfma_f32_16x16x32_bf16 v[112:115], v[64:67], a[192:195], v[112:115]
    s_waitcnt lgkmcnt(0)
    v_mfma_f32_16x16x32_bf16 v[140:143], v[80:83], a[204:207], v[140:143]
    ds_read_b64_tr_b16 v[64:65], v19 offset:8192
    v_mfma_f32_16x16x32_bf16 v[140:143], v[84:87], a[220:223], v[140:143]
    buffer_load_dwordx2 a[136:137], v27, s[28:31], s57 offen offset:2048 sc1
    v_mfma_f32_16x16x32_bf16 v[140:143], v[88:91], a[236:239], v[140:143]
    ds_read_b64_tr_b16 v[66:67], v19 offset:10240
    v_mfma_f32_16x16x32_bf16 v[140:143], v[92:95], a[252:255], v[140:143]
    ds_read_b64_tr_b16 v[68:69], v19 offset:16384
    v_mfma_f32_16x16x32_bf16 v[136:139], v[92:95], a[248:251], v[136:139]
    ds_read_b64_tr_b16 v[70:71], v19 offset:18432
    v_mfma_f32_16x16x32_bf16 v[136:139], v[88:91], a[232:235], v[136:139]
    buffer_load_dwordx2 a[138:139], v27, s[28:31], s57 offen offset:2560 sc1
    v_mfma_f32_16x16x32_bf16 v[136:139], v[84:87], a[216:219], v[136:139]
    ds_read_b64_tr_b16 v[72:73], v19 offset:24576
    v_mfma_f32_16x16x32_bf16 v[136:139], v[80:83], a[200:203], v[136:139]
    ds_read_b64_tr_b16 v[74:75], v19 offset:26624
    v_mfma_f32_16x16x32_bf16 v[132:135], v[80:83], a[196:199], v[132:135]
    ds_read_b64_tr_b16 v[76:77], v19 offset:32768
    v_mfma_f32_16x16x32_bf16 v[132:135], v[84:87], a[212:215], v[132:135]
    buffer_load_dwordx2 a[140:141], v27, s[28:31], s57 offen offset:3072 sc1
ffn_c_h5_2:
    s_cbranch_execz ffn_c_ret
    v_mfma_f32_16x16x32_bf16 v[132:135], v[88:91], a[228:231], v[132:135]
    ds_read_b64_tr_b16 v[78:79], v19 offset:34816
    v_mfma_f32_16x16x32_bf16 v[132:135], v[92:95], a[244:247], v[132:135]
    v_mfma_f32_16x16x32_bf16 v[128:131], v[92:95], a[240:243], v[128:131]
    v_mfma_f32_16x16x32_bf16 v[128:131], v[88:91], a[224:227], v[128:131]
    buffer_load_dwordx2 a[142:143], v27, s[28:31], s57 offen offset:3584 sc1
    v_mfma_f32_16x16x32_bf16 v[128:131], v[84:87], a[208:211], v[128:131]
    s_add_u32 s57, s57, 4096
    v_mfma_f32_16x16x32_bf16 v[128:131], v[80:83], a[192:195], v[128:131]
    s_waitcnt lgkmcnt(0)
    v_mfma_f32_16x16x32_bf16 v[156:159], v[64:67], a[204:207], v[156:159]
    ds_read_b64_tr_b16 v[80:81], v18 offset:36864
    v_mfma_f32_16x16x32_bf16 v[156:159], v[68:71], a[220:223], v[156:159]
    buffer_load_dwordx2 a[144:145], v27, s[28:31], s57 offen offset:0 sc1
    v_mfma_f32_16x16x32_bf16 v[156:159], v[72:75], a[236:239], v[156:159]
    ds_read_b64_tr_b16 v[82:83], v18 offset:38912
    v_mfma_f32_16x16x32_bf16 v[156:159], v[76:79], a[252:255], v[156:159]
    ds_read_b64_tr_b16 v[84:85], v18 offset:45056
    v_mfma_f32_16x16x32_bf16 v[152:155], v[76:79], a[248:251], v[152:155]
    ds_read_b64_tr_b16 v[86:87], v18 offset:47104
    v_mfma_f32_16x16x32_bf16 v[152:155], v[72:75], a[232:235], v[152:155]
    buffer_load_dwordx2 a[146:147], v27, s[28:31], s57 offen offset:512 sc1
    v_mfma_f32_16x16x32_bf16 v[152:155], v[68:71], a[216:219], v[152:155]
    ds_read_b64_tr_b16 v[88:89], v18 offset:40960
    v_mfma_f32_16x16x32_bf16 v[152:155], v[64:67], a[200:203], v[152:155]
    ds_read_b64_tr_b16 v[90:91], v18 offset:43008
    v_mfma_f32_16x16x32_bf16 v[148:151], v[64:67], a[196:199], v[148:151]
    ds_read_b64_tr_b16 v[92:93], v18 offset:49152
    v_mfma_f32_16x16x32_bf16 v[148:151], v[68:71], a[212:215], v[148:151]
    buffer_load_dwordx2 a[148:149], v27, s[28:31], s57 offen offset:1024 sc1
    v_mfma_f32_16x16x32_bf16 v[148:151], v[72:75], a[228:231], v[148:151]
    ds_read_b64_tr_b16 v[94:95], v18 offset:51200
    v_mfma_f32_16x16x32_bf16 v[148:151], v[76:79], a[244:247], v[148:151]
    s_waitcnt vmcnt(19)
    v_mfma_f32_16x16x32_bf16 v[144:147], v[76:79], a[240:243], v[144:147]
    v_mfma_f32_16x16x32_bf16 v[144:147], v[72:75], a[224:227], v[144:147]
    buffer_store_dword v28, v33, s[28:31], s49 offen sc1
    v_mfma_f32_16x16x32_bf16 v[144:147], v[68:71], a[208:211], v[144:147]
    s_add_u32 s49, s49, 0x4000
    v_mfma_f32_16x16x32_bf16 v[144:147], v[64:67], a[192:195], v[144:147]
    s_waitcnt lgkmcnt(0)
    v_mfma_f32_16x16x32_bf16 v[108:111], v[80:83], v[236:239], v[108:111]
    ds_read_b64_tr_b16 v[64:65], v19 offset:36864
    v_mfma_f32_16x16x32_bf16 v[108:111], v[84:87], v[252:255], v[108:111]
    buffer_load_dwordx2 a[150:151], v27, s[28:31], s57 offen offset:1536 sc1
    v_mfma_f32_16x16x32_bf16 v[104:107], v[84:87], v[248:251], v[104:107]
    ds_read_b64_tr_b16 v[66:67], v19 offset:38912
    v_mfma_f32_16x16x32_bf16 v[104:107], v[80:83], v[232:235], v[104:107]
    ds_read_b64_tr_b16 v[68:69], v19 offset:45056
    v_mfma_f32_16x16x32_bf16 v[100:103], v[80:83], v[228:231], v[100:103]
    ds_read_b64_tr_b16 v[70:71], v19 offset:47104
    v_mfma_f32_16x16x32_bf16 v[100:103], v[84:87], v[244:247], v[100:103]
    buffer_load_dwordx2 a[152:153], v27, s[28:31], s57 offen offset:2048 sc1
    v_mfma_f32_16x16x32_bf16 v[96:99], v[84:87], v[240:243], v[96:99]
    ds_read_b64_tr_b16 v[72:73], v19 offset:40960
    v_mfma_f32_16x16x32_bf16 v[96:99], v[80:83], v[224:227], v[96:99]
    ds_read_b64_tr_b16 v[74:75], v19 offset:43008
    v_mfma_f32_16x16x32_bf16 v[112:115], v[88:91], v[224:227], v[112:115]
    ds_read_b64_tr_b16 v[76:77], v19 offset:49152
    v_mfma_f32_16x16x32_bf16 v[112:115], v[92:95], v[240:243], v[112:115]
    buffer_load_dwordx2 a[154:155], v27, s[28:31], s57 offen offset:2560 sc1
    v_mfma_f32_16x16x32_bf16 v[116:119], v[92:95], v[244:247], v[116:119]
    ds_read_b64_tr_b16 v[78:79], v19 offset:51200
    v_mfma_f32_16x16x32_bf16 v[116:119], v[88:91], v[228:231], v[116:119]
    v_mfma_f32_16x16x32_bf16 v[120:123], v[88:91], v[232:235], v[120:123]
    v_mfma_f32_16x16x32_bf16 v[120:123], v[92:95], v[248:251], v[120:123]
    buffer_load_dwordx2 a[156:157], v27, s[28:31], s57 offen offset:3072 sc1
    v_mfma_f32_16x16x32_bf16 v[124:127], v[92:95], v[252:255], v[124:127]
    v_mfma_f32_16x16x32_bf16 v[124:127], v[88:91], v[236:239], v[124:127]
    s_waitcnt lgkmcnt(0)
    v_mfma_f32_16x16x32_bf16 v[140:143], v[64:67], v[236:239], v[140:143]
    s_barrier
    s_add_u32 m0, s58, 110592
    v_mfma_f32_16x16x32_bf16 v[140:143], v[68:71], v[252:255], v[140:143]
    buffer_load_dwordx4 v30, s[28:31], m0 offen sc1 lds
    v_mfma_f32_16x16x32_bf16 v[136:139], v[68:71], v[248:251], v[136:139]
    ds_read_b128 v[80:83], v24 offset:12288
    v_mul_f32 v96, v112, v96
    v_mfma_f32_16x16x32_bf16 v[136:139], v[64:67], v[232:235], v[136:139]
    ds_read_b128 v[84:87], v24 offset:13312
    v_mul_f32 v97, v113, v97
    v_mfma_f32_16x16x32_bf16 v[132:135], v[64:67], v[228:231], v[132:135]
    ds_read_b128 v[88:91], v24 offset:14336
    s_add_u32 m0, s58, 114688
    v_mfma_f32_16x16x32_bf16 v[132:135], v[68:71], v[244:247], v[132:135]
    buffer_load_dwordx4 v30, s[28:31], m0 offen sc1 lds
    v_mfma_f32_16x16x32_bf16 v[128:131], v[68:71], v[240:243], v[128:131]
    ds_read_b128 v[92:95], v24 offset:15360
    v_mul_f32 v98, v114, v98
    v_mfma_f32_16x16x32_bf16 v[128:131], v[64:67], v[224:227], v[128:131]
    ds_read_b128 v[40:43], v24 offset:16384
    v_mul_f32 v99, v115, v99
    v_mfma_f32_16x16x32_bf16 v[144:147], v[72:75], v[224:227], v[144:147]
    ds_read_b128 v[8:11], v24 offset:17408
    s_add_u32 m0, s58, 118784
    v_mfma_f32_16x16x32_bf16 v[144:147], v[76:79], v[240:243], v[144:147]
    buffer_load_dwordx4 v30, s[28:31], m0 offen sc1 lds
    v_mfma_f32_16x16x32_bf16 v[148:151], v[76:79], v[244:247], v[148:151]
    ds_read_b128 v[20:23], v24 offset:18432
    v_cvt_pk_bf16_f32 v48, v96, v97
    v_mfma_f32_16x16x32_bf16 v[148:151], v[72:75], v[228:231], v[148:151]
    v_cvt_pk_bf16_f32 v49, v98, v99
    v_mul_f32 v100, v116, v100
    v_mfma_f32_16x16x32_bf16 v[152:155], v[72:75], v[232:235], v[152:155]
    v_mul_f32 v101, v117, v101
    s_add_u32 m0, s58, 122880
    v_mfma_f32_16x16x32_bf16 v[152:155], v[76:79], v[248:251], v[152:155]
    buffer_load_dwordx4 v30, s[28:31], m0 offen sc1 lds
    v_mfma_f32_16x16x32_bf16 v[156:159], v[76:79], v[252:255], v[156:159]
    v_mul_f32 v102, v118, v102
    v_mul_f32 v103, v119, v103
    v_mfma_f32_16x16x32_bf16 v[156:159], v[72:75], v[236:239], v[156:159]
    v_cvt_pk_bf16_f32 v52, v100, v101
    s_waitcnt lgkmcnt(0)
    v_mfma_f32_16x16x32_bf16 v[204:207], v[80:83], a[0:3], 0
    ds_read_b128 v[64:67], v24 offset:19456
    s_add_u32 m0, s58, 126976
    v_mfma_f32_16x16x32_bf16 v[204:207], v[84:87], a[8:11], v[204:207]
    buffer_load_dwordx4 v30, s[28:31], m0 offen sc1 lds
    v_mfma_f32_16x16x32_bf16 v[204:207], v[88:91], a[16:19], v[204:207]
    ds_read_b128 v[68:71], v24 offset:20480
    v_cvt_pk_bf16_f32 v53, v102, v103
    v_mfma_f32_16x16x32_bf16 v[204:207], v[92:95], a[24:27], v[204:207]
    ds_read_b128 v[72:75], v24 offset:21504
    v_mul_f32 v104, v120, v104
    v_mfma_f32_16x16x32_bf16 v[204:207], v[40:43], a[32:35], v[204:207]
    ds_read_b128 v[76:79], v24 offset:22528
    s_add_u32 m0, s58, 131072
    v_mfma_f32_16x16x32_bf16 v[204:207], v[8:11], a[40:43], v[204:207]
    buffer_load_dwordx4 v30, s[28:31], m0 offen sc1 lds
    v_mfma_f32_16x16x32_bf16 v[204:207], v[20:23], a[48:51], v[204:207]
    ds_read_b128 v[4:7], v24 offset:23552
    v_mul_f32 v105, v121, v105
    v_mfma_f32_16x16x32_bf16 v[220:223], v[20:23], a[52:55], 0
    ds_read_b128 v[44:47], v24 offset:24576
    v_mul_f32 v106, v122, v106
    v_mfma_f32_16x16x32_bf16 v[220:223], v[8:11], a[44:47], v[220:223]
    ds_read_b128 v[172:175], v24 offset:25600
    s_add_u32 m0, s58, 135168
    v_mfma_f32_16x16x32_bf16 v[220:223], v[40:43], a[36:39], v[220:223]
    buffer_load_dwordx4 v30, s[28:31], m0 offen sc1 lds
    v_mfma_f32_16x16x32_bf16 v[220:223], v[92:95], a[28:31], v[220:223]
    v_mul_f32 v107, v123, v107
    v_cvt_pk_bf16_f32 v56, v104, v105
    v_mfma_f32_16x16x32_bf16 v[220:223], v[88:91], a[20:23], v[220:223]
    v_cvt_pk_bf16_f32 v57, v106, v107
    v_mul_f32 v108, v124, v108
    v_mfma_f32_16x16x32_bf16 v[220:223], v[84:87], a[12:15], v[220:223]
    v_mul_f32 v109, v125, v109
    v_mul_f32 v110, v126, v110
    v_mfma_f32_16x16x32_bf16 v[220:223], v[80:83], a[4:7], v[220:223]
    s_add_u32 m0, s58, 139264
    s_waitcnt lgkmcnt(0)
    v_mfma_f32_16x16x32_bf16 v[168:171], v[64:67], a[0:3], 0
    buffer_load_dwordx4 v30, s[28:31], m0 offen sc1 lds
    v_mfma_f32_16x16x32_bf16 v[168:171], v[68:71], a[8:11], v[168:171]
    ds_read_b128 v[80:83], v24 offset:26624
    v_mul_f32 v111, v127, v111
    v_mfma_f32_16x16x32_bf16 v[168:171], v[72:75], a[16:19], v[168:171]
    ds_read_b128 v[84:87], v24 offset:27648
    v_cvt_pk_bf16_f32 v60, v108, v109
    v_mfma_f32_16x16x32_bf16 v[168:171], v[76:79], a[24:27], v[168:171]
    ds_read_b128 v[88:91], v24 offset:28672
    v_cvt_pk_bf16_f32 v61, v110, v111
    v_mfma_f32_16x16x32_bf16 v[168:171], v[4:7], a[32:35], v[168:171]
    buffer_load_dwordx2 a[158:159], v27, s[28:31], s57 offen offset:3584 sc1
    v_mfma_f32_16x16x32_bf16 v[168:171], v[44:47], a[40:43], v[168:171]
    s_add_u32 s57, s57, 4096
    ds_read_b128 v[92:95], v24 offset:29696
    v_mfma_f32_16x16x32_bf16 v[168:171], v[172:175], a[48:51], v[168:171]
    ds_read_b128 v[40:43], v24 offset:30720
    v_mul_f32 v128, v144, v128
    v_mfma_f32_16x16x32_bf16 v[184:187], v[172:175], a[52:55], 0
    ds_read_b128 v[8:11], v24 offset:31744
    s_add_u32 m0, s58, 143360
    v_mfma_f32_16x16x32_bf16 v[184:187], v[44:47], a[44:47], v[184:187]
    buffer_load_dwordx4 v30, s[28:31], m0 offen sc1 lds
    v_mfma_f32_16x16x32_bf16 v[184:187], v[4:7], a[36:39], v[184:187]
    ds_read_b128 v[20:23], v24 offset:32768
    v_mul_f32 v129, v145, v129
    v_mfma_f32_16x16x32_bf16 v[184:187], v[76:79], a[28:31], v[184:187]
    v_mul_f32 v130, v146, v130
    v_mul_f32 v131, v147, v131
    v_mfma_f32_16x16x32_bf16 v[184:187], v[72:75], a[20:23], v[184:187]
    v_cvt_pk_bf16_f32 v50, v128, v129
    s_add_u32 m0, s58, 147456
    v_mfma_f32_16x16x32_bf16 v[184:187], v[68:71], a[12:15], v[184:187]
    buffer_load_dwordx4 v30, s[28:31], m0 offen sc1 lds
    v_mfma_f32_16x16x32_bf16 v[184:187], v[64:67], a[4:7], v[184:187]
    v_cvt_pk_bf16_f32 v51, v130, v131
    s_waitcnt lgkmcnt(0)
    v_mfma_f32_16x16x32_bf16 v[200:203], v[80:83], a[0:3], 0
    ds_read_b128 v[64:67], v24 offset:33792
    v_mul_f32 v132, v148, v132
    v_mfma_f32_16x16x32_bf16 v[200:203], v[84:87], a[8:11], v[200:203]
    ds_read_b128 v[68:71], v24 offset:34816
    v_mul_f32 v133, v149, v133
    v_mfma_f32_16x16x32_bf16 v[200:203], v[88:91], a[16:19], v[200:203]
    buffer_store_dwordx4 v[48:51], v24, s[28:31], s70 offen sc1
    v_mfma_f32_16x16x32_bf16 v[200:203], v[92:95], a[24:27], v[200:203]
    ds_read_b128 v[72:75], v24 offset:35840
    v_mul_f32 v134, v150, v134
    v_mfma_f32_16x16x32_bf16 v[200:203], v[40:43], a[32:35], v[200:203]
    ds_read_b128 v[76:79], v24 offset:36864
    v_mul_f32 v135, v151, v135
    v_mfma_f32_16x16x32_bf16 v[200:203], v[8:11], a[40:43], v[200:203]
    ds_read_b128 v[4:7], v24 offset:37888
    s_add_u32 m0, s58, 151552
    v_mfma_f32_16x16x32_bf16 v[200:203], v[20:23], a[48:51], v[200:203]
    buffer_load_dwordx4 v30, s[28:31], m0 offen sc1 lds
    v_mfma_f32_16x16x32_bf16 v[216:219], v[20:23], a[52:55], 0
    ds_read_b128 v[44:47], v24 offset:38912
    v_cvt_pk_bf16_f32 v54, v132, v133
    v_mfma_f32_16x16x32_bf16 v[216:219], v[8:11], a[44:47], v[216:219]
    ds_read_b128 v[172:175], v24 offset:39936
    v_cvt_pk_bf16_f32 v55, v134, v135
    v_mfma_f32_16x16x32_bf16 v[216:219], v[40:43], a[36:39], v[216:219]
    v_mul_f32 v136, v152, v136
    s_add_u32 m0, s58, 155648
    v_mfma_f32_16x16x32_bf16 v[216:219], v[92:95], a[28:31], v[216:219]
    buffer_load_dwordx4 v30, s[28:31], m0 offen sc1 lds
    v_mfma_f32_16x16x32_bf16 v[216:219], v[88:91], a[20:23], v[216:219]
    v_add_u32 v30, 147456, v30
    v_mul_f32 v137, v153, v137
    v_mfma_f32_16x16x32_bf16 v[216:219], v[84:87], a[12:15], v[216:219]
    v_mul_f32 v138, v154, v138
    v_mul_f32 v139, v155, v139
    v_mfma_f32_16x16x32_bf16 v[216:219], v[80:83], a[4:7], v[216:219]
    v_cvt_pk_bf16_f32 v58, v136, v137
    s_waitcnt lgkmcnt(0)
    v_mfma_f32_16x16x32_bf16 v[164:167], v[64:67], a[0:3], 0
    buffer_store_dwordx4 v[52:55], v24, s[28:31], s71 offen sc1
    v_mfma_f32_16x16x32_bf16 v[164:167], v[68:71], a[8:11], v[164:167]
    ds_read_b128 v[80:83], v24 offset:40960
    v_cvt_pk_bf16_f32 v59, v138, v139
    v_mfma_f32_16x16x32_bf16 v[164:167], v[72:75], a[16:19], v[164:167]
    ds_read_b128 v[84:87], v24 offset:41984
    v_mul_f32 v140, v156, v140
    v_mfma_f32_16x16x32_bf16 v[164:167], v[76:79], a[24:27], v[164:167]
    ds_read_b128 v[88:91], v24 offset:43008
    v_mul_f32 v141, v157, v141
    v_mfma_f32_16x16x32_bf16 v[164:167], v[4:7], a[32:35], v[164:167]
    ds_read_b128 v[92:95], v24 offset:44032
    v_mul_f32 v142, v158, v142
    v_mfma_f32_16x16x32_bf16 v[164:167], v[44:47], a[40:43], v[164:167]
    ds_read_b128 v[40:43], v24 offset:45056
    v_mul_f32 v143, v159, v143
    v_mfma_f32_16x16x32_bf16 v[164:167], v[172:175], a[48:51], v[164:167]
    ds_read_b128 v[8:11], v24 offset:46080
    v_cvt_pk_bf16_f32 v62, v140, v141
    v_mfma_f32_16x16x32_bf16 v[180:183], v[172:175], a[52:55], 0
    buffer_store_dwordx4 v[56:59], v24, s[28:31], s73 offen sc1
    v_mfma_f32_16x16x32_bf16 v[180:183], v[44:47], a[44:47], v[180:183]
    ds_read_b128 v[20:23], v24 offset:47104
    v_cvt_pk_bf16_f32 v63, v142, v143
    v_mfma_f32_16x16x32_bf16 v[180:183], v[4:7], a[36:39], v[180:183]
    v_lshrrev_b32 v12, 2, v1
    v_and_b32 v13, 3, v1
    v_mfma_f32_16x16x32_bf16 v[180:183], v[76:79], a[28:31], v[180:183]
    v_lshlrev_b32 v13, 3, v13
    v_lshl_add_u32 v13, v12, 6, v13
    v_mfma_f32_16x16x32_bf16 v[180:183], v[72:75], a[20:23], v[180:183]
    v_add_u32 v3, s75, v13
    v_add_u32 v31, s48, v24
    v_mfma_f32_16x16x32_bf16 v[180:183], v[68:71], a[12:15], v[180:183]
    v_and_b32 v14, 15, v1
    v_bfe_u32 v15, v1, 4, 1
    v_mfma_f32_16x16x32_bf16 v[180:183], v[64:67], a[4:7], v[180:183]
    v_bfe_u32 v16, v1, 5, 1
    s_waitcnt lgkmcnt(0)
    v_mfma_f32_16x16x32_bf16 v[196:199], v[80:83], a[0:3], 0
    ds_read_b128 v[64:67], v24 offset:48128
    s_movk_i32 s5, 1152
    v_mfma_f32_16x16x32_bf16 v[196:199], v[84:87], a[8:11], v[196:199]
    ds_read_b128 v[68:71], v24 offset:49152
    v_lshlrev_b32 v16, 4, v16
    v_mfma_f32_16x16x32_bf16 v[196:199], v[88:91], a[16:19], v[196:199]
    ds_read_b128 v[72:75], v24 offset:50176
    v_mad_u32_u24 v16, v14, s5, v16
    v_mfma_f32_16x16x32_bf16 v[196:199], v[92:95], a[24:27], v[196:199]
    ds_read_b128 v[76:79], v24 offset:51200
    v_lshl_add_u32 v18, v15, 5, v16
    v_mfma_f32_16x16x32_bf16 v[196:199], v[40:43], a[32:35], v[196:199]
    ds_read_b128 v[4:7], v24 offset:52224
    v_mul_u32_u24 v15, 18432, v15
    v_mfma_f32_16x16x32_bf16 v[196:199], v[8:11], a[40:43], v[196:199]
    ds_read_b128 v[44:47], v24 offset:53248
    v_add3_u32 v19, v15, v16, s47
    v_mfma_f32_16x16x32_bf16 v[196:199], v[20:23], a[48:51], v[196:199]
    ds_read_b128 v[172:175], v24 offset:54272
    s_add_u32 s12, s12, 0x4000
    v_mfma_f32_16x16x32_bf16 v[212:215], v[20:23], a[52:55], 0
    buffer_load_dword v29, v32, s[28:31], s12 offen sc1
    v_mfma_f32_16x16x32_bf16 v[212:215], v[8:11], a[44:47], v[212:215]
    v_lshrrev_b32 v15, 4, v1
    v_lshlrev_b32 v15, 2, v15
    v_mfma_f32_16x16x32_bf16 v[212:215], v[40:43], a[36:39], v[212:215]
    v_sub_u32 v14, v14, v15
    v_and_b32 v15, 1, v14
    v_mfma_f32_16x16x32_bf16 v[212:215], v[92:95], a[28:31], v[212:215]
    v_lshlrev_b32 v15, 4, v15
    v_mov_b32 v16, 0x3f80
    v_mfma_f32_16x16x32_bf16 v[212:215], v[88:91], a[20:23], v[212:215]
    buffer_store_dwordx4 v[60:63], v24, s[28:31], s74 offen sc1
    v_mfma_f32_16x16x32_bf16 v[212:215], v[84:87], a[12:15], v[212:215]
    v_lshlrev_b32 v15, v15, v16
    v_lshrrev_b32 v14, 1, v14
    v_mfma_f32_16x16x32_bf16 v[212:215], v[80:83], a[4:7], v[212:215]
    v_cmp_eq_u32 s[64:65], 0, v14
    s_waitcnt lgkmcnt(0)
    v_mfma_f32_16x16x32_bf16 v[160:163], v[64:67], a[0:3], 0
    s_waitcnt vmcnt(37)
    s_barrier
    v_mfma_f32_16x16x32_bf16 v[160:163], v[68:71], a[8:11], v[160:163]
    ds_read_b128 v[80:83], v24 offset:55296
    ds_read_b128 v[84:87], v24 offset:56320
    v_mfma_f32_16x16x32_bf16 v[160:163], v[72:75], a[16:19], v[160:163]
    ds_read_b128 v[88:91], v25 offset:0
    ds_read_b128 v[92:95], v25 offset:1024
    v_mfma_f32_16x16x32_bf16 v[160:163], v[76:79], a[24:27], v[160:163]
    ds_read_b128 v[40:43], v25 offset:2048
    ds_read_b128 v[8:11], v25 offset:3072
    v_mfma_f32_16x16x32_bf16 v[160:163], v[4:7], a[32:35], v[160:163]
    ds_read_b128 v[20:23], v25 offset:4096
    v_cmp_eq_u32 s[66:67], 1, v14
    v_mfma_f32_16x16x32_bf16 v[160:163], v[44:47], a[40:43], v[160:163]
    v_mov_b32 v14, 0
    s_add_u32 m0, s58, 12288
    v_mfma_f32_16x16x32_bf16 v[160:163], v[172:175], a[48:51], v[160:163]
    buffer_load_dwordx4 v30, s[28:31], m0 offen sc1 lds
    v_mfma_f32_16x16x32_bf16 v[176:179], v[172:175], a[52:55], 0
    v_cndmask_b32 v12, 0, v15, s[64:65]
    v_cndmask_b32 v13, 0, v15, s[66:67]
    v_mfma_f32_16x16x32_bf16 v[176:179], v[44:47], a[44:47], v[176:179]
    v_mov_b32 v15, 0
    v_mov_b32 v16, v12
    v_mfma_f32_16x16x32_bf16 v[176:179], v[4:7], a[36:39], v[176:179]
    v_mov_b32 v17, v13
    s_add_u32 m0, s58, 16384
    v_mfma_f32_16x16x32_bf16 v[176:179], v[76:79], a[28:31], v[176:179]
    buffer_load_dwordx4 v30, s[28:31], m0 offen sc1 lds
    v_mfma_f32_16x16x32_bf16 v[176:179], v[72:75], a[20:23], v[176:179]
    v_mfma_f32_16x16x32_bf16 v[176:179], v[68:71], a[12:15], v[176:179]
    v_mfma_f32_16x16x32_bf16 v[176:179], v[64:67], a[4:7], v[176:179]
    s_add_u32 m0, s58, 20480
    s_waitcnt lgkmcnt(0)
    v_mfma_f32_16x16x32_bf16 v[192:195], v[80:83], a[0:3], 0
    buffer_load_dwordx4 v30, s[28:31], m0 offen sc1 lds
    v_mfma_f32_16x16x32_bf16 v[192:195], v[84:87], a[8:11], v[192:195]
    ds_read_b128 v[64:67], v25 offset:5120
    v_mfma_f32_16x16x32_bf16 v[192:195], v[88:91], a[16:19], v[192:195]
    ds_read_b128 v[68:71], v25 offset:6144
    v_mfma_f32_16x16x32_bf16 v[192:195], v[92:95], a[24:27], v[192:195]
    ds_read_b128 v[72:75], v25 offset:7168
    s_add_u32 m0, s58, 24576
    v_mfma_f32_16x16x32_bf16 v[192:195], v[40:43], a[32:35], v[192:195]
    buffer_load_dwordx4 v30, s[28:31], m0 offen sc1 lds
    v_mfma_f32_16x16x32_bf16 v[192:195], v[8:11], a[40:43], v[192:195]
    ds_read_b128 v[76:79], v25 offset:8192
    v_mfma_f32_16x16x32_bf16 v[192:195], v[20:23], a[48:51], v[192:195]
    ds_read_b128 v[4:7], v25 offset:9216
    v_mfma_f32_16x16x32_bf16 v[208:211], v[20:23], a[52:55], 0
    ds_read_b128 v[44:47], v25 offset:10240
    s_add_u32 m0, s58, 28672
    v_mfma_f32_16x16x32_bf16 v[208:211], v[8:11], a[44:47], v[208:211]
    buffer_load_dwordx4 v30, s[28:31], m0 offen sc1 lds
    v_mfma_f32_16x16x32_bf16 v[208:211], v[40:43], a[36:39], v[208:211]
    ds_read_b128 v[172:175], v25 offset:11264
    v_mfma_f32_16x16x32_bf16 v[208:211], v[92:95], a[28:31], v[208:211]
    v_mfma_f32_16x16x32_bf16 v[208:211], v[88:91], a[20:23], v[208:211]
    s_add_u32 m0, s58, 32768
    v_mfma_f32_16x16x32_bf16 v[208:211], v[84:87], a[12:15], v[208:211]
    buffer_load_dwordx4 v30, s[28:31], m0 offen sc1 lds
    v_mfma_f32_16x16x32_bf16 v[208:211], v[80:83], a[4:7], v[208:211]
    s_waitcnt lgkmcnt(0)
    v_mfma_f32_16x16x32_bf16 v[204:207], v[64:67], a[56:59], v[204:207]
    ds_read_b128 v[80:83], v25 offset:12288
    v_mfma_f32_16x16x32_bf16 v[204:207], v[68:71], a[64:67], v[204:207]
    ds_read_b128 v[84:87], v25 offset:13312
    s_add_u32 m0, s58, 36864
    v_mfma_f32_16x16x32_bf16 v[204:207], v[72:75], a[72:75], v[204:207]
    buffer_load_dwordx4 v30, s[28:31], m0 offen sc1 lds
    v_mfma_f32_16x16x32_bf16 v[204:207], v[76:79], a[80:83], v[204:207]
    ds_read_b128 v[88:91], v25 offset:14336
    v_mfma_f32_16x16x32_bf16 v[204:207], v[4:7], a[88:91], v[204:207]
    ds_read_b128 v[92:95], v25 offset:15360
    v_mfma_f32_16x16x32_bf16 v[204:207], v[44:47], a[96:99], v[204:207]
    ds_read_b128 v[40:43], v25 offset:16384
    s_add_u32 m0, s58, 40960
    v_mfma_f32_16x16x32_bf16 v[204:207], v[172:175], a[104:107], v[204:207]
    buffer_load_dwordx4 v30, s[28:31], m0 offen sc1 lds
    v_mfma_f32_16x16x32_bf16 v[220:223], v[172:175], a[108:111], v[220:223]
    ds_read_b128 v[8:11], v25 offset:17408
    v_mfma_f32_16x16x32_bf16 v[220:223], v[44:47], a[100:103], v[220:223]
    ds_read_b128 v[20:23], v25 offset:18432
    v_mfma_f32_16x16x32_bf16 v[220:223], v[4:7], a[92:95], v[220:223]
    s_add_u32 m0, s58, 45056
    v_mfma_f32_16x16x32_bf16 v[220:223], v[76:79], a[84:87], v[220:223]
    buffer_load_dwordx4 v30, s[28:31], m0 offen sc1 lds
    v_mfma_f32_16x16x32_bf16 v[220:223], v[72:75], a[76:79], v[220:223]
    v_mfma_f32_16x16x32_bf16 v[220:223], v[68:71], a[68:71], v[220:223]
    v_mfma_f32_16x16x32_bf16 v[220:223], v[64:67], a[60:63], v[220:223]
    s_add_u32 m0, s58, 49152
    s_waitcnt lgkmcnt(0)
    v_mfma_f32_16x16x32_bf16 v[168:171], v[80:83], a[56:59], v[168:171]
    buffer_load_dwordx4 v30, s[28:31], m0 offen sc1 lds
    v_mfma_f32_16x16x32_bf16 v[168:171], v[84:87], a[64:67], v[168:171]
    ds_read_b128 v[64:67], v25 offset:19456
    v_mfma_f32_16x16x32_bf16 v[168:171], v[88:91], a[72:75], v[168:171]
    ds_read_b128 v[68:71], v25 offset:20480
    v_mfma_f32_16x16x32_bf16 v[168:171], v[92:95], a[80:83], v[168:171]
    ds_read_b128 v[72:75], v25 offset:21504
    v_mfma_f32_16x16x32_bf16 v[168:171], v[40:43], a[88:91], v[168:171]
    ds_read_b128 v[76:79], v25 offset:22528
    v_mfma_f32_16x16x32_bf16 v[168:171], v[8:11], a[96:99], v[168:171]
    ds_read_b128 v[4:7], v25 offset:23552
    v_mfma_f32_16x16x32_bf16 v[168:171], v[20:23], a[104:107], v[168:171]
    ds_read_b128 v[44:47], v25 offset:24576
    v_mfma_f32_16x16x32_bf16 v[184:187], v[20:23], a[108:111], v[184:187]
    s_waitcnt vmcnt(11)
    ds_read_b128 v[172:175], v25 offset:25600
    v_mfma_f32_16x16x32_bf16 v[184:187], v[8:11], a[100:103], v[184:187]
    v_cmp_ne_u32 vcc, s96, v29
    v_mfma_f32_16x16x32_bf16 v[184:187], v[40:43], a[92:95], v[184:187]
    s_cbranch_vccnz ffn_slow4
ffn_back4:
    v_mfma_f32_16x16x32_bf16 v[184:187], v[92:95], a[84:87], v[184:187]
    buffer_load_dwordx4 a[160:163], v24, s[28:31], s57 offen offset:0 sc1
    v_mfma_f32_16x16x32_bf16 v[184:187], v[88:91], a[76:79], v[184:187]
    v_mfma_f32_16x16x32_bf16 v[184:187], v[84:87], a[68:71], v[184:187]
    v_mfma_f32_16x16x32_bf16 v[184:187], v[80:83], a[60:63], v[184:187]
    s_waitcnt lgkmcnt(0)
    v_mfma_f32_16x16x32_bf16 v[200:203], v[64:67], a[56:59], v[200:203]
    buffer_load_dwordx4 a[164:167], v24, s[28:31], s57 offen offset:1024 sc1
    v_mfma_f32_16x16x32_bf16 v[200:203], v[68:71], a[64:67], v[200:203]
    ds_read_b128 v[80:83], v25 offset:26624
    v_mfma_f32_16x16x32_bf16 v[200:203], v[72:75], a[72:75], v[200:203]
    ds_read_b128 v[84:87], v25 offset:27648
    v_mfma_f32_16x16x32_bf16 v[200:203], v[76:79], a[80:83], v[200:203]
    ds_read_b128 v[88:91], v25 offset:28672
    v_mfma_f32_16x16x32_bf16 v[200:203], v[4:7], a[88:91], v[200:203]
    buffer_load_dwordx4 a[168:171], v24, s[28:31], s57 offen offset:2048 sc1
    v_mfma_f32_16x16x32_bf16 v[200:203], v[44:47], a[96:99], v[200:203]
    ds_read_b128 v[92:95], v25 offset:29696
    v_mfma_f32_16x16x32_bf16 v[200:203], v[172:175], a[104:107], v[200:203]
    ds_read_b128 v[40:43], v25 offset:30720
    v_mfma_f32_16x16x32_bf16 v[216:219], v[172:175], a[108:111], v[216:219]
    ds_read_b128 v[8:11], v25 offset:31744
    v_mfma_f32_16x16x32_bf16 v[216:219], v[44:47], a[100:103], v[216:219]
    buffer_load_dwordx4 a[172:175], v24, s[28:31], s57 offen offset:3072 sc1
    v_mfma_f32_16x16x32_bf16 v[216:219], v[4:7], a[92:95], v[216:219]
    s_add_u32 s57, s57, 4096
    ds_read_b128 v[20:23], v25 offset:32768
    v_mfma_f32_16x16x32_bf16 v[216:219], v[76:79], a[84:87], v[216:219]
    v_mfma_f32_16x16x32_bf16 v[216:219], v[72:75], a[76:79], v[216:219]
    v_mfma_f32_16x16x32_bf16 v[216:219], v[68:71], a[68:71], v[216:219]
    buffer_load_dwordx4 a[176:179], v24, s[28:31], s57 offen offset:0 sc1
    v_mfma_f32_16x16x32_bf16 v[216:219], v[64:67], a[60:63], v[216:219]
    s_waitcnt lgkmcnt(0)
    v_mfma_f32_16x16x32_bf16 v[164:167], v[80:83], a[56:59], v[164:167]
    ds_read_b128 v[64:67], v25 offset:33792
    v_mfma_f32_16x16x32_bf16 v[164:167], v[84:87], a[64:67], v[164:167]
    ds_read_b128 v[68:71], v25 offset:34816
    v_mfma_f32_16x16x32_bf16 v[164:167], v[88:91], a[72:75], v[164:167]
    buffer_load_dwordx4 a[180:183], v24, s[28:31], s57 offen offset:1024 sc1
    v_mfma_f32_16x16x32_bf16 v[164:167], v[92:95], a[80:83], v[164:167]
    ds_read_b128 v[72:75], v25 offset:35840
    v_mfma_f32_16x16x32_bf16 v[164:167], v[40:43], a[88:91], v[164:167]
ffn_c_h6:
    s_cbranch_execz ffn_c_h6_1
    ds_read_b128 v[76:79], v25 offset:36864
    v_mfma_f32_16x16x32_bf16 v[164:167], v[8:11], a[96:99], v[164:167]
    ds_read_b128 v[4:7], v25 offset:37888
    v_mfma_f32_16x16x32_bf16 v[164:167], v[20:23], a[104:107], v[164:167]
    buffer_load_dwordx4 a[184:187], v24, s[28:31], s57 offen offset:2048 sc1
    v_mfma_f32_16x16x32_bf16 v[180:183], v[20:23], a[108:111], v[180:183]
    ds_read_b128 v[44:47], v25 offset:38912
    v_mfma_f32_16x16x32_bf16 v[180:183], v[8:11], a[100:103], v[180:183]
    ds_read_b128 v[172:175], v25 offset:39936
    v_mfma_f32_16x16x32_bf16 v[180:183], v[40:43], a[92:95], v[180:183]
    v_mfma_f32_16x16x32_bf16 v[180:183], v[92:95], a[84:87], v[180:183]
    buffer_load_dwordx4 a[188:191], v24, s[28:31], s57 offen offset:3072 sc1
    v_mfma_f32_16x16x32_bf16 v[180:183], v[88:91], a[76:79], v[180:183]
    s_add_u32 s57, s57, 4096
    v_mfma_f32_16x16x32_bf16 v[180:183], v[84:87], a[68:71], v[180:183]
    v_mfma_f32_16x16x32_bf16 v[180:183], v[80:83], a[60:63], v[180:183]
    s_waitcnt lgkmcnt(0)
    v_mfma_f32_16x16x32_bf16 v[196:199], v[64:67], a[56:59], v[196:199]
    buffer_load_dwordx4 a[192:195], v24, s[28:31], s57 offen offset:0 sc1
    v_mfma_f32_16x16x32_bf16 v[196:199], v[68:71], a[64:67], v[196:199]
    s_barrier
    ds_read_b128 v[80:83], v25 offset:40960
    v_mfma_f32_16x16x32_bf16 v[196:199], v[72:75], a[72:75], v[196:199]
    ds_read_b128 v[84:87], v25 offset:41984
    ds_read_b128 v[88:91], v25 offset:43008
    v_mfma_f32_16x16x32_bf16 v[196:199], v[76:79], a[80:83], v[196:199]
    s_waitcnt vmcnt(19)
    ds_read_b128 v[92:95], v25 offset:44032
    v_mfma_f32_16x16x32_bf16 v[196:199], v[4:7], a[88:91], v[196:199]
    ds_read_b128 v[40:43], v25 offset:45056
    ds_read_b128 v[8:11], v25 offset:46080
    v_mfma_f32_16x16x32_bf16 v[196:199], v[44:47], a[96:99], v[196:199]
    buffer_store_dword v28, v33, s[28:31], s49 offen sc1
    v_mfma_f32_16x16x32_bf16 v[196:199], v[172:175], a[104:107], v[196:199]
    s_add_u32 s49, s49, 0x4000
    ds_read_b128 v[20:23], v25 offset:47104
    v_mfma_f32_16x16x32_bf16 v[212:215], v[172:175], a[108:111], v[212:215]
    v_mfma_f32_16x16x32_bf16 v[212:215], v[44:47], a[100:103], v[212:215]
    v_mfma_f32_16x16x32_bf16 v[212:215], v[4:7], a[92:95], v[212:215]
    buffer_load_dwordx4 a[196:199], v24, s[28:31], s57 offen offset:1024 sc1
    v_mfma_f32_16x16x32_bf16 v[212:215], v[76:79], a[84:87], v[212:215]
ffn_c_h6_1:
    s_cbranch_execz ffn_c_h6_2
    v_mfma_f32_16x16x32_bf16 v[212:215], v[72:75], a[76:79], v[212:215]
    v_mfma_f32_16x16x32_bf16 v[212:215], v[68:71], a[68:71], v[212:215]
    v_mfma_f32_16x16x32_bf16 v[212:215], v[64:67], a[60:63], v[212:215]
    s_add_u32 m0, s58, 53248
    s_waitcnt lgkmcnt(0)
    v_mfma_f32_16x16x32_bf16 v[160:163], v[80:83], a[56:59], v[160:163]
    buffer_load_dwordx4 v30, s[28:31], m0 offen sc1 lds
    v_mfma_f32_16x16x32_bf16 v[160:163], v[84:87], a[64:67], v[160:163]
    ds_read_b128 v[64:67], v25 offset:48128
    v_mfma_f32_16x16x32_bf16 v[160:163], v[88:91], a[72:75], v[160:163]
    ds_read_b128 v[68:71], v25 offset:49152
    v_mfma_f32_16x16x32_bf16 v[160:163], v[92:95], a[80:83], v[160:163]
    ds_read_b128 v[72:75], v25 offset:50176
    s_add_u32 m0, s58, 57344
    v_mfma_f32_16x16x32_bf16 v[160:163], v[40:43], a[88:91], v[160:163]
    buffer_load_dwordx4 v30, s[28:31], m0 offen sc1 lds
    v_mfma_f32_16x16x32_bf16 v[160:163], v[8:11], a[96:99], v[160:163]
    ds_read_b128 v[76:79], v25 offset:51200
    v_mfma_f32_16x16x32_bf16 v[160:163], v[20:23], a[104:107], v[160:163]
    ds_read_b128 v[4:7], v25 offset:52224
    v_mfma_f32_16x16x32_bf16 v[176:179], v[20:23], a[108:111], v[176:179]
    ds_read_b128 v[44:47], v25 offset:53248
    s_add_u32 m0, s58, 61440
    v_mfma_f32_16x16x32_bf16 v[176:179], v[8:11], a[100:103], v[176:179]
    buffer_load_dwordx4 v30, s[28:31], m0 offen sc1 lds
    v_mfma_f32_16x16x32_bf16 v[176:179], v[40:43], a[92:95], v[176:179]
    ds_read_b128 v[172:175], v25 offset:54272
    v_mfma_f32_16x16x32_bf16 v[176:179], v[92:95], a[84:87], v[176:179]
    v_mfma_f32_16x16x32_bf16 v[176:179], v[88:91], a[76:79], v[176:179]
    s_add_u32 m0, s58, 65536
    v_mfma_f32_16x16x32_bf16 v[176:179], v[84:87], a[68:71], v[176:179]
    buffer_load_dwordx4 v30, s[28:31], m0 offen sc1 lds
    v_mfma_f32_16x16x32_bf16 v[176:179], v[80:83], a[60:63], v[176:179]
    s_waitcnt lgkmcnt(0)
    v_mfma_f32_16x16x32_bf16 v[192:195], v[64:67], a[56:59], v[192:195]
    ds_read_b128 v[80:83], v25 offset:55296
    v_mfma_f32_16x16x32_bf16 v[192:195], v[68:71], a[64:67], v[192:195]
    ds_read_b128 v[84:87], v25 offset:56320
    s_add_u32 m0, s58, 69632
    v_mfma_f32_16x16x32_bf16 v[192:195], v[72:75], a[72:75], v[192:195]
    buffer_load_dwordx4 v30, s[28:31], m0 offen sc1 lds
ffn_c_h6_2:
    s_cbranch_execz ffn_c_ret
    v_mfma_f32_16x16x32_bf16 v[192:195], v[76:79], a[80:83], v[192:195]
    ds_read_b128 v[88:91], v26 offset:0
    v_mfma_f32_16x16x32_bf16 v[192:195], v[4:7], a[88:91], v[192:195]
    ds_read_b128 v[92:95], v26 offset:1024
    v_mfma_f32_16x16x32_bf16 v[192:195], v[44:47], a[96:99], v[192:195]
    ds_read_b128 v[40:43], v26 offset:2048
    s_add_u32 m0, s58, 73728
    v_mfma_f32_16x16x32_bf16 v[192:195], v[172:175], a[104:107], v[192:195]
    buffer_load_dwordx4 v30, s[28:31], m0 offen sc1 lds
    v_mfma_f32_16x16x32_bf16 v[208:211], v[172:175], a[108:111], v[208:211]
    ds_read_b128 v[8:11], v26 offset:3072
    v_mfma_f32_16x16x32_bf16 v[208:211], v[44:47], a[100:103], v[208:211]
    v_mfma_f32_16x16x32_bf16 v[208:211], v[4:7], a[92:95], v[208:211]
    s_add_u32 m0, s58, 77824
    v_mfma_f32_16x16x32_bf16 v[208:211], v[76:79], a[84:87], v[208:211]
    buffer_load_dwordx4 v30, s[28:31], m0 offen sc1 lds
    v_mfma_f32_16x16x32_bf16 v[208:211], v[72:75], a[76:79], v[208:211]
    v_mfma_f32_16x16x32_bf16 v[208:211], v[68:71], a[68:71], v[208:211]
    v_mfma_f32_16x16x32_bf16 v[208:211], v[64:67], a[60:63], v[208:211]
    s_waitcnt lgkmcnt(0)
    v_mfma_f32_16x16x32_bf16 v[204:207], v[80:83], a[112:115], v[204:207]
    buffer_load_dwordx4 a[200:203], v24, s[28:31], s57 offen offset:2048 sc1
    v_mfma_f32_16x16x32_bf16 v[204:207], v[84:87], a[120:123], v[204:207]
    ds_read_b128 v[64:67], v26 offset:4096
    v_mfma_f32_16x16x32_bf16 v[204:207], v[88:91], a[128:131], v[204:207]
    ds_read_b128 v[68:71], v26 offset:5120
    v_mfma_f32_16x16x32_bf16 v[204:207], v[92:95], a[136:139], v[204:207]
    ds_read_b128 v[72:75], v26 offset:6144
    v_mfma_f32_16x16x32_bf16 v[204:207], v[40:43], a[144:147], v[204:207]
    buffer_load_dwordx4 a[204:207], v24, s[28:31], s57 offen offset:3072 sc1
    v_mfma_f32_16x16x32_bf16 v[204:207], v[8:11], a[152:155], v[204:207]
    s_add_u32 s57, s57, 4096
    ds_read_b128 v[76:79], v26 offset:7168
    v_mfma_f32_16x16x32_bf16 v[220:223], v[8:11], a[156:159], v[220:223]
    ds_read_b128 v[4:7], v26 offset:8192
    v_mfma_f32_16x16x32_bf16 v[220:223], v[40:43], a[148:151], v[220:223]
    ds_read_b128 v[44:47], v26 offset:9216
    v_mfma_f32_16x16x32_bf16 v[220:223], v[92:95], a[140:143], v[220:223]
    buffer_load_dwordx4 a[208:211], v24, s[28:31], s57 offen offset:0 sc1
    v_mfma_f32_16x16x32_bf16 v[220:223], v[88:91], a[132:135], v[220:223]
    v_mfma_f32_16x16x32_bf16 v[220:223], v[84:87], a[124:127], v[220:223]
    v_mfma_f32_16x16x32_bf16 v[220:223], v[80:83], a[116:119], v[220:223]
    s_waitcnt lgkmcnt(0)
    v_mfma_f32_16x16x32_bf16 v[168:171], v[64:67], a[112:115], v[168:171]
    buffer_load_dwordx4 a[212:215], v24, s[28:31], s57 offen offset:1024 sc1
    v_mfma_f32_16x16x32_bf16 v[168:171], v[68:71], a[120:123], v[168:171]
    ds_read_b128 v[80:83], v26 offset:10240
    v_mfma_f32_16x16x32_bf16 v[168:171], v[72:75], a[128:131], v[168:171]
    ds_read_b128 v[84:87], v26 offset:11264
    v_mfma_f32_16x16x32_bf16 v[168:171], v[76:79], a[136:139], v[168:171]
    ds_read_b128 v[88:91], v26 offset:12288
    v_mfma_f32_16x16x32_bf16 v[168:171], v[4:7], a[144:147], v[168:171]
    buffer_load_dwordx4 a[216:219], v24, s[28:31], s57 offen offset:2048 sc1
    v_mfma_f32_16x16x32_bf16 v[168:171], v[44:47], a[152:155], v[168:171]
    ds_read_b128 v[92:95], v26 offset:13312
    v_mfma_f32_16x16x32_bf16 v[184:187], v[44:47], a[156:159], v[184:187]
    ds_read_b128 v[40:43], v26 offset:14336
    v_mfma_f32_16x16x32_bf16 v[184:187], v[4:7], a[148:151], v[184:187]
    ds_read_b128 v[8:11], v26 offset:15360
    v_mfma_f32_16x16x32_bf16 v[184:187], v[76:79], a[140:143], v[184:187]
    buffer_load_dwordx4 a[220:223], v24, s[28:31], s57 offen offset:3072 sc1
    v_mfma_f32_16x16x32_bf16 v[184:187], v[72:75], a[132:135], v[184:187]
    s_add_u32 s57, s57, 4096
    v_mfma_f32_16x16x32_bf16 v[184:187], v[68:71], a[124:127], v[184:187]
    v_mfma_f32_16x16x32_bf16 v[184:187], v[64:67], a[116:119], v[184:187]
    s_add_u32 m0, s58, 81920
    s_waitcnt lgkmcnt(0)
    v_mfma_f32_16x16x32_bf16 v[200:203], v[80:83], a[112:115], v[200:203]
    buffer_load_dwordx4 v30, s[28:31], m0 offen sc1 lds
    v_mfma_f32_16x16x32_bf16 v[200:203], v[84:87], a[120:123], v[200:203]
    ds_read_b128 v[64:67], v26 offset:16384
    v_mfma_f32_16x16x32_bf16 v[200:203], v[88:91], a[128:131], v[200:203]
    ds_read_b128 v[68:71], v26 offset:17408
    v_mfma_f32_16x16x32_bf16 v[200:203], v[92:95], a[136:139], v[200:203]
    ds_read_b128 v[72:75], v26 offset:18432
    s_add_u32 s12, s12, 0x4000
    v_mfma_f32_16x16x32_bf16 v[200:203], v[40:43], a[144:147], v[200:203]
    buffer_load_dword v29, v32, s[28:31], s12 offen sc1
    v_mfma_f32_16x16x32_bf16 v[200:203], v[8:11], a[152:155], v[200:203]
    ds_read_b128 v[76:79], v26 offset:19456
    v_mfma_f32_16x16x32_bf16 v[216:219], v[8:11], a[156:159], v[216:219]
    ds_read_b128 v[4:7], v26 offset:20480
    v_mfma_f32_16x16x32_bf16 v[216:219], v[40:43], a[148:151], v[216:219]
    ds_read_b128 v[44:47], v26 offset:21504
    s_add_u32 m0, s58, 86016
    v_mfma_f32_16x16x32_bf16 v[216:219], v[92:95], a[140:143], v[216:219]
    buffer_load_dwordx4 v30, s[28:31], m0 offen sc1 lds
    v_mfma_f32_16x16x32_bf16 v[216:219], v[88:91], a[132:135], v[216:219]
    v_mfma_f32_16x16x32_bf16 v[216:219], v[84:87], a[124:127], v[216:219]
    v_mfma_f32_16x16x32_bf16 v[216:219], v[80:83], a[116:119], v[216:219]
    s_add_u32 m0, s58, 90112
    s_waitcnt lgkmcnt(0)
    v_mfma_f32_16x16x32_bf16 v[164:167], v[64:67], a[112:115], v[164:167]
    buffer_load_dwordx4 v30, s[28:31], m0 offen sc1 lds
    v_mfma_f32_16x16x32_bf16 v[164:167], v[68:71], a[120:123], v[164:167]
    ds_read_b128 v[80:83], v26 offset:22528
    v_mfma_f32_16x16x32_bf16 v[164:167], v[72:75], a[128:131], v[164:167]
    ds_read_b128 v[84:87], v26 offset:23552
    v_mfma_f32_16x16x32_bf16 v[164:167], v[76:79], a[136:139], v[164:167]
    ds_read_b128 v[88:91], v26 offset:24576
    s_add_u32 m0, s58, 94208
    v_mfma_f32_16x16x32_bf16 v[164:167], v[4:7], a[144:147], v[164:167]
    buffer_load_dwordx4 v30, s[28:31], m0 offen sc1 lds
    v_mfma_f32_16x16x32_bf16 v[164:167], v[44:47], a[152:155], v[164:167]
    ds_read_b128 v[92:95], v26 offset:25600
    v_mfma_f32_16x16x32_bf16 v[180:183], v[44:47], a[156:159], v[180:183]
    ds_read_b128 v[40:43], v26 offset:26624
    v_mfma_f32_16x16x32_bf16 v[180:183], v[4:7], a[148:151], v[180:183]
    ds_read_b128 v[8:11], v26 offset:27648
    v_mfma_f32_16x16x32_bf16 v[180:183], v[76:79], a[140:143], v[180:183]
    v_mfma_f32_16x16x32_bf16 v[180:183], v[72:75], a[132:135], v[180:183]
    v_mfma_f32_16x16x32_bf16 v[180:183], v[68:71], a[124:127], v[180:183]
    v_mfma_f32_16x16x32_bf16 v[180:183], v[64:67], a[116:119], v[180:183]
    s_waitcnt lgkmcnt(0)
    v_mfma_f32_16x16x32_bf16 v[196:199], v[80:83], a[112:115], v[196:199]
    s_waitcnt vmcnt(32)
    s_barrier
    v_mfma_f32_16x16x32_bf16 v[196:199], v[84:87], a[120:123], v[196:199]
    ds_read_b128 v[64:67], v26 offset:28672
    s_add_u32 m0, s58, 98304
    v_mfma_f32_16x16x32_bf16 v[196:199], v[88:91], a[128:131], v[196:199]
    buffer_load_dwordx4 v30, s[28:31], m0 offen sc1 lds
    v_mfma_f32_16x16x32_bf16 v[196:199], v[92:95], a[136:139], v[196:199]
    ds_read_b128 v[68:71], v26 offset:29696
    ds_read_b128 v[72:75], v26 offset:30720
    v_mfma_f32_16x16x32_bf16 v[196:199], v[40:43], a[144:147], v[196:199]
    ds_read_b128 v[76:79], v26 offset:31744
    ds_read_b128 v[4:7], v26 offset:32768
    v_mfma_f32_16x16x32_bf16 v[196:199], v[8:11], a[152:155], v[196:199]
    ds_read_b128 v[44:47], v26 offset:33792
    s_add_u32 m0, s58, 102400
    v_mfma_f32_16x16x32_bf16 v[212:215], v[8:11], a[156:159], v[212:215]
    buffer_load_dwordx4 v30, s[28:31], m0 offen sc1 lds
    v_mfma_f32_16x16x32_bf16 v[212:215], v[40:43], a[148:151], v[212:215]
    v_mfma_f32_16x16x32_bf16 v[212:215], v[92:95], a[140:143], v[212:215]
    v_mfma_f32_16x16x32_bf16 v[212:215], v[88:91], a[132:135], v[212:215]
    s_add_u32 m0, s58, 106496
    v_mfma_f32_16x16x32_bf16 v[212:215], v[84:87], a[124:127], v[212:215]
    buffer_load_dwordx4 v30, s[28:31], m0 offen sc1 lds
    v_mfma_f32_16x16x32_bf16 v[212:215], v[80:83], a[116:119], v[212:215]
    s_waitcnt lgkmcnt(0)
    v_mfma_f32_16x16x32_bf16 v[160:163], v[64:67], a[112:115], v[160:163]
    ds_read_b128 v[80:83], v26 offset:34816
    v_mfma_f32_16x16x32_bf16 v[160:163], v[68:71], a[120:123], v[160:163]
    ds_read_b128 v[84:87], v26 offset:35840
    s_add_u32 m0, s58, 110592
    v_mfma_f32_16x16x32_bf16 v[160:163], v[72:75], a[128:131], v[160:163]
    buffer_load_dwordx4 v30, s[28:31], m0 offen sc1 lds
    v_mfma_f32_16x16x32_bf16 v[160:163], v[76:79], a[136:139], v[160:163]
    ds_read_b128 v[88:91], v26 offset:36864
    v_mfma_f32_16x16x32_bf16 v[160:163], v[4:7], a[144:147], v[160:163]
    ds_read_b128 v[92:95], v26 offset:37888
    v_mfma_f32_16x16x32_bf16 v[160:163], v[44:47], a[152:155], v[160:163]
    ds_read_b128 v[40:43], v26 offset:38912
    s_add_u32 m0, s58, 114688
    v_mfma_f32_16x16x32_bf16 v[176:179], v[44:47], a[156:159], v[176:179]
    buffer_load_dwordx4 v30, s[28:31], m0 offen sc1 lds
    v_mfma_f32_16x16x32_bf16 v[176:179], v[4:7], a[148:151], v[176:179]
    ds_read_b128 v[8:11], v26 offset:39936
    v_mfma_f32_16x16x32_bf16 v[176:179], v[76:79], a[140:143], v[176:179]
    v_mfma_f32_16x16x32_bf16 v[176:179], v[72:75], a[132:135], v[176:179]
    s_add_u32 m0, s58, 118784
    v_mfma_f32_16x16x32_bf16 v[176:179], v[68:71], a[124:127], v[176:179]
    buffer_load_dwordx4 v30, s[28:31], m0 offen sc1 lds
    v_mfma_f32_16x16x32_bf16 v[176:179], v[64:67], a[116:119], v[176:179]
    s_waitcnt lgkmcnt(0)
    v_mfma_f32_16x16x32_bf16 v[192:195], v[80:83], a[112:115], v[192:195]
    ds_read_b128 v[64:67], v26 offset:40960
    v_mfma_f32_16x16x32_bf16 v[192:195], v[84:87], a[120:123], v[192:195]
    ds_read_b128 v[68:71], v26 offset:41984
    s_add_u32 m0, s58, 122880
    v_mfma_f32_16x16x32_bf16 v[192:195], v[88:91], a[128:131], v[192:195]
    buffer_load_dwordx4 v30, s[28:31], m0 offen sc1 lds
    v_mfma_f32_16x16x32_bf16 v[192:195], v[92:95], a[136:139], v[192:195]
    ds_read_b128 v[72:75], v26 offset:43008
    v_mfma_f32_16x16x32_bf16 v[192:195], v[40:43], a[144:147], v[192:195]
    ds_read_b128 v[76:79], v26 offset:44032
    v_mfma_f32_16x16x32_bf16 v[192:195], v[8:11], a[152:155], v[192:195]
    ds_read_b128 v[4:7], v24 offset:12288
    s_add_u32 m0, s58, 126976
    v_mfma_f32_16x16x32_bf16 v[208:211], v[8:11], a[156:159], v[208:211]
    buffer_load_dwordx4 v30, s[28:31], m0 offen sc1 lds
    v_mfma_f32_16x16x32_bf16 v[208:211], v[40:43], a[148:151], v[208:211]
    v_mfma_f32_16x16x32_bf16 v[208:211], v[92:95], a[140:143], v[208:211]
    v_mfma_f32_16x16x32_bf16 v[208:211], v[88:91], a[132:135], v[208:211]
    s_add_u32 m0, s58, 131072
    v_mfma_f32_16x16x32_bf16 v[208:211], v[84:87], a[124:127], v[208:211]
    buffer_load_dwordx4 v30, s[28:31], m0 offen sc1 lds
    v_mfma_f32_16x16x32_bf16 v[208:211], v[80:83], a[116:119], v[208:211]
    s_waitcnt vmcnt(27)
    s_waitcnt lgkmcnt(0)
    v_mfma_f32_16x16x32_bf16 v[204:207], v[64:67], a[160:163], v[204:207]
    s_waitcnt vmcnt(12)
    v_cmp_ne_u32 vcc, s96, v29
    v_mfma_f32_16x16x32_bf16 v[204:207], v[68:71], a[168:171], v[204:207]
    s_cbranch_vccnz ffn_slow5
ffn_back5:
    ds_read_b128 v[80:83], v24 offset:13312
    v_mfma_f32_16x16x32_bf16 v[204:207], v[72:75], a[176:179], v[204:207]
    buffer_load_dwordx4 a[224:227], v24, s[28:31], s57 offen offset:0 sc1
    v_mfma_f32_16x16x32_bf16 v[204:207], v[76:79], a[184:187], v[204:207]
    ds_read_b128 v[84:87], v24 offset:14336
    ds_read_b128 v[88:91], v24 offset:15360
    v_mfma_f32_16x16x32_bf16 v[204:207], v[4:7], a[192:195], v[204:207]
    ds_read_b128 v[92:95], v24 offset:16384
    ds_read_b128 v[40:43], v24 offset:17408
    v_mfma_f32_16x16x32_bf16 v[220:223], v[4:7], a[196:199], v[220:223]
    v_mfma_f32_16x16x32_bf16 v[220:223], v[76:79], a[188:191], v[220:223]
    buffer_load_dwordx4 a[228:231], v24, s[28:31], s57 offen offset:1024 sc1
    v_mfma_f32_16x16x32_bf16 v[220:223], v[72:75], a[180:183], v[220:223]
    v_mfma_f32_16x16x32_bf16 v[220:223], v[68:71], a[172:175], v[220:223]
    v_mfma_f32_16x16x32_bf16 v[220:223], v[64:67], a[164:167], v[220:223]
    s_waitcnt lgkmcnt(0)
    v_mfma_f32_16x16x32_bf16 v[168:171], v[80:83], a[160:163], v[168:171]
    buffer_load_dwordx4 a[232:235], v24, s[28:31], s57 offen offset:2048 sc1
    v_mfma_f32_16x16x32_bf16 v[168:171], v[84:87], a[168:171], v[168:171]
    ds_read_b128 v[64:67], v24 offset:18432
    ds_read_b128 v[68:71], v24 offset:19456
    v_mfma_f32_16x16x32_bf16 v[168:171], v[88:91], a[176:179], v[168:171]
    ds_read_b128 v[72:75], v24 offset:20480
    ds_read_b128 v[76:79], v24 offset:21504
    v_mfma_f32_16x16x32_bf16 v[168:171], v[92:95], a[184:187], v[168:171]
    ds_read_b128 v[4:7], v24 offset:22528
    v_mfma_f32_16x16x32_bf16 v[168:171], v[40:43], a[192:195], v[168:171]
    buffer_load_dwordx4 a[236:239], v24, s[28:31], s57 offen offset:3072 sc1
    v_mfma_f32_16x16x32_bf16 v[184:187], v[40:43], a[196:199], v[184:187]
    s_add_u32 s57, s57, 4096
    v_mfma_f32_16x16x32_bf16 v[184:187], v[92:95], a[188:191], v[184:187]
    v_mfma_f32_16x16x32_bf16 v[184:187], v[88:91], a[180:183], v[184:187]
    v_mfma_f32_16x16x32_bf16 v[184:187], v[84:87], a[172:175], v[184:187]
    buffer_load_dwordx4 a[240:243], v24, s[28:31], s57 offen offset:0 sc1
    v_mfma_f32_16x16x32_bf16 v[184:187], v[80:83], a[164:167], v[184:187]
    s_waitcnt lgkmcnt(0)
    v_mfma_f32_16x16x32_bf16 v[200:203], v[64:67], a[160:163], v[200:203]
    ds_read_b128 v[80:83], v24 offset:23552
    ds_read_b128 v[84:87], v24 offset:24576
    v_mfma_f32_16x16x32_bf16 v[200:203], v[68:71], a[168:171], v[200:203]
    ds_read_b128 v[88:91], v24 offset:25600
    ds_read_b128 v[92:95], v24 offset:26624
    v_mfma_f32_16x16x32_bf16 v[200:203], v[72:75], a[176:179], v[200:203]
    buffer_load_dwordx4 a[244:247], v24, s[28:31], s57 offen offset:1024 sc1
    v_mfma_f32_16x16x32_bf16 v[200:203], v[76:79], a[184:187], v[200:203]
    ds_read_b128 v[40:43], v24 offset:27648
    v_mfma_f32_16x16x32_bf16 v[200:203], v[4:7], a[192:195], v[200:203]
    v_mfma_f32_16x16x32_bf16 v[216:219], v[4:7], a[196:199], v[216:219]
    v_mfma_f32_16x16x32_bf16 v[216:219], v[76:79], a[188:191], v[216:219]
    buffer_load_dwordx4 a[248:251], v24, s[28:31], s57 offen offset:2048 sc1
    v_mfma_f32_16x16x32_bf16 v[216:219], v[72:75], a[180:183], v[216:219]
    v_mfma_f32_16x16x32_bf16 v[216:219], v[68:71], a[172:175], v[216:219]
    v_mfma_f32_16x16x32_bf16 v[216:219], v[64:67], a[164:167], v[216:219]
    s_waitcnt lgkmcnt(0)
    v_mfma_f32_16x16x32_bf16 v[164:167], v[80:83], a[160:163], v[164:167]
    buffer_load_dwordx4 a[252:255], v24, s[28:31], s57 offen offset:3072 sc1
    v_mfma_f32_16x16x32_bf16 v[164:167], v[84:87], a[168:171], v[164:167]
    s_add_u32 s57, s57, 4096
    ds_read_b128 v[64:67], v24 offset:28672
    v_mfma_f32_16x16x32_bf16 v[164:167], v[88:91], a[176:179], v[164:167]
    ds_read_b128 v[68:71], v24 offset:29696
    ds_read_b128 v[72:75], v24 offset:30720
    v_mfma_f32_16x16x32_bf16 v[164:167], v[92:95], a[184:187], v[164:167]
    ds_read_b128 v[76:79], v24 offset:31744
    ds_read_b128 v[4:7], v24 offset:32768
    v_mfma_f32_16x16x32_bf16 v[164:167], v[40:43], a[192:195], v[164:167]
    buffer_load_dwordx4 v[224:227], v24, s[28:31], s57 offen offset:0 sc1
    v_mfma_f32_16x16x32_bf16 v[180:183], v[40:43], a[196:199], v[180:183]
    ds_read_b64_tr_b16 v[112:113], v3 offset:0
    ds_read_b64_tr_b16 v[114:115], v3 offset:32
    v_mfma_f32_16x16x32_bf16 v[180:183], v[92:95], a[188:191], v[180:183]
    ds_read_b64_tr_b16 v[116:117], v3 offset:1024
    ds_read_b64_tr_b16 v[118:119], v3 offset:1056
    v_mfma_f32_16x16x32_bf16 v[180:183], v[88:91], a[180:183], v[180:183]
    ds_read_b64_tr_b16 v[120:121], v3 offset:2048
    ds_read_b64_tr_b16 v[122:123], v3 offset:2080
    v_mfma_f32_16x16x32_bf16 v[180:183], v[84:87], a[172:175], v[180:183]
    buffer_load_dwordx4 v[228:231], v24, s[28:31], s57 offen offset:1024 sc1
    v_mfma_f32_16x16x32_bf16 v[180:183], v[80:83], a[164:167], v[180:183]
    s_waitcnt lgkmcnt(6)
    v_mfma_f32_16x16x32_bf16 v[196:199], v[64:67], a[160:163], v[196:199]
    ds_read_b128 v[80:83], v24 offset:33792
    ds_read_b128 v[84:87], v24 offset:34816
    v_mfma_f32_16x16x32_bf16 v[196:199], v[68:71], a[168:171], v[196:199]
    ds_read_b128 v[88:91], v24 offset:35840
    ds_read_b128 v[92:95], v24 offset:36864
    v_mfma_f32_16x16x32_bf16 v[196:199], v[72:75], a[176:179], v[196:199]
    buffer_load_dwordx4 v[232:235], v24, s[28:31], s57 offen offset:2048 sc1
    v_mfma_f32_16x16x32_bf16 v[196:199], v[76:79], a[184:187], v[196:199]
    ds_read_b128 v[40:43], v24 offset:37888
    v_mfma_f32_16x16x32_bf16 v[196:199], v[4:7], a[192:195], v[196:199]
    v_mfma_f32_16x16x32_bf16 v[212:215], v[4:7], a[196:199], v[212:215]
    v_mfma_f32_16x16x32_bf16 v[212:215], v[76:79], a[188:191], v[212:215]
    buffer_load_dwordx4 v[236:239], v24, s[28:31], s57 offen offset:3072 sc1
    v_mfma_f32_16x16x32_bf16 v[212:215], v[72:75], a[180:183], v[212:215]
    s_add_u32 s57, s57, 4096
    s_waitcnt lgkmcnt(5)
    v_mfma_f32_16x16x32_bf16 v[212:215], v[68:71], a[172:175], v[212:215]
    v_lshlrev_b32 v124, 16, v112
    v_and_b32 v125, 0xffff0000, v112
    v_mfma_f32_16x16x32_bf16 v[212:215], v[64:67], a[164:167], v[212:215]
    v_lshlrev_b32 v126, 16, v113
    s_waitcnt lgkmcnt(0)
    v_mfma_f32_16x16x32_bf16 v[160:163], v[80:83], a[160:163], v[160:163]
    buffer_load_dwordx4 v[240:243], v24, s[28:31], s57 offen offset:0 sc1
    v_mfma_f32_16x16x32_bf16 v[160:163], v[84:87], a[168:171], v[160:163]
    s_barrier
    ds_read_b128 v[64:67], v24 offset:38912
    v_mfma_f32_16x16x32_bf16 v[160:163], v[88:91], a[176:179], v[160:163]
    ds_read_b128 v[68:71], v24 offset:39936
    ds_read_b128 v[72:75], v24 offset:40960
    v_mfma_f32_16x16x32_bf16 v[160:163], v[92:95], a[184:187], v[160:163]
    ds_read_b128 v[76:79], v24 offset:41984
    ds_read_b128 v[4:7], v24 offset:43008
    v_mfma_f32_16x16x32_bf16 v[160:163], v[40:43], a[192:195], v[160:163]
    buffer_load_dwordx4 v[244:247], v24, s[28:31], s57 offen offset:1024 sc1
    v_mfma_f32_16x16x32_bf16 v[176:179], v[40:43], a[196:199], v[176:179]
    v_and_b32 v127, 0xffff0000, v113
    v_lshlrev_b32 v128, 16, v114
    v_mfma_f32_16x16x32_bf16 v[176:179], v[92:95], a[188:191], v[176:179]
    v_and_b32 v129, 0xffff0000, v114
    v_lshlrev_b32 v130, 16, v115
    v_mfma_f32_16x16x32_bf16 v[176:179], v[88:91], a[180:183], v[176:179]
    v_and_b32 v131, 0xffff0000, v115
    v_lshlrev_b32 v132, 16, v116
    v_mfma_f32_16x16x32_bf16 v[176:179], v[84:87], a[172:175], v[176:179]
    buffer_load_dwordx4 v[248:251], v24, s[28:31], s57 offen offset:2048 sc1
    v_mfma_f32_16x16x32_bf16 v[176:179], v[80:83], a[164:167], v[176:179]
    v_and_b32 v133, 0xffff0000, v116
    s_waitcnt lgkmcnt(0)
    v_mfma_f32_16x16x32_bf16 v[192:195], v[64:67], a[160:163], v[192:195]
    ds_read_b128 v[80:83], v24 offset:44032
    ds_read_b128 v[84:87], v24 offset:45056
    v_mfma_f32_16x16x32_bf16 v[192:195], v[68:71], a[168:171], v[192:195]
    ds_read_b128 v[88:91], v24 offset:46080
    ds_read_b128 v[92:95], v24 offset:47104
    v_mfma_f32_16x16x32_bf16 v[192:195], v[72:75], a[176:179], v[192:195]
    buffer_load_dwordx4 v[252:255], v24, s[28:31], s57 offen offset:3072 sc1
    v_mfma_f32_16x16x32_bf16 v[192:195], v[76:79], a[184:187], v[192:195]
    s_add_u32 s57, s57, 4096
    ds_read_b128 v[40:43], v24 offset:48128
    v_mfma_f32_16x16x32_bf16 v[192:195], v[4:7], a[192:195], v[192:195]
    v_lshlrev_b32 v134, 16, v117
    v_and_b32 v135, 0xffff0000, v117
    v_mfma_f32_16x16x32_bf16 v[208:211], v[4:7], a[196:199], v[208:211]
    v_lshlrev_b32 v136, 16, v118
    s_add_u32 m0, s58, 135168
    v_mfma_f32_16x16x32_bf16 v[208:211], v[76:79], a[188:191], v[208:211]
    buffer_load_dwordx4 v30, s[28:31], m0 offen sc1 lds
    v_mfma_f32_16x16x32_bf16 v[208:211], v[72:75], a[180:183], v[208:211]
    v_and_b32 v137, 0xffff0000, v118
    v_lshlrev_b32 v138, 16, v119
    v_mfma_f32_16x16x32_bf16 v[208:211], v[68:71], a[172:175], v[208:211]
    v_and_b32 v139, 0xffff0000, v119
    v_lshlrev_b32 v140, 16, v120
    v_mfma_f32_16x16x32_bf16 v[208:211], v[64:67], a[164:167], v[208:211]
    s_add_u32 m0, s58, 139264
    s_waitcnt vmcnt(13)
    s_waitcnt lgkmcnt(0)
    v_mfma_f32_16x16x32_bf16 v[204:207], v[80:83], a[200:203], v[204:207]
    buffer_load_dwordx4 v30, s[28:31], m0 offen sc1 lds
    v_mfma_f32_16x16x32_bf16 v[204:207], v[84:87], a[208:211], v[204:207]
    ds_read_b128 v[64:67], v24 offset:49152
    ds_read_b128 v[68:71], v24 offset:50176
    v_mfma_f32_16x16x32_bf16 v[204:207], v[88:91], a[216:219], v[204:207]
    ds_read_b128 v[72:75], v24 offset:51200
    ds_read_b128 v[76:79], v24 offset:52224
    v_mfma_f32_16x16x32_bf16 v[204:207], v[92:95], a[224:227], v[204:207]
    ds_read_b128 v[4:7], v24 offset:53248
    s_add_u32 m0, s58, 143360
    v_mfma_f32_16x16x32_bf16 v[204:207], v[40:43], a[232:235], v[204:207]
    buffer_load_dwordx4 v30, s[28:31], m0 offen sc1 lds
    v_mfma_f32_16x16x32_bf16 v[220:223], v[40:43], a[236:239], v[220:223]
    v_and_b32 v141, 0xffff0000, v120
    v_lshlrev_b32 v142, 16, v121
    v_mfma_f32_16x16x32_bf16 v[220:223], v[92:95], a[228:231], v[220:223]
    v_and_b32 v143, 0xffff0000, v121
    v_lshlrev_b32 v144, 16, v122
    v_mfma_f32_16x16x32_bf16 v[220:223], v[88:91], a[220:223], v[220:223]
    v_and_b32 v145, 0xffff0000, v122
    s_add_u32 m0, s58, 147456
    v_mfma_f32_16x16x32_bf16 v[220:223], v[84:87], a[212:215], v[220:223]
    buffer_load_dwordx4 v30, s[28:31], m0 offen sc1 lds
    v_mfma_f32_16x16x32_bf16 v[220:223], v[80:83], a[204:207], v[220:223]
    v_lshlrev_b32 v146, 16, v123
    s_waitcnt lgkmcnt(0)
    v_mfma_f32_16x16x32_bf16 v[168:171], v[64:67], a[200:203], v[168:171]
    ds_read_b128 v[80:83], v24 offset:54272
    ds_read_b128 v[84:87], v24 offset:55296
    v_mfma_f32_16x16x32_bf16 v[168:171], v[68:71], a[208:211], v[168:171]
    ds_read_b128 v[88:91], v24 offset:56320
    s_add_u32 m0, s58, 151552
    v_mfma_f32_16x16x32_bf16 v[168:171], v[72:75], a[216:219], v[168:171]
    buffer_load_dwordx4 v30, s[28:31], m0 offen sc1 lds
    v_mfma_f32_16x16x32_bf16 v[168:171], v[76:79], a[224:227], v[168:171]
    ds_read_b128 v[92:95], v25 offset:0
    ds_read_b128 v[40:43], v25 offset:1024
    v_mfma_f32_16x16x32_bf16 v[168:171], v[4:7], a[232:235], v[168:171]
    v_and_b32 v147, 0xffff0000, v123
    v_mfma_f32_16x16x32_bf16 v[184:187], v[4:7], a[236:239], v[184:187]
    s_add_u32 m0, s58, 155648
    v_mfma_f32_16x16x32_bf16 v[184:187], v[76:79], a[228:231], v[184:187]
    buffer_load_dwordx4 v30, s[28:31], m0 offen sc1 lds
    v_mfma_f32_16x16x32_bf16 v[184:187], v[72:75], a[220:223], v[184:187]
    v_add_u32 v30, 147456, v30
    v_mfma_f32_16x16x32_bf16 v[184:187], v[68:71], a[212:215], v[184:187]
    v_mfma_f32_16x16x32_bf16 v[184:187], v[64:67], a[204:207], v[184:187]
    s_add_u32 m0, s58, 12288
    s_waitcnt lgkmcnt(0)
    v_mfma_f32_16x16x32_bf16 v[200:203], v[80:83], a[200:203], v[200:203]
    buffer_load_dwordx4 v30, s[28:31], m0 offen sc1 lds
    v_mfma_f32_16x16x32_bf16 v[200:203], v[84:87], a[208:211], v[200:203]
    ds_read_b128 v[64:67], v25 offset:2048
    ds_read_b128 v[68:71], v25 offset:3072
    v_mfma_f32_16x16x32_bf16 v[200:203], v[88:91], a[216:219], v[200:203]
    ds_read_b128 v[72:75], v25 offset:4096
    ds_read_b128 v[76:79], v25 offset:5120
    v_mfma_f32_16x16x32_bf16 v[200:203], v[92:95], a[224:227], v[200:203]
    ds_read_b128 v[4:7], v25 offset:6144
    s_add_u32 m0, s58, 16384
    v_mfma_f32_16x16x32_bf16 v[200:203], v[40:43], a[232:235], v[200:203]
    buffer_load_dwordx4 v30, s[28:31], m0 offen sc1 lds
    v_mfma_f32_16x16x32_bf16 v[216:219], v[40:43], a[236:239], v[216:219]
    v_mfma_f32_16x16x32_bf16 v[216:219], v[92:95], a[228:231], v[216:219]
    v_mfma_f32_16x16x32_bf16 v[216:219], v[88:91], a[220:223], v[216:219]
    s_add_u32 m0, s58, 20480
    v_mfma_f32_16x16x32_bf16 v[216:219], v[84:87], a[212:215], v[216:219]
    buffer_load_dwordx4 v30, s[28:31], m0 offen sc1 lds
    v_mfma_f32_16x16x32_bf16 v[216:219], v[80:83], a[204:207], v[216:219]
    s_waitcnt lgkmcnt(0)
    v_mfma_f32_16x16x32_bf16 v[164:167], v[64:67], a[200:203], v[164:167]
    ds_read_b128 v[80:83], v25 offset:7168
    ds_read_b128 v[84:87], v25 offset:8192
    v_mfma_f32_16x16x32_bf16 v[164:167], v[68:71], a[208:211], v[164:167]
    ds_read_b128 v[88:91], v25 offset:9216
    s_add_u32 m0, s58, 24576
    v_mfma_f32_16x16x32_bf16 v[164:167], v[72:75], a[216:219], v[164:167]
    buffer_load_dwordx4 v30, s[28:31], m0 offen sc1 lds
    v_mfma_f32_16x16x32_bf16 v[164:167], v[76:79], a[224:227], v[164:167]
    ds_read_b128 v[92:95], v25 offset:10240
    ds_read_b128 v[40:43], v25 offset:11264
    v_mfma_f32_16x16x32_bf16 v[164:167], v[4:7], a[232:235], v[164:167]
    v_mfma_f32_16x16x32_bf16 v[180:183], v[4:7], a[236:239], v[180:183]
    s_add_u32 m0, s58, 28672
    v_mfma_f32_16x16x32_bf16 v[180:183], v[76:79], a[228:231], v[180:183]
    buffer_load_dwordx4 v30, s[28:31], m0 offen sc1 lds
    v_mfma_f32_16x16x32_bf16 v[180:183], v[72:75], a[220:223], v[180:183]
    v_mfma_f32_16x16x32_bf16 v[180:183], v[68:71], a[212:215], v[180:183]
    v_mfma_f32_16x16x32_bf16 v[180:183], v[64:67], a[204:207], v[180:183]
    s_add_u32 m0, s58, 32768
    s_waitcnt lgkmcnt(0)
    v_mfma_f32_16x16x32_bf16 v[196:199], v[80:83], a[200:203], v[196:199]
    buffer_load_dwordx4 v30, s[28:31], m0 offen sc1 lds
    v_mfma_f32_16x16x32_bf16 v[196:199], v[84:87], a[208:211], v[196:199]
    ds_read_b128 v[64:67], v25 offset:12288
ffn_c_h7:
    s_cbranch_execz ffn_c_h7_1
    ds_read_b128 v[68:71], v25 offset:13312
    v_mfma_f32_16x16x32_bf16 v[196:199], v[88:91], a[216:219], v[196:199]
    ds_read_b128 v[72:75], v25 offset:14336
    ds_read_b128 v[76:79], v25 offset:15360
    v_mfma_f32_16x16x32_bf16 v[196:199], v[92:95], a[224:227], v[196:199]
    ds_read_b128 v[4:7], v25 offset:16384
    v_mfma_f32_16x16x32_bf16 v[196:199], v[40:43], a[232:235], v[196:199]
    v_mfma_f32_16x16x32_bf16 v[212:215], v[40:43], a[236:239], v[212:215]
    v_mfma_f32_16x16x32_bf16 v[212:215], v[92:95], a[228:231], v[212:215]
    v_mfma_f32_16x16x32_bf16 v[212:215], v[88:91], a[220:223], v[212:215]
    v_mfma_f32_16x16x32_bf16 v[212:215], v[84:87], a[212:215], v[212:215]
    v_mfma_f32_16x16x32_bf16 v[212:215], v[80:83], a[204:207], v[212:215]
    s_waitcnt lgkmcnt(0)
    v_mfma_f32_16x16x32_bf16 v[160:163], v[64:67], a[200:203], v[160:163]
    ds_read_b128 v[80:83], v25 offset:17408
    ds_read_b128 v[84:87], v25 offset:18432
    v_mfma_f32_16x16x32_bf16 v[160:163], v[68:71], a[208:211], v[160:163]
    ds_read_b128 v[88:91], v25 offset:19456
    ds_read_b128 v[92:95], v25 offset:20480
    v_mfma_f32_16x16x32_bf16 v[160:163], v[72:75], a[216:219], v[160:163]
    ds_read_b128 v[40:43], v25 offset:21504
    v_mfma_f32_16x16x32_bf16 v[160:163], v[76:79], a[224:227], v[160:163]
    v_mfma_f32_16x16x32_bf16 v[160:163], v[4:7], a[232:235], v[160:163]
    v_mfma_f32_16x16x32_bf16 v[176:179], v[4:7], a[236:239], v[176:179]
    v_mfma_f32_16x16x32_bf16 v[176:179], v[76:79], a[228:231], v[176:179]
    v_mfma_f32_16x16x32_bf16 v[176:179], v[72:75], a[220:223], v[176:179]
    v_mfma_f32_16x16x32_bf16 v[176:179], v[68:71], a[212:215], v[176:179]
    v_mfma_f32_16x16x32_bf16 v[176:179], v[64:67], a[204:207], v[176:179]
    s_waitcnt lgkmcnt(0)
    v_mfma_f32_16x16x32_bf16 v[192:195], v[80:83], a[200:203], v[192:195]
    s_barrier
    s_add_u32 m0, s58, 36864
    v_mfma_f32_16x16x32_bf16 v[192:195], v[84:87], a[208:211], v[192:195]
    buffer_load_dwordx4 v30, s[28:31], m0 offen sc1 lds
    v_mfma_f32_16x16x32_bf16 v[192:195], v[88:91], a[216:219], v[192:195]
    ds_read_b128 v[64:67], v25 offset:22528
    ds_read_b128 v[68:71], v25 offset:23552
    v_mfma_f32_16x16x32_bf16 v[192:195], v[92:95], a[224:227], v[192:195]
    ds_read_b128 v[72:75], v25 offset:24576
    ds_read_b128 v[76:79], v25 offset:25600
    v_mfma_f32_16x16x32_bf16 v[192:195], v[40:43], a[232:235], v[192:195]
ffn_c_h7_1:
    s_cbranch_execz ffn_c_h7_2
    ds_read_b128 v[4:7], v25 offset:26624
    s_add_u32 m0, s58, 40960
    v_mfma_f32_16x16x32_bf16 v[208:211], v[40:43], a[236:239], v[208:211]
    buffer_load_dwordx4 v30, s[28:31], m0 offen sc1 lds
    v_mfma_f32_16x16x32_bf16 v[208:211], v[92:95], a[228:231], v[208:211]
    ds_read_b128 v[44:47], v25 offset:27648
    v_mfma_f32_16x16x32_bf16 v[208:211], v[88:91], a[220:223], v[208:211]
    v_mfma_f32_16x16x32_bf16 v[208:211], v[84:87], a[212:215], v[208:211]
    v_mfma_f32_16x16x32_bf16 v[208:211], v[80:83], a[204:207], v[208:211]
    s_add_u32 m0, s58, 45056
    s_waitcnt vmcnt(14)
    s_waitcnt lgkmcnt(0)
    v_mfma_f32_16x16x32_bf16 v[204:207], v[64:67], a[240:243], v[204:207]
    buffer_load_dwordx4 v30, s[28:31], m0 offen sc1 lds
    v_mfma_f32_16x16x32_bf16 v[204:207], v[68:71], a[248:251], v[204:207]
    ds_read_b128 v[80:83], v25 offset:28672
    v_mfma_f32_16x16x32_bf16 v[204:207], v[72:75], v[224:227], v[204:207]
    ds_read_b128 v[84:87], v25 offset:29696
    v_mfma_f32_16x16x32_bf16 v[204:207], v[76:79], v[232:235], v[204:207]
    ds_read_b128 v[88:91], v25 offset:30720
    v_mfma_f32_16x16x32_bf16 v[204:207], v[4:7], v[240:243], v[204:207]
    ds_read_b128 v[92:95], v25 offset:31744
    v_mfma_f32_16x16x32_bf16 v[204:207], v[44:47], v[248:251], v[204:207]
    ds_read_b128 v[40:43], v25 offset:32768
    v_mfma_f32_16x16x32_bf16 v[220:223], v[44:47], v[252:255], v[220:223]
    ds_read_b128 v[8:11], v25 offset:33792
    v_mfma_f32_16x16x32_bf16 v[220:223], v[4:7], v[244:247], v[220:223]
    v_mfma_f32_16x16x32_bf16 v[220:223], v[76:79], v[236:239], v[220:223]
    v_mfma_f32_16x16x32_bf16 v[220:223], v[72:75], v[228:231], v[220:223]
    v_mfma_f32_16x16x32_bf16 v[220:223], v[68:71], a[252:255], v[220:223]
    v_mfma_f32_16x16x32_bf16 v[220:223], v[64:67], a[244:247], v[220:223]
    s_waitcnt lgkmcnt(0)
    v_mfma_f32_16x16x32_bf16 v[168:171], v[80:83], a[240:243], v[168:171]
    ds_read_b128 v[64:67], v25 offset:34816
    v_mfma_f32_16x16x32_bf16 v[168:171], v[84:87], a[248:251], v[168:171]
    ds_read_b128 v[68:71], v25 offset:35840
    v_mfma_f32_16x16x32_bf16 v[168:171], v[88:91], v[224:227], v[168:171]
    ds_read_b128 v[72:75], v25 offset:36864
    v_mfma_f32_16x16x32_bf16 v[168:171], v[92:95], v[232:235], v[168:171]
    ds_read_b128 v[76:79], v25 offset:37888
    v_mfma_f32_16x16x32_bf16 v[168:171], v[40:43], v[240:243], v[168:171]
ffn_c_h7_2:
    s_cbranch_execz ffn_c_ret
    ds_read_b128 v[4:7], v25 offset:38912
    v_cvt_pk_bf16_f32 v204, v204, v205
    v_mfma_f32_16x16x32_bf16 v[168:171], v[8:11], v[248:251], v[168:171]
    ds_read_b128 v[44:47], v25 offset:39936
    v_cvt_pk_bf16_f32 v205, v206, v207
    v_mfma_f32_16x16x32_bf16 v[184:187], v[8:11], v[252:255], v[184:187]
    v_cvt_pk_bf16_f32 v206, v220, v221
    v_cvt_pk_bf16_f32 v207, v222, v223
    v_mfma_f32_16x16x32_bf16 v[184:187], v[40:43], v[244:247], v[184:187]
    v_mfma_f32_16x16x32_bf16 v[184:187], v[92:95], v[236:239], v[184:187]
    v_mfma_f32_16x16x32_bf16 v[184:187], v[88:91], v[228:231], v[184:187]
    buffer_store_dwordx4 v[204:207], v24, s[28:31], s51 offen offset:0 sc1
    v_mfma_f32_16x16x32_bf16 v[184:187], v[84:87], a[252:255], v[184:187]
    v_mfma_f32_16x16x32_bf16 v[184:187], v[80:83], a[244:247], v[184:187]
    s_waitcnt lgkmcnt(0)
    v_mfma_f32_16x16x32_bf16 v[200:203], v[64:67], a[240:243], v[200:203]
    ds_read_b128 v[80:83], v25 offset:40960
    v_mfma_f32_16x16x32_bf16 v[200:203], v[68:71], a[248:251], v[200:203]
    ds_read_b128 v[84:87], v25 offset:41984
    v_mfma_f32_16x16x32_bf16 v[200:203], v[72:75], v[224:227], v[200:203]
    ds_read_b128 v[88:91], v25 offset:43008
    v_mfma_f32_16x16x32_bf16 v[200:203], v[76:79], v[232:235], v[200:203]
    ds_read_b128 v[92:95], v25 offset:44032
    v_mfma_f32_16x16x32_bf16 v[200:203], v[4:7], v[240:243], v[200:203]
    ds_read_b128 v[40:43], v25 offset:45056
    v_cvt_pk_bf16_f32 v168, v168, v169
    v_mfma_f32_16x16x32_bf16 v[200:203], v[44:47], v[248:251], v[200:203]
    ds_read_b128 v[8:11], v25 offset:46080
    v_cvt_pk_bf16_f32 v169, v170, v171
    v_mfma_f32_16x16x32_bf16 v[216:219], v[44:47], v[252:255], v[216:219]
    v_cvt_pk_bf16_f32 v170, v184, v185
    v_cvt_pk_bf16_f32 v171, v186, v187
    v_mfma_f32_16x16x32_bf16 v[216:219], v[4:7], v[244:247], v[216:219]
    v_mfma_f32_16x16x32_bf16 v[216:219], v[76:79], v[236:239], v[216:219]
    v_mfma_f32_16x16x32_bf16 v[216:219], v[72:75], v[228:231], v[216:219]
    buffer_store_dwordx4 v[168:171], v24, s[28:31], s51 offen offset:1024 sc1
    v_mfma_f32_16x16x32_bf16 v[216:219], v[68:71], a[252:255], v[216:219]
    v_mfma_f32_16x16x32_bf16 v[216:219], v[64:67], a[244:247], v[216:219]
    s_waitcnt lgkmcnt(0)
    v_mfma_f32_16x16x32_bf16 v[164:167], v[80:83], a[240:243], v[164:167]
    ds_read_b128 v[64:67], v25 offset:47104
    v_mfma_f32_16x16x32_bf16 v[164:167], v[84:87], a[248:251], v[164:167]
    ds_read_b128 v[68:71], v25 offset:48128
    v_mfma_f32_16x16x32_bf16 v[164:167], v[88:91], v[224:227], v[164:167]
    ds_read_b128 v[72:75], v25 offset:49152
    v_mfma_f32_16x16x32_bf16 v[164:167], v[92:95], v[232:235], v[164:167]
    ds_read_b128 v[76:79], v25 offset:50176
    v_mfma_f32_16x16x32_bf16 v[164:167], v[40:43], v[240:243], v[164:167]
    ds_read_b128 v[4:7], v25 offset:51200
    v_cvt_pk_bf16_f32 v200, v200, v201
    v_mfma_f32_16x16x32_bf16 v[164:167], v[8:11], v[248:251], v[164:167]
    ds_read_b128 v[44:47], v25 offset:52224
    v_cvt_pk_bf16_f32 v201, v202, v203
    v_mfma_f32_16x16x32_bf16 v[180:183], v[8:11], v[252:255], v[180:183]
    v_cvt_pk_bf16_f32 v202, v216, v217
    v_cvt_pk_bf16_f32 v203, v218, v219
    v_mfma_f32_16x16x32_bf16 v[180:183], v[40:43], v[244:247], v[180:183]
    v_mfma_f32_16x16x32_bf16 v[180:183], v[92:95], v[236:239], v[180:183]
    v_mfma_f32_16x16x32_bf16 v[180:183], v[88:91], v[228:231], v[180:183]
    buffer_store_dwordx4 v[200:203], v24, s[28:31], s52 offen offset:0 sc1
    v_mfma_f32_16x16x32_bf16 v[180:183], v[84:87], a[252:255], v[180:183]
    v_mfma_f32_16x16x32_bf16 v[180:183], v[80:83], a[244:247], v[180:183]
    s_waitcnt lgkmcnt(0)
    v_mfma_f32_16x16x32_bf16 v[196:199], v[64:67], a[240:243], v[196:199]
    ds_read_b128 v[80:83], v25 offset:53248
    v_mfma_f32_16x16x32_bf16 v[196:199], v[68:71], a[248:251], v[196:199]
    ds_read_b128 v[84:87], v25 offset:54272
    v_mfma_f32_16x16x32_bf16 v[196:199], v[72:75], v[224:227], v[196:199]
    ds_read_b128 v[88:91], v25 offset:55296
    v_mfma_f32_16x16x32_bf16 v[196:199], v[76:79], v[232:235], v[196:199]
    ds_read_b128 v[92:95], v25 offset:56320
    v_mfma_f32_16x16x32_bf16 v[196:199], v[4:7], v[240:243], v[196:199]
    ds_read_b128 v[40:43], v26 offset:0
    v_cvt_pk_bf16_f32 v164, v164, v165
    v_mfma_f32_16x16x32_bf16 v[196:199], v[44:47], v[248:251], v[196:199]
    ds_read_b128 v[8:11], v26 offset:1024
    v_cvt_pk_bf16_f32 v165, v166, v167
    v_mfma_f32_16x16x32_bf16 v[212:215], v[44:47], v[252:255], v[212:215]
    v_cvt_pk_bf16_f32 v166, v180, v181
    v_cvt_pk_bf16_f32 v167, v182, v183
    v_mfma_f32_16x16x32_bf16 v[212:215], v[4:7], v[244:247], v[212:215]
    v_mfma_f32_16x16x32_bf16 v[212:215], v[76:79], v[236:239], v[212:215]
    v_mfma_f32_16x16x32_bf16 v[212:215], v[72:75], v[228:231], v[212:215]
    buffer_store_dwordx4 v[164:167], v24, s[28:31], s52 offen offset:1024 sc1
    v_mfma_f32_16x16x32_bf16 v[212:215], v[68:71], a[252:255], v[212:215]
    v_mfma_f32_16x16x32_bf16 v[212:215], v[64:67], a[244:247], v[212:215]
    s_waitcnt lgkmcnt(0)
    v_mfma_f32_16x16x32_bf16 v[160:163], v[80:83], a[240:243], v[160:163]
    ds_read_b128 v[64:67], v26 offset:2048
    v_mfma_f32_16x16x32_bf16 v[160:163], v[84:87], a[248:251], v[160:163]
    ds_read_b128 v[68:71], v26 offset:3072
    v_mfma_f32_16x16x32_bf16 v[160:163], v[88:91], v[224:227], v[160:163]
    ds_read_b128 v[72:75], v26 offset:4096
    v_mfma_f32_16x16x32_bf16 v[160:163], v[92:95], v[232:235], v[160:163]
    ds_read_b128 v[76:79], v26 offset:5120
    v_mfma_f32_16x16x32_bf16 v[160:163], v[40:43], v[240:243], v[160:163]
    ds_read_b128 v[4:7], v26 offset:6144
    v_cvt_pk_bf16_f32 v196, v196, v197
    v_mfma_f32_16x16x32_bf16 v[160:163], v[8:11], v[248:251], v[160:163]
    ds_read_b128 v[44:47], v26 offset:7168
    v_cvt_pk_bf16_f32 v197, v198, v199
    v_mfma_f32_16x16x32_bf16 v[176:179], v[8:11], v[252:255], v[176:179]
    v_cvt_pk_bf16_f32 v198, v212, v213
    v_cvt_pk_bf16_f32 v199, v214, v215
    v_mfma_f32_16x16x32_bf16 v[176:179], v[40:43], v[244:247], v[176:179]
    v_mfma_f32_16x16x32_bf16 v[176:179], v[92:95], v[236:239], v[176:179]
    v_mfma_f32_16x16x32_bf16 v[176:179], v[88:91], v[228:231], v[176:179]
    buffer_store_dwordx4 v[196:199], v24, s[28:31], s53 offen offset:0 sc1
    v_mfma_f32_16x16x32_bf16 v[176:179], v[84:87], a[252:255], v[176:179]
    v_mfma_f32_16x16x32_bf16 v[176:179], v[80:83], a[244:247], v[176:179]
    s_waitcnt lgkmcnt(0)
    v_mfma_f32_16x16x32_bf16 v[192:195], v[64:67], a[240:243], v[192:195]
    s_waitcnt vmcnt(14)
    s_barrier
    v_mfma_f32_16x16x32_bf16 v[192:195], v[68:71], a[248:251], v[192:195]
    ds_read_b128 v[80:83], v26 offset:8192
    ds_read_b128 v[84:87], v26 offset:9216
    v_mfma_f32_16x16x32_bf16 v[192:195], v[72:75], v[224:227], v[192:195]
    ds_read_b128 v[88:91], v26 offset:10240
    ds_read_b128 v[92:95], v26 offset:11264
    v_mfma_f32_16x16x32_bf16 v[192:195], v[76:79], v[232:235], v[192:195]
    ds_read_b128 v[40:43], v26 offset:12288
    ds_read_b128 v[8:11], v26 offset:13312
    v_mfma_f32_16x16x32_bf16 v[192:195], v[4:7], v[240:243], v[192:195]
    ds_read_b128 v[20:23], v26 offset:14336
    v_mfma_f32_16x16x32_bf16 v[192:195], v[44:47], v[248:251], v[192:195]
    v_mfma_f32_16x16x32_bf16 v[208:211], v[44:47], v[252:255], v[208:211]
    v_mfma_f32_16x16x32_bf16 v[208:211], v[4:7], v[244:247], v[208:211]
    v_mfma_f32_16x16x32_bf16 v[208:211], v[76:79], v[236:239], v[208:211]
    v_cvt_pk_bf16_f32 v160, v160, v161
    v_cvt_pk_bf16_f32 v161, v162, v163
    v_mfma_f32_16x16x32_bf16 v[208:211], v[72:75], v[228:231], v[208:211]
    v_cvt_pk_bf16_f32 v162, v176, v177
    v_cvt_pk_bf16_f32 v163, v178, v179
    v_mfma_f32_16x16x32_bf16 v[208:211], v[68:71], a[252:255], v[208:211]
    v_mfma_f32_16x16x32_bf16 v[208:211], v[64:67], a[244:247], v[208:211]
    s_waitcnt lgkmcnt(0)
    v_mfma_f32_16x16x32_bf16 v[96:99], v[80:83], a[0:3], 0
    buffer_store_dwordx4 v[160:163], v24, s[28:31], s53 offen offset:1024 sc1
    v_mfma_f32_16x16x32_bf16 v[96:99], v[84:87], a[8:11], v[96:99]
    ds_read_b128 v[64:67], v26 offset:15360
    v_mfma_f32_16x16x32_bf16 v[96:99], v[88:91], a[16:19], v[96:99]
    ds_read_b128 v[68:71], v26 offset:16384
    v_mfma_f32_16x16x32_bf16 v[96:99], v[92:95], a[24:27], v[96:99]
    ds_read_b128 v[72:75], v26 offset:17408
    v_mfma_f32_16x16x32_bf16 v[96:99], v[40:43], a[32:35], v[96:99]
    ds_read_b128 v[76:79], v26 offset:18432
    v_mfma_f32_16x16x32_bf16 v[96:99], v[8:11], a[40:43], v[96:99]
    ds_read_b128 v[4:7], v26 offset:19456
    v_cvt_pk_bf16_f32 v148, v192, v193
    v_mfma_f32_16x16x32_bf16 v[96:99], v[20:23], a[48:51], v[96:99]
    ds_read_b128 v[44:47], v26 offset:20480
    v_cvt_pk_bf16_f32 v149, v194, v195
    v_mfma_f32_16x16x32_bf16 v[100:103], v[20:23], a[52:55], 0
    ds_read_b128 v[172:175], v26 offset:21504
    v_cvt_pk_bf16_f32 v150, v208, v209
    v_mfma_f32_16x16x32_bf16 v[100:103], v[8:11], a[44:47], v[100:103]
    v_cvt_pk_bf16_f32 v151, v210, v211
    v_mfma_f32_16x16x32_bf16 v[100:103], v[40:43], a[36:39], v[100:103]
    v_mfma_f32_16x16x32_bf16 v[100:103], v[92:95], a[28:31], v[100:103]
    buffer_store_dwordx4 v[148:151], v31, s[28:31], s54 offen sc1
    v_mfma_f32_16x16x32_bf16 v[100:103], v[88:91], a[20:23], v[100:103]
    v_mfma_f32_16x16x32_bf16 v[100:103], v[84:87], a[12:15], v[100:103]
    v_mfma_f32_16x16x32_bf16 v[100:103], v[80:83], a[4:7], v[100:103]
    s_waitcnt lgkmcnt(0)
    v_mfma_f32_16x16x32_bf16 v[104:107], v[64:67], a[0:3], 0
    ds_read_b128 v[80:83], v26 offset:22528
    v_mfma_f32_16x16x32_bf16 v[104:107], v[68:71], a[8:11], v[104:107]
    ds_read_b128 v[84:87], v26 offset:23552
    v_mfma_f32_16x16x32_bf16 v[104:107], v[72:75], a[16:19], v[104:107]
    ds_read_b128 v[88:91], v26 offset:24576
    v_mfma_f32_16x16x32_bf16 v[104:107], v[76:79], a[24:27], v[104:107]
    ds_read_b128 v[92:95], v26 offset:25600
    v_mfma_f32_16x16x32_bf16 v[104:107], v[4:7], a[32:35], v[104:107]
    ds_read_b128 v[40:43], v26 offset:26624
    v_mfma_f32_16x16x32_bf16 v[104:107], v[44:47], a[40:43], v[104:107]
    ds_read_b128 v[8:11], v26 offset:27648
    v_mfma_f32_16x16x32_bf16 v[104:107], v[172:175], a[48:51], v[104:107]
    ds_read_b128 v[20:23], v26 offset:28672
    v_mfma_f32_16x16x32_bf16 v[108:111], v[172:175], a[52:55], 0
    v_mfma_f32_16x16x32_bf16 v[108:111], v[44:47], a[44:47], v[108:111]
    v_mfma_f32_16x16x32_bf16 v[108:111], v[4:7], a[36:39], v[108:111]
    v_mfma_f32_16x16x32_bf16 v[108:111], v[76:79], a[28:31], v[108:111]
    v_mfma_f32_16x16x32_bf16 v[108:111], v[72:75], a[20:23], v[108:111]
    v_mfma_f32_16x16x32_bf16 v[108:111], v[68:71], a[12:15], v[108:111]
    v_mfma_f32_16x16x32_bf16 v[108:111], v[64:67], a[4:7], v[108:111]
    s_waitcnt lgkmcnt(0)
    v_mfma_f32_16x16x32_bf16 v[96:99], v[80:83], a[56:59], v[96:99]
    ds_read_b128 v[64:67], v26 offset:29696
    v_mfma_f32_16x16x32_bf16 v[96:99], v[84:87], a[64:67], v[96:99]
    ds_read_b128 v[68:71], v26 offset:30720
    v_mfma_f32_16x16x32_bf16 v[96:99], v[88:91], a[72:75], v[96:99]
    ds_read_b128 v[72:75], v26 offset:31744
    v_mfma_f32_16x16x32_bf16 v[96:99], v[92:95], a[80:83], v[96:99]
    ds_read_b128 v[76:79], v26 offset:32768
    v_mfma_f32_16x16x32_bf16 v[96:99], v[40:43], a[88:91], v[96:99]
    ds_read_b128 v[4:7], v26 offset:33792
    v_mfma_f32_16x16x32_bf16 v[96:99], v[8:11], a[96:99], v[96:99]
    ds_read_b128 v[44:47], v26 offset:34816
    v_mfma_f32_16x16x32_bf16 v[96:99], v[20:23], a[104:107], v[96:99]
    ds_read_b128 v[172:175], v26 offset:35840
    v_mfma_f32_16x16x32_bf16 v[100:103], v[20:23], a[108:111], v[100:103]
    v_mfma_f32_16x16x32_bf16 v[100:103], v[8:11], a[100:103], v[100:103]
    v_mfma_f32_16x16x32_bf16 v[100:103], v[40:43], a[92:95], v[100:103]
    v_mfma_f32_16x16x32_bf16 v[100:103], v[92:95], a[84:87], v[100:103]
    v_mfma_f32_16x16x32_bf16 v[100:103], v[88:91], a[76:79], v[100:103]
    v_mfma_f32_16x16x32_bf16 v[100:103], v[84:87], a[68:71], v[100:103]
    v_mfma_f32_16x16x32_bf16 v[100:103], v[80:83], a[60:63], v[100:103]
    s_waitcnt lgkmcnt(0)
    v_mfma_f32_16x16x32_bf16 v[104:107], v[64:67], a[56:59], v[104:107]
    ds_read_b128 v[80:83], v26 offset:36864
    v_mfma_f32_16x16x32_bf16 v[104:107], v[68:71], a[64:67], v[104:107]
    ds_read_b128 v[84:87], v26 offset:37888
    v_mfma_f32_16x16x32_bf16 v[104:107], v[72:75], a[72:75], v[104:107]
    ds_read_b128 v[88:91], v26 offset:38912
    v_mfma_f32_16x16x32_bf16 v[104:107], v[76:79], a[80:83], v[104:107]
    ds_read_b128 v[92:95], v26 offset:39936
    v_mfma_f32_16x16x32_bf16 v[104:107], v[4:7], a[88:91], v[104:107]
    ds_read_b128 v[40:43], v26 offset:40960
    v_mfma_f32_16x16x32_bf16 v[104:107], v[44:47], a[96:99], v[104:107]
    ds_read_b128 v[8:11], v26 offset:41984
    v_mfma_f32_16x16x32_bf16 v[104:107], v[172:175], a[104:107], v[104:107]
    v_mfma_f32_16x16x32_bf16 v[108:111], v[172:175], a[108:111], v[108:111]
    v_mfma_f32_16x16x32_bf16 v[108:111], v[44:47], a[100:103], v[108:111]
    v_mfma_f32_16x16x32_bf16 v[108:111], v[4:7], a[92:95], v[108:111]
    v_mfma_f32_16x16x32_bf16 v[108:111], v[76:79], a[84:87], v[108:111]
    v_mfma_f32_16x16x32_bf16 v[108:111], v[72:75], a[76:79], v[108:111]
    v_mfma_f32_16x16x32_bf16 v[108:111], v[68:71], a[68:71], v[108:111]
    v_mfma_f32_16x16x32_bf16 v[108:111], v[64:67], a[60:63], v[108:111]
    s_waitcnt lgkmcnt(0)
    v_mfma_f32_16x16x32_bf16 v[96:99], v[80:83], a[112:115], v[96:99]
    s_waitcnt vmcnt(7)
    s_barrier
    v_mfma_f32_16x16x32_bf16 v[96:99], v[84:87], a[120:123], v[96:99]
    ds_read_b128 v[64:67], v26 offset:43008
    ds_read_b128 v[68:71], v26 offset:44032
    v_mfma_f32_16x16x32_bf16 v[96:99], v[88:91], a[128:131], v[96:99]
    ds_read_b128 v[72:75], v24 offset:12288
    ds_read_b128 v[76:79], v24 offset:13312
    v_mfma_f32_16x16x32_bf16 v[96:99], v[92:95], a[136:139], v[96:99]
    ds_read_b128 v[4:7], v24 offset:14336
    ds_read_b128 v[44:47], v24 offset:15360
    v_mfma_f32_16x16x32_bf16 v[96:99], v[40:43], a[144:147], v[96:99]
    v_mfma_f32_16x16x32_bf16 v[96:99], v[8:11], a[152:155], v[96:99]
    v_mfma_f32_16x16x32_bf16 v[100:103], v[8:11], a[156:159], v[100:103]
    v_mfma_f32_16x16x32_bf16 v[100:103], v[40:43], a[148:151], v[100:103]
    v_mfma_f32_16x16x32_bf16 v[100:103], v[92:95], a[140:143], v[100:103]
    v_mfma_f32_16x16x32_bf16 v[100:103], v[88:91], a[132:135], v[100:103]
    v_mfma_f32_16x16x32_bf16 v[100:103], v[84:87], a[124:127], v[100:103]
    v_mfma_f32_16x16x32_bf16 v[100:103], v[80:83], a[116:119], v[100:103]
    s_waitcnt lgkmcnt(0)
    v_mfma_f32_16x16x32_bf16 v[104:107], v[64:67], a[112:115], v[104:107]
    ds_read_b128 v[80:83], v24 offset:16384
    v_mfma_f32_16x16x32_bf16 v[104:107], v[68:71], a[120:123], v[104:107]
    ds_read_b128 v[84:87], v24 offset:17408
    v_mfma_f32_16x16x32_bf16 v[104:107], v[72:75], a[128:131], v[104:107]
    ds_read_b128 v[88:91], v24 offset:18432
    v_mfma_f32_16x16x32_bf16 v[104:107], v[76:79], a[136:139], v[104:107]
    ds_read_b128 v[92:95], v24 offset:19456
    v_mfma_f32_16x16x32_bf16 v[104:107], v[4:7], a[144:147], v[104:107]
    ds_read_b128 v[40:43], v24 offset:20480
    v_mfma_f32_16x16x32_bf16 v[104:107], v[44:47], a[152:155], v[104:107]
    v_mfma_f32_16x16x32_bf16 v[108:111], v[44:47], a[156:159], v[108:111]
    v_mfma_f32_16x16x32_bf16 v[108:111], v[4:7], a[148:151], v[108:111]
    v_mfma_f32_16x16x32_bf16 v[108:111], v[76:79], a[140:143], v[108:111]
    v_mfma_f32_16x16x32_bf16 v[108:111], v[72:75], a[132:135], v[108:111]
    v_mfma_f32_16x16x32_bf16 v[108:111], v[68:71], a[124:127], v[108:111]
    v_mfma_f32_16x16x32_bf16 v[108:111], v[64:67], a[116:119], v[108:111]
    s_waitcnt lgkmcnt(0)
    v_mfma_f32_16x16x32_bf16 v[96:99], v[80:83], a[160:163], v[96:99]
    ds_read_b128 v[64:67], v24 offset:21504
    ds_read_b128 v[68:71], v24 offset:22528
    v_mfma_f32_16x16x32_bf16 v[96:99], v[84:87], a[168:171], v[96:99]
    buffer_load_dwordx4 v[220:223], v24, s[28:31], s50 offen offset:0 sc1
    v_mfma_f32_16x16x32_bf16 v[96:99], v[88:91], a[176:179], v[96:99]
    ds_read_b128 v[72:75], v24 offset:23552
    ds_read_b128 v[76:79], v24 offset:24576
    v_mfma_f32_16x16x32_bf16 v[96:99], v[92:95], a[184:187], v[96:99]
    ds_read_b128 v[4:7], v24 offset:25600
    v_mfma_f32_16x16x32_bf16 v[96:99], v[40:43], a[192:195], v[96:99]
    buffer_load_dwordx4 v[184:187], v24, s[28:31], s55 offen offset:0 sc1
    v_mfma_f32_16x16x32_bf16 v[100:103], v[40:43], a[196:199], v[100:103]
    v_mfma_f32_16x16x32_bf16 v[100:103], v[92:95], a[188:191], v[100:103]
    v_mfma_f32_16x16x32_bf16 v[100:103], v[88:91], a[180:183], v[100:103]
    buffer_load_dwordx4 v[216:219], v24, s[28:31], s56 offen offset:0 sc1
    v_mfma_f32_16x16x32_bf16 v[100:103], v[84:87], a[172:175], v[100:103]
    v_mfma_f32_16x16x32_bf16 v[100:103], v[80:83], a[164:167], v[100:103]
    s_waitcnt lgkmcnt(0)
    v_mfma_f32_16x16x32_bf16 v[104:107], v[64:67], a[160:163], v[104:107]
    buffer_load_dwordx4 v[180:183], v24, s[28:31], s50 offen offset:1024 sc1
    v_mfma_f32_16x16x32_bf16 v[104:107], v[68:71], a[168:171], v[104:107]
    ds_read_b128 v[80:83], v24 offset:26624
    ds_read_b128 v[84:87], v24 offset:27648
    v_mfma_f32_16x16x32_bf16 v[104:107], v[72:75], a[176:179], v[104:107]
    ds_read_b128 v[88:91], v24 offset:28672
    ds_read_b128 v[92:95], v24 offset:29696
    v_mfma_f32_16x16x32_bf16 v[104:107], v[76:79], a[184:187], v[104:107]
    buffer_load_dwordx4 v[212:215], v24, s[28:31], s55 offen offset:1024 sc1
    v_mfma_f32_16x16x32_bf16 v[104:107], v[4:7], a[192:195], v[104:107]
    ds_read_b128 v[40:43], v24 offset:30720
    v_mfma_f32_16x16x32_bf16 v[108:111], v[4:7], a[196:199], v[108:111]
    v_mfma_f32_16x16x32_bf16 v[108:111], v[76:79], a[188:191], v[108:111]
    buffer_load_dwordx4 v[176:179], v24, s[28:31], s56 offen offset:1024 sc1
    v_mfma_f32_16x16x32_bf16 v[108:111], v[72:75], a[180:183], v[108:111]
    v_mfma_f32_16x16x32_bf16 v[108:111], v[68:71], a[172:175], v[108:111]
    v_mfma_f32_16x16x32_bf16 v[108:111], v[64:67], a[164:167], v[108:111]
    s_waitcnt lgkmcnt(0)
    v_mfma_f32_16x16x32_bf16 v[96:99], v[80:83], a[200:203], v[96:99]
    buffer_load_dwordx4 v[112:115], v34, s[28:31], s50 offen offset:2048 sc1
    v_mfma_f32_16x16x32_bf16 v[96:99], v[84:87], a[208:211], v[96:99]
    ds_read_b128 v[64:67], v24 offset:31744
    ds_read_b128 v[68:71], v24 offset:32768
    v_mfma_f32_16x16x32_bf16 v[96:99], v[88:91], a[216:219], v[96:99]
    ds_read_b128 v[72:75], v24 offset:33792
    ds_read_b128 v[76:79], v24 offset:34816
    v_mfma_f32_16x16x32_bf16 v[96:99], v[92:95], a[224:227], v[96:99]
    buffer_load_dwordx4 v[116:119], v34, s[28:31], s55 offen offset:2048 sc1
    v_mfma_f32_16x16x32_bf16 v[96:99], v[40:43], a[232:235], v[96:99]
    ds_read_b128 v[4:7], v24 offset:35840
    v_mfma_f32_16x16x32_bf16 v[100:103], v[40:43], a[236:239], v[100:103]
    v_mfma_f32_16x16x32_bf16 v[100:103], v[92:95], a[228:231], v[100:103]
    buffer_load_dwordx4 v[120:123], v34, s[28:31], s56 offen offset:2048 sc1
    v_mfma_f32_16x16x32_bf16 v[100:103], v[88:91], a[220:223], v[100:103]
    v_mfma_f32_16x16x32_bf16 v[100:103], v[84:87], a[212:215], v[100:103]
    v_mfma_f32_16x16x32_bf16 v[100:103], v[80:83], a[204:207], v[100:103]
    s_waitcnt lgkmcnt(0)
    v_mfma_f32_16x16x32_bf16 v[104:107], v[64:67], a[200:203], v[104:107]
    ds_read_b128 v[80:83], v24 offset:36864
    ds_read_b128 v[84:87], v24 offset:37888
    v_mfma_f32_16x16x32_bf16 v[104:107], v[68:71], a[208:211], v[104:107]
    ds_read_b128 v[88:91], v24 offset:38912
    ds_read_b128 v[92:95], v24 offset:39936
    v_mfma_f32_16x16x32_bf16 v[104:107], v[72:75], a[216:219], v[104:107]
    ds_read_b128 v[40:43], v24 offset:40960
    ds_read_b128 v[8:11], v24 offset:41984
    v_mfma_f32_16x16x32_bf16 v[104:107], v[76:79], a[224:227], v[104:107]
    v_mfma_f32_16x16x32_bf16 v[104:107], v[4:7], a[232:235], v[104:107]
    v_mfma_f32_16x16x32_bf16 v[108:111], v[4:7], a[236:239], v[108:111]
    v_mfma_f32_16x16x32_bf16 v[108:111], v[76:79], a[228:231], v[108:111]
    v_mfma_f32_16x16x32_bf16 v[108:111], v[72:75], a[220:223], v[108:111]
    v_mfma_f32_16x16x32_bf16 v[108:111], v[68:71], a[212:215], v[108:111]
    v_mfma_f32_16x16x32_bf16 v[108:111], v[64:67], a[204:207], v[108:111]
    s_waitcnt lgkmcnt(0)
    v_mfma_f32_16x16x32_bf16 v[96:99], v[80:83], a[240:243], v[96:99]
    ds_read_b128 v[64:67], v24 offset:43008
    v_mfma_f32_16x16x32_bf16 v[96:99], v[84:87], a[248:251], v[96:99]
    ds_read_b128 v[68:71], v24 offset:44032
    v_mfma_f32_16x16x32_bf16 v[96:99], v[88:91], v[224:227], v[96:99]
    ds_read_b128 v[72:75], v24 offset:45056
    v_mfma_f32_16x16x32_bf16 v[96:99], v[92:95], v[232:235], v[96:99]
    ds_read_b128 v[76:79], v24 offset:46080
    v_mfma_f32_16x16x32_bf16 v[96:99], v[40:43], v[240:243], v[96:99]
    ds_read_b128 v[4:7], v24 offset:47104
    v_mfma_f32_16x16x32_bf16 v[96:99], v[8:11], v[248:251], v[96:99]
    ds_read_b128 v[44:47], v24 offset:48128
    v_mfma_f32_16x16x32_bf16 v[100:103], v[8:11], v[252:255], v[100:103]
    v_mfma_f32_16x16x32_bf16 v[100:103], v[40:43], v[244:247], v[100:103]
    v_mfma_f32_16x16x32_bf16 v[100:103], v[92:95], v[236:239], v[100:103]
    v_mfma_f32_16x16x32_bf16 v[100:103], v[88:91], v[228:231], v[100:103]
    v_mfma_f32_16x16x32_bf16 v[100:103], v[84:87], a[252:255], v[100:103]
    v_mfma_f32_16x16x32_bf16 v[100:103], v[80:83], a[244:247], v[100:103]
    s_waitcnt lgkmcnt(0)
    v_mfma_f32_16x16x32_bf16 v[104:107], v[64:67], a[240:243], v[104:107]
    v_mfma_f32_16x16x32_bf16 v[104:107], v[68:71], a[248:251], v[104:107]
    v_mfma_f32_16x16x32_bf16 v[104:107], v[72:75], v[224:227], v[104:107]
    v_mfma_f32_16x16x32_bf16 v[104:107], v[76:79], v[232:235], v[104:107]
    v_mfma_f32_16x16x32_bf16 v[104:107], v[4:7], v[240:243], v[104:107]
    v_mfma_f32_16x16x32_bf16 v[104:107], v[44:47], v[248:251], v[104:107]
    v_mfma_f32_16x16x32_bf16 v[108:111], v[44:47], v[252:255], v[108:111]
    v_mfma_f32_16x16x32_bf16 v[108:111], v[4:7], v[244:247], v[108:111]
    v_mfma_f32_16x16x32_bf16 v[108:111], v[76:79], v[236:239], v[108:111]
    v_mfma_f32_16x16x32_bf16 v[108:111], v[72:75], v[228:231], v[108:111]
    v_mfma_f32_16x16x32_bf16 v[108:111], v[68:71], a[252:255], v[108:111]
    v_mfma_f32_16x16x32_bf16 v[108:111], v[64:67], a[244:247], v[108:111]
    s_mov_b32 s5, 0x40000
ffn_retry:
    s_waitcnt vmcnt(0)
    v_max3_u32 v28, v220, v221, v222
    v_max3_u32 v29, v223, v184, v185
    v_max3_u32 v28, v28, v186, v187
    v_max3_u32 v29, v29, v216, v217
    v_max3_u32 v28, v28, v218, v219
    v_max3_u32 v29, v29, v180, v181
    v_max3_u32 v28, v28, v182, v183
    v_max3_u32 v29, v29, v212, v213
    v_max3_u32 v28, v28, v214, v215
    v_max3_u32 v29, v29, v176, v177
    v_max3_u32 v28, v28, v178, v179
    v_max3_u32 v29, v29, v112, v113
    v_max3_u32 v28, v28, v114, v115
    v_max3_u32 v29, v29, v116, v117
    v_max3_u32 v28, v28, v118, v119
    v_max3_u32 v29, v29, v120, v121
    v_max3_u32 v28, v28, v122, v123
    v_max_u32 v28, v28, v29
    v_cmp_eq_u32 vcc, -1, v28
    s_cbranch_vccnz ffn_again
ffn_fin:
    v_mfma_f32_16x16x32_bf16 v[96:99], v[12:15], v[220:223], v[96:99]
    v_mfma_f32_16x16x32_bf16 v[104:107], v[12:15], v[180:183], v[104:107]
    v_mfma_f32_16x16x32_bf16 v[96:99], v[12:15], v[184:187], v[96:99]
    v_mfma_f32_16x16x32_bf16 v[104:107], v[12:15], v[212:215], v[104:107]
    v_mfma_f32_16x16x32_bf16 v[96:99], v[12:15], v[216:219], v[96:99]
    v_mfma_f32_16x16x32_bf16 v[104:107], v[12:15], v[176:179], v[104:107]
    v_mfma_f32_16x16x32_bf16 v[100:103], v[14:17], v[220:223], v[100:103]
    v_mfma_f32_16x16x32_bf16 v[108:111], v[14:17], v[180:183], v[108:111]
    v_mfma_f32_16x16x32_bf16 v[100:103], v[14:17], v[184:187], v[100:103]
    v_mfma_f32_16x16x32_bf16 v[108:111], v[14:17], v[212:215], v[108:111]
    v_mfma_f32_16x16x32_bf16 v[100:103], v[14:17], v[216:219], v[100:103]
    v_mfma_f32_16x16x32_bf16 v[108:111], v[14:17], v[176:179], v[108:111]
    s_nop 0
    v_fmac_f32 v124, v38, v96
    v_fmac_f32 v125, v38, v97
    v_mfma_f32_16x16x32_bf16 v[192:195], v[12:15], v[112:115], v[192:195]
    v_fmac_f32 v126, v38, v98
    v_fmac_f32 v127, v38, v99
    v_mfma_f32_16x16x32_bf16 v[208:211], v[14:17], v[112:115], v[208:211]
    v_cvt_pk_bf16_f32 v48, v124, v125
    v_cvt_pk_bf16_f32 v49, v126, v127
    v_mfma_f32_16x16x32_bf16 v[192:195], v[12:15], v[116:119], v[192:195]
    v_fmac_f32 v132, v38, v104
    v_fmac_f32 v133, v38, v105
    v_mfma_f32_16x16x32_bf16 v[208:211], v[14:17], v[116:119], v[208:211]
    v_fmac_f32 v134, v38, v106
    v_fmac_f32 v135, v38, v107
    v_mfma_f32_16x16x32_bf16 v[192:195], v[12:15], v[120:123], v[192:195]
    v_cvt_pk_bf16_f32 v50, v132, v133
    v_cvt_pk_bf16_f32 v51, v134, v135
    v_mfma_f32_16x16x32_bf16 v[208:211], v[14:17], v[120:123], v[208:211]
    v_fmac_f32 v128, v39, v100
    v_fmac_f32 v129, v39, v101
    v_fmac_f32 v130, v39, v102
    v_fmac_f32 v131, v39, v103
    v_cvt_pk_bf16_f32 v52, v128, v129
    v_cvt_pk_bf16_f32 v53, v130, v131
    v_fmac_f32 v136, v39, v108
    v_fmac_f32 v137, v39, v109
    v_fmac_f32 v138, v39, v110
    v_fmac_f32 v139, v39, v111
    v_cvt_pk_bf16_f32 v54, v136, v137
    v_cvt_pk_bf16_f32 v55, v138, v139
    v_permlane16_swap_b32 v48, v50
    v_permlane16_swap_b32 v49, v51
    buffer_store_dwordx4 v[48:51], v18, s[76:79], s62 offen
    v_fmac_f32 v140, v38, v192
    v_fmac_f32 v141, v38, v193
    v_fmac_f32 v142, v38, v194
    v_fmac_f32 v143, v38, v195
    v_cvt_pk_bf16_f32 v56, v140, v141
    v_cvt_pk_bf16_f32 v57, v142, v143
    v_fmac_f32 v144, v39, v208
    v_fmac_f32 v145, v39, v209
    v_fmac_f32 v146, v39, v210
    v_fmac_f32 v147, v39, v211
    v_cvt_pk_bf16_f32 v58, v144, v145
    v_cvt_pk_bf16_f32 v59, v146, v147
    v_permlane16_swap_b32 v52, v54
    v_permlane16_swap_b32 v53, v55
    buffer_store_dwordx4 v[52:55], v18, s[76:79], s63 offen
    v_permlane16_swap_b32 v56, v58
    v_permlane16_swap_b32 v57, v59
    buffer_store_dwordx4 v[56:59], v19, s[76:79], s61 offen offset:256
ffn_c1:
    s_endpgm
ffn_bg:
    s_waitcnt lgkmcnt(0)
    s_barrier
    v_readfirstlane_b32 s96, v31
    s_mov_b32 s20, s40
    s_and_b32 s21, s41, 0xffff
    s_mov_b32 s40, s42
    s_and_b32 s41, s43, 0xffff
    s_mov_b32 s76, s46
    s_and_b32 s77, s47, 0xffff
    s_and_b32 s3, s2, 7
    s_lshr_b32 s4, s2, 3
    s_and_b32 s5, s3, 1
    s_lshl_b32 s5, s5, 2
    s_and_b32 s6, s4, 3
    s_add_u32 s34, s5, s6
    s_lshr_b32 s35, s3, 1
    s_lshr_b32 s36, s4, 2
    s_lshl_b32 s5, s35, 3
    s_add_u32 s37, s5, s36
    s_lshr_b32 s5, s37, 2
    s_lshl_b32 s6, s37, 1
    s_add_u32 s39, s5, s6
    s_lshl_b32 s72, s39, 7
    v_lshrrev_b32 v5, 3, v1
    v_and_b32 v6, 6, v5
    v_xor_b32 v6, v6, v1
    v_and_b32 v6, 7, v6
    v_lshlrev_b32 v6, 4, v6
    v_lshl_add_u32 v2, v5, 7, v6
    v_lshrrev_b32 v5, 3, v0
    v_mul_u32_u24 v5, 9216, v5
    v_add_u32 v3, v5, v6
    s_lshl_b32 s5, s34, 2
    s_add_u32 s5, s5, s33
    s_mul_i32 s5, s5, 73728
    s_add_u32 s60, s5, 0x900000
    s_lshl_b32 s58, s33, 10
    s_mul_i32 s59, s33, 12288
    s_mov_b32 s22, 5308416
    s_mov_b32 s23, 0x20000
    s_mov_b32 s42, 5308416
    s_mov_b32 s43, 0x20000
    v_cmp_gt_u32 vcc, 8, v0
    s_lshl_b32 s5, s2, 7
    s_add_u32 s5, s5, 0x40000
    v_mov_b32 v46, 0x20000000
    v_lshl_add_u32 v45, v0, 15, s5
    v_cndmask_b32 v47, v46, v45, vcc
    s_and_b32 s13, s2, 7
    s_lshl_b32 s13, s13, 15
    v_min_u32 v4, 35, v1
    s_mul_i32 s5, s33, 36
    v_add_u32 v4, s5, v4
    v_cmp_eq_u32 vcc, s2, v4
    v_xor_b32 v5, 1, v4
    s_mov_b32 s5, 2048
    v_cndmask_b32 v4, v4, v5, vcc
    v_add_lshl_u32 v4, v4, s5, 7
    s_sub_u32 s5, s2, 112
    s_lshl_b32 s5, s5, 7
    s_add_u32 s5, s5, 0x40000
    v_mov_b32 v6, s5
    v_min_u32 v39, 27, v1
    s_mul_i32 s5, s33, 28
    s_add_u32 s5, s5, 2192
    v_add_lshl_u32 v39, v39, s5, 7
    v_mov_b32 v5, s96
    s_add_u32 m0, s58, 49152
    s_nop 0
    buffer_load_dwordx4 v3, s[20:23], s72 offen lds
    s_and_b32 s15, s36, 3
    s_lshl_b32 s5, s15, 5
    v_lshrrev_b32 v40, 2, v1
    v_and_b32 v41, 6, v40
    v_lshlrev_b32 v41, 4, v41
    v_and_b32 v42, 3, v1
    v_lshlrev_b32 v43, 3, v42
    v_lshl_add_u32 v44, v40, 7, v43
    v_add_u32 v44, v44, v41
    v_xor_b32 v45, s5, v44
    v_xor_b32 v46, 0, v45
    v_add_u32 v8, s59, v46
    v_xor_b32 v46, 0, v44
    v_add_u32 v12, 49152, v46
    v_add_u32 v16, 106496, v46
    v_xor_b32 v46, 32, v45
    v_add_u32 v9, s59, v46
    s_add_u32 m0, s58, 53248
    s_nop 0
    buffer_load_dwordx4 v3, s[40:43], s72 offen lds
    v_xor_b32 v46, 32, v44
    v_add_u32 v13, 49152, v46
    v_add_u32 v17, 106496, v46
    v_xor_b32 v46, 64, v45
    v_add_u32 v10, s59, v46
    v_xor_b32 v46, 64, v44
    v_add_u32 v14, 49152, v46
    v_add_u32 v18, 106496, v46
    v_xor_b32 v46, 96, v45
    v_add_u32 v11, s59, v46
    v_xor_b32 v46, 96, v44
    v_add_u32 v15, 49152, v46
    v_add_u32 v19, 106496, v46
    v_mov_b32 v20, 0x3f803f80
    v_mov_b32 v21, 0x3f803f80
    v_mov_b32 v22, 0x3f803f80
    v_mov_b32 v23, 0x3f803f80
    s_add_u32 s72, s72, 294912
    s_add_u32 m0, s58, 57344
    s_nop 0
    buffer_load_dwordx4 v3, s[20:23], s72 offen lds
    v_lshlrev_b32 v24, 4, v1
    v_add_u32 v25, 57344, v24
    v_add_u32 v26, 114688, v24
    v_cmp_eq_u32 s[64:65], 1, v42
    v_cmp_eq_u32 s[66:67], 2, v42
    v_cmp_eq_u32 s[68:69], 3, v42
    v_lshlrev_b32 v27, 3, v1
    s_lshr_b32 s45, s36, 1
    s_and_b32 s44, s36, 1
    s_mul_i32 s38, s35, 36
    s_lshl_b32 s17, s34, 1
    s_add_u32 s17, s17, s44
    s_lshl_b32 s17, s17, 2
    s_add_u32 s17, s17, s33
    s_lshl_b32 s5, s34, 3
    s_lshl_b32 s6, s33, 1
    s_add_u32 s5, s5, s6
    s_add_u32 m0, s58, 61440
    s_nop 0
    buffer_load_dwordx4 v3, s[40:43], s72 offen lds
    s_mul_i32 s5, s5, 144
    s_add_u32 s5, s5, s38
    s_add_u32 s5, s5, s36
    s_lshl_b32 s5, s5, 11
    s_add_u32 s5, s5, 0x1b40000
    s_xor_b32 s6, s15, 0
    s_lshr_b32 s7, s6, 1
    s_mul_i32 s7, s7, 292864
    s_lshl_b32 s6, s6, 10
    s_add_u32 s6, s6, s7
    s_add_u32 s70, s5, s6
    s_xor_b32 s6, s15, 1
    s_lshr_b32 s7, s6, 1
    s_mul_i32 s7, s7, 292864
    s_lshl_b32 s6, s6, 10
    s_add_u32 s6, s6, s7
    s_add_u32 s71, s5, s6
    s_add_u32 s72, s72, 294912
    s_add_u32 m0, s58, 65536
    s_nop 0
    buffer_load_dwordx4 v3, s[20:23], s72 offen lds
    s_xor_b32 s6, s15, 2
    s_lshr_b32 s7, s6, 1
    s_mul_i32 s7, s7, 292864
    s_lshl_b32 s6, s6, 10
    s_add_u32 s6, s6, s7
    s_add_u32 s73, s5, s6
    s_xor_b32 s6, s15, 3
    s_lshr_b32 s7, s6, 1
    s_mul_i32 s7, s7, 292864
    s_lshl_b32 s6, s6, 10
    s_add_u32 s6, s6, s7
    s_add_u32 s74, s5, s6
    s_add_u32 s6, s45, 8
    s_sub_u32 s6, s6, s36
    s_lshl_b32 s6, s6, 11
    s_lshl_b32 s7, s44, 9
    s_add_u32 s16, s6, s7
    s_add_u32 m0, s58, 69632
    s_nop 0
    buffer_load_dwordx4 v3, s[40:43], s72 offen lds
    s_sub_u32 s18, 24576, s16
    s_lshl_b32 s5, s34, 3
    s_add_u32 s5, s5, s36
    s_mul_i32 s5, s5, 147456
    s_mul_i32 s6, s33, 9216
    s_add_u32 s5, s5, s6
    s_add_u32 s5, s5, 0x2d40000
    s_add_u32 s6, s35, 0
    s_and_b32 s6, s6, 3
    s_mul_i32 s6, s6, 36864
    s_add_u32 s50, s5, s6
    s_add_u32 s6, s35, 1
    s_and_b32 s6, s6, 3
    s_mul_i32 s6, s6, 36864
    s_add_u32 s51, s5, s6
    s_add_u32 s6, s35, 2
    s_and_b32 s6, s6, 3
    s_add_u32 s72, s72, 294912
    s_add_u32 m0, s58, 73728
    s_nop 0
    buffer_load_dwordx4 v3, s[20:23], s72 offen lds
    s_mul_i32 s6, s6, 36864
    s_add_u32 s52, s5, s6
    s_add_u32 s52, s52, 3072
    s_add_u32 s6, s35, 3
    s_and_b32 s6, s6, 3
    s_mul_i32 s6, s6, 36864
    s_add_u32 s53, s5, s6
    s_add_u32 s53, s53, 6144
    s_sub_u32 s46, s33, s35
    s_and_b32 s46, s46, 3
    s_mul_i32 s6, s33, 36864
    s_add_u32 s54, s5, s6
    s_mul_i32 s6, s46, 3072
    s_add_u32 s54, s54, s6
    s_sub_u32 s54, s54, 1024
    s_add_u32 s55, s50, 3072
    s_add_u32 s56, s50, 6144
    s_add_u32 m0, s58, 77824
    s_nop 0
    buffer_load_dwordx4 v3, s[40:43], s72 offen lds
    s_min_u32 s6, s46, 1
    s_mul_i32 s47, s6, 0x20000000
    s_sub_u32 s48, 0x20000000, s47
    s_mov_b32 s78, 2359296
    s_mov_b32 s79, 0x20000
    s_mul_i32 s5, s17, 36864
    s_mul_i32 s6, s45, 288
    s_add_u32 s61, s5, s6
    s_lshl_b32 s6, s35, 6
    s_add_u32 s62, s61, s6
    s_add_u32 s63, s62, 18432
    s_mul_i32 s5, s17, 144
    s_add_u32 s5, s5, s38
    s_lshl_b32 s5, s5, 11
    s_add_u32 s57, s5, 0x1b40000
    s_mul_i32 s5, s45, 18432
    s_lshr_b32 s6, s17, 1
    s_add_u32 s72, s72, 294912
    s_add_u32 m0, s58, 81920
    s_nop 0
    buffer_load_dwordx4 v3, s[20:23], s72 offen lds
    s_mul_i32 s6, s6, 73728
    s_add_u32 s5, s5, s6
    s_and_b32 s6, s17, 1
    s_lshl_b32 s6, s6, 6
    s_add_u32 s5, s5, s6
    s_add_u32 s5, s5, 0x900000
    s_lshl_b32 s6, s35, 12
    s_add_u32 s8, s5, s6
    s_add_u32 s9, s8, 2048
    s_add_u32 s10, s5, 16384
    s_mul_i32 s75, s33, 3072
    s_add_u32 s75, s75, 0
    s_lshl_b32 s49, s34, 11
    s_add_u32 s49, s49, 0xb60000
    s_sub_u32 s12, s49, 0x4000
    v_cmp_eq_u32 vcc, 0, v1
    s_lshl_b32 s5, s35, 9
    s_waitcnt vmcnt(9)
    s_barrier
    buffer_store_dword v5, v47, s[28:31], 0 offen sc1
    buffer_load_dword v7, v6, s[28:31], s13 offen sc1
    s_add_u32 m0, s58, 86016
    s_nop 0
    buffer_load_dwordx4 v3, s[40:43], s72 offen lds
    s_lshl_b32 s6, s33, 7
    s_lshl_b32 s7, s36, 2
    s_add_u32 s6, s6, s7
    s_add_u32 s7, s5, s6
    v_mov_b32 v46, 0x20000000
    v_mov_b32 v45, s7
    v_cndmask_b32 v33, v46, v45, vcc
    s_bfe_u32 s7, s17, 0x20001
    s_lshl_b32 s7, s7, 7
    s_add_u32 s14, s7, s5
    v_cmp_gt_u32 vcc, 8, v1
    v_lshl_add_u32 v32, v1, 2, s14
    v_lshl_add_u32 v45, v42, 9, s6
    v_cndmask_b32 v32, v45, v32, vcc
    v_add_u32 v34, s47, v24
    s_lshl_b32 s5, s45, 2
    s_add_u32 s5, s5, s35
    s_add_u32 s72, s72, 294912
    s_add_u32 m0, s58, 90112
    s_nop 0
    buffer_load_dwordx4 v3, s[20:23], s72 offen lds
    s_mul_i32 s5, s5, 331776
    s_add_u32 s5, s5, 0x161d000
    v_add_u32 v30, s5, v24
    s_mul_i32 s5, s37, 36864
    s_add_u32 s5, s5, 0xbeb000
    v_add_u32 v31, s5, v24
    v_and_b32 v40, 15, v1
    v_lshrrev_b32 v44, 4, v1
    v_lshlrev_b32 v35, 4, v44
    v_add_u32 v35, 159744, v35
    s_lshl_b32 s5, s34, 2
    s_add_u32 s5, s5, s35
    s_lshl_b32 s5, s5, 10
    s_add_u32 s19, s5, 0xb40000
    s_lshl_b32 s5, s33, 2
    s_add_u32 s5, s5, s15
    s_add_u32 m0, s58, 94208
    s_nop 0
    buffer_load_dwordx4 v3, s[40:43], s72 offen lds
    s_lshl_b32 s5, s5, 6
    v_lshl_add_u32 v45, v40, 2, s5
    s_and_b32 s5, s17, 7
    s_lshl_b32 s5, s5, 7
    v_lshl_add_u32 v37, v40, 2, s5
    v_lshrrev_b32 v40, 2, v40
    v_cmp_eq_u32 vcc, v40, v44
    s_lshl_b32 s5, s34, 2
    s_add_u32 s5, s5, s35
    s_lshl_b32 s5, s5, 1
    s_lshr_b32 s6, s36, 2
    s_add_u32 s5, s5, s6
    s_lshl_b32 s5, s5, 2
    s_add_u32 s5, s5, s33
    s_lshl_b32 s5, s5, 2
    s_add_u32 s5, s5, s15
    s_add_u32 s72, s72, 294912
    s_add_u32 m0, s58, 98304
    s_nop 0
    buffer_load_dwordx4 v3, s[20:23], s72 offen lds
    s_lshl_b32 s5, s5, 7
    s_add_u32 s24, s5, 0x100000
    s_xor_b32 s25, s24, 128
    s_xor_b32 s26, s24, 256
    s_xor_b32 s27, s24, 384
    s_lshr_b32 s5, s33, 1
    s_add_u32 s5, s5, s39
    s_lshl_b32 s5, s5, 8
    s_and_b32 s6, s33, 1
    s_mul_i32 s6, s6, 18432
    s_add_u32 s5, s5, s6
    s_add_u32 s32, s5, 0x480000
    v_lshlrev_b32 v29, 2, v1
    v_cndmask_b32 v36, v46, v45, vcc
    v_lshlrev_b32 v28, 2, v0
    v_add_u32 v28, 159744, v28
    s_branch ffn_hop
ffn_hb:
    s_add_u32 m0, s58, 102400
    s_nop 0
    buffer_load_dwordx4 v3, s[40:43], s72 offen lds
    s_add_u32 s72, s72, 294912
    s_add_u32 m0, s58, 106496
    s_nop 0
    buffer_load_dwordx4 v3, s[20:23], s72 offen lds
    s_add_u32 m0, s58, 110592
    s_nop 0
    buffer_load_dwordx4 v3, s[40:43], s72 offen lds
    s_add_u32 s72, s72, 294912
    s_add_u32 m0, s58, 114688
    s_nop 0
    buffer_load_dwordx4 v3, s[20:23], s72 offen lds
    s_add_u32 m0, s58, 118784
    s_nop 0
    buffer_load_dwordx4 v3, s[40:43], s72 offen lds
    s_add_u32 s72, s72, 294912
    s_mov_b32 s11, 0x100000
    s_waitcnt vmcnt(9)
ffn_q0:
    v_cmp_ne_u32 vcc, s96, v7
    s_cbranch_vccz ffn_q2
    buffer_load_dword v7, v6, s[28:31], s13 offen sc1
    s_sub_u32 s11, s11, 1
    s_cbranch_scc1 ffn_q2
    s_sleep 6
    s_waitcnt vmcnt(0)
    s_branch ffn_q0
ffn_p1:
    buffer_load_dword v5, v4, s[28:31], s13 offen sc1
    s_sub_u32 s11, s11, 1
    s_cbranch_scc1 ffn_p2
    s_sleep 6
    s_waitcnt vmcnt(0)
    v_cmp_ne_u32 vcc, s96, v5
    s_cbranch_vccnz ffn_p1
    s_branch ffn_p2
ffn_m1:
    s_mov_b32 s11, 0x100000
ffn_m3:
    s_sub_u32 s11, s11, 1
    s_cbranch_scc1 ffn_m2
    buffer_load_dwordx2 v[52:53], v38, s[28:31], s25 offen sc1
    buffer_load_dwordx2 v[56:57], v38, s[28:31], s26 offen sc1
    buffer_load_dwordx2 v[60:61], v38, s[28:31], s27 offen sc1
    s_waitcnt vmcnt(0)
    v_xor_b32 v53, s96, v53
    v_bitop3_b32 v53, v57, s96, v53 bitop3:0xbe
    v_bitop3_b32 v53, v61, s96, v53 bitop3:0xbe
    v_cmp_ne_u32 vcc, 0, v53
    s_cbranch_vccnz ffn_m3
    s_branch ffn_m2
ffn_b1:
    s_mov_b32 s11, 0x100000
ffn_b3:
    s_sub_u32 s11, s11, 1
    s_cbranch_scc1 ffn_b2
    buffer_load_dword v38, v39, s[28:31], s13 offen sc1
    s_waitcnt vmcnt(0)
    v_cmp_ne_u32 vcc, s96, v38
    s_cbranch_vccnz ffn_b3
    s_branch ffn_b2
ffn_again:
    s_sub_u32 s5, s5, 1
    s_cbranch_scc1 ffn_fin
    buffer_load_dwordx4 v[220:223], v24, s[28:31], s50 offen offset:0 sc1
    buffer_load_dwordx4 v[184:187], v24, s[28:31], s55 offen offset:0 sc1
    buffer_load_dwordx4 v[216:219], v24, s[28:31], s56 offen offset:0 sc1
    buffer_load_dwordx4 v[180:183], v24, s[28:31], s50 offen offset:1024 sc1
    buffer_load_dwordx4 v[212:215], v24, s[28:31], s55 offen offset:1024 sc1
    buffer_load_dwordx4 v[176:179], v24, s[28:31], s56 offen offset:1024 sc1
    buffer_load_dwordx4 v[112:115], v34, s[28:31], s50 offen offset:2048 sc1
    buffer_load_dwordx4 v[116:119], v34, s[28:31], s55 offen offset:2048 sc1
    buffer_load_dwordx4 v[120:123], v34, s[28:31], s56 offen offset:2048 sc1
    s_branch ffn_retry
ffn_slow2:
    s_mov_b32 s11, 0x100000
ffn_spin2:
    s_sub_u32 s11, s11, 1
    s_cbranch_scc1 ffn_back2
    buffer_load_dword v29, v32, s[28:31], s12 offen sc1
    s_waitcnt vmcnt(0)
    v_cmp_ne_u32 vcc, s96, v29
    s_cbranch_vccnz ffn_spin2
    s_branch ffn_back2
ffn_slow3:
    s_mov_b32 s11, 0x100000
ffn_spin3:
    s_sub_u32 s11, s11, 1
    s_cbranch_scc1 ffn_back3
    buffer_load_dword v29, v32, s[28:31], s12 offen sc1
    s_waitcnt vmcnt(0)
    v_cmp_ne_u32 vcc, s96, v29
    s_cbranch_vccnz ffn_spin3
    s_branch ffn_back3
ffn_slow4:
    s_mov_b32 s11, 0x100000
ffn_spin4:
    s_sub_u32 s11, s11, 1
    s_cbranch_scc1 ffn_back4
    buffer_load_dword v29, v32, s[28:31], s12 offen sc1
    s_waitcnt vmcnt(0)
    v_cmp_ne_u32 vcc, s96, v29
    s_cbranch_vccnz ffn_spin4
    s_branch ffn_back4
ffn_slow5:
    s_mov_b32 s11, 0x100000
ffn_spin5:
    s_sub_u32 s11, s11, 1
    s_cbranch_scc1 ffn_back5
    buffer_load_dword v29, v32, s[28:31], s12 offen sc1
    s_waitcnt vmcnt(0)
    v_cmp_ne_u32 vcc, s96, v29
    s_cbranch_vccnz ffn_spin5
    s_branch ffn_back5
ffn_last:
.section .rodata,"a"
.p2align 6
.amdhsa_kernel sequential_preLN__ssm_conv_s4__glu_gated_bilinear__prompt_kernel
  .amdhsa_next_free_vgpr 512
  .amdhsa_next_free_sgpr 102
  .amdhsa_accum_offset 256
  .amdhsa_group_segment_fixed_size 0
  .amdhsa_kernarg_size 128
  .amdhsa_user_sgpr_count 2
  .amdhsa_user_sgpr_kernarg_segment_ptr 1
  .amdhsa_system_sgpr_workgroup_id_x 1
  .amdhsa_float_denorm_mode_32 3
.end_amdhsa_kernel
```
